```python
import torch

def _softmax(x, axis=-1):
    return torch.softmax(x, dim=axis)
def _gelu(x):
    return torch.nn.functional.gelu(x, approximate="tanh")
def _silu(x):
    return torch.nn.functional.silu(x)
def _sigmoid(x):
    return torch.sigmoid(x)
def _layernorm(x, axis=-1, eps=1e-5):
    m = x.mean(dim=axis, keepdim=True)
    v = x.var(dim=axis, keepdim=True, unbiased=False)
    return (x - m) / torch.sqrt(v + eps)
def _scatter_add(tgt, idx, src, axis=0):
    return tgt.clone().index_add_(axis, idx, src)
def _segment_sum(src, seg, n):
    out = torch.zeros((n,) + src.shape[1:], dtype=src.dtype)
    return out.index_add_(0, seg, src)
def _pad(x, pw):
    flat = tuple(v for pair in reversed(pw) for v in pair)
    return torch.nn.functional.pad(x, flat)

kernel_name = 'interleave_layers__linear_kernel_hedgehog__mha_block__prompt'

def setup_inputs():

    _w = (lambda a: (lambda t: t.to(torch.bfloat16) if t.is_floating_point() else t)(torch.as_tensor(a)))
    def _A_setup():
        B, S, D, H = 1, 2048, 1024, 32
        Dh = D // H
        return {
            "x": _w((lambda *s: torch.randn(*s, dtype=torch.bfloat16) * 0.05)(B, S, D)),
            "wqkv": _w((lambda *s: torch.randn(*s, dtype=torch.bfloat16) * 0.2)(D, 3 * D)),
            "w_phi": _w((lambda *s: torch.randn(*s, dtype=torch.bfloat16) * 0.2)(H, Dh, Dh) * (Dh ** -0.5)),
            "wo": _w((lambda *s: torch.randn(*s, dtype=torch.bfloat16) * 0.05)(D, D)),
        }
    _A_in = _A_setup()

    def _B_setup():
        B, S, D, H = 1, 2048, 1024, 32
        return {
            "x": _w((lambda *s: torch.randn(*s, dtype=torch.bfloat16) * 0.05)(B, S, D)),
            "wqkv": _w((lambda *s: torch.randn(*s, dtype=torch.bfloat16) * 0.1)(D, 3 * D)),
            "wo": _w((lambda *s: torch.randn(*s, dtype=torch.bfloat16) * 0.05)(D, D)),
        }
    _B_in = _B_setup()

    return {
        "A_x": _A_in["x"],
        "A_wqkv": _A_in["wqkv"],
        "A_w_phi": _A_in["w_phi"],
        "A_wo": _A_in["wo"],
        "B_x": _B_in["x"],
        "B_wqkv": _B_in["wqkv"],
        "B_wo": _B_in["wo"],
    }

def reference(A_x, A_wqkv, A_w_phi, A_wo, B_x, B_wqkv, B_wo):
    def _A_ref(x, wqkv, w_phi, wo):
        B, S, D = x.shape
        H = 32; Dh = D // H
        qkv = (lambda x, *d: x.permute(*d))((x @ wqkv).reshape(B, S, 3, H, Dh), 2, 0, 3, 1, 4)
        q, k, v = qkv[0], qkv[1], qkv[2]
        pq = torch.einsum("bhsd,hdf->bhsf", q, w_phi)
        pk = torch.einsum("bhsd,hdf->bhsf", k, w_phi)
        phi_q = torch.concatenate([_softmax(pq, axis=-1), _softmax(-pq, axis=-1)], axis=-1)
        phi_k = torch.concatenate([_softmax(pk, axis=-1), _softmax(-pk, axis=-1)], axis=-1)
        kv = torch.einsum("bhsf,bhsd->bhfd", phi_k, v)
        z  = torch.einsum("bhsf->bhf", phi_k)
        num = torch.einsum("bhqf,bhfd->bhqd", phi_q, kv)
        den = torch.einsum("bhqf,bhf->bhq", phi_q, z)[..., None] + 1e-6
        o = num / den
        return (lambda x, *d: x.permute(*d))(o, 0, 2, 1, 3).reshape(B, S, D) @ wo

    def _B_ref(x, wqkv, wo):
        B, S, D = x.shape
        H = 32
        Dh = D // H
        qkv = (lambda x, *d: x.permute(*d))((x @ wqkv).reshape(B, S, 3, H, Dh), 2, 0, 3, 1, 4)
        q, k, v = qkv[0], qkv[1], qkv[2]
        scores = torch.einsum("bhqd,bhkd->bhqk", q, k) * (Dh ** -0.5)
        p = _softmax(scores, axis=-1)
        o = torch.einsum("bhqk,bhkd->bhqd", p, v)
        return (lambda x, *d: x.permute(*d))(o, 0, 2, 1, 3).reshape(B, S, D) @ wo

    x = A_x
    x = x + _A_ref(_layernorm(x, axis=-1), A_wqkv, A_w_phi, A_wo)
    x = x + _B_ref(_layernorm(x, axis=-1), B_wqkv, B_wo)
    x = x + _A_ref(_layernorm(x, axis=-1), A_wqkv, A_w_phi, A_wo)
    x = x + _B_ref(_layernorm(x, axis=-1), B_wqkv, B_wo)
    return x
```

```asm
; @launch grid=(256,1,1) block=(512,1,1) lds=155648
.amdgcn_target "amdgcn-amd-amdhsa--gfx950"
.text
.globl interleave_layers__linear_kernel_hedgehog__mha_block__prompt_kernel
.p2align 8
.type interleave_layers__linear_kernel_hedgehog__mha_block__prompt_kernel,@function
interleave_layers__linear_kernel_hedgehog__mha_block__prompt_kernel:
s_load_dwordx2 s[4:5], s[0:1], 72
s_load_dwordx2 s[6:7], s[0:1], 8
s_load_dwordx2 s[8:9], s[0:1], 40
s_load_dwordx2 s[10:11], s[0:1], 16
s_load_dwordx2 s[12:13], s[0:1], 24
s_load_dwordx2 s[14:15], s[0:1], 48
s_load_dwordx2 s[16:17], s[0:1], 56
s_load_dwordx2 s[18:19], s[0:1], 0
s_cmp_ge_u32 s2, 256
s_cbranch_scc1 L_interleave_layers__linear_kernel_hedgehog__mha_block__prompt_kernel_end
s_and_b32 s31, s2, 1
s_lshl_b32 s31, s31, 3
s_bfe_u32 s32, s2, 0x30003
s_add_u32 s20, s31, s32
s_bfe_u32 s31, s2, 0x20001
s_lshl_b32 s31, s31, 2
s_bfe_u32 s32, s2, 0x20006
s_add_u32 s21, s31, s32
v_lshrrev_b32 v1, 6, v0
v_and_b32 v0, 63, v0
s_nop 0
v_readfirstlane_b32 s22, v1
v_lshlrev_b32 v239, 4, v0
s_and_b32 s23, s22, 1
s_bfe_u32 s26, s22, 0x10001
s_lshr_b32 s28, s22, 2
s_lshl_b32 s31, s26, 1
s_add_u32 s24, s31, s28
s_and_b32 s27, s22, 3
s_lshl_b32 s25, s21, 1
s_add_u32 s25, s25, s23
s_mov_b32 s29, 0
s_mov_b32 s30, 0
s_mov_b32 s56, 0
s_mov_b32 s57, 0
s_mov_b32 s58, 0
s_mov_b32 s59, 0
s_mov_b32 s60, 0
s_mov_b32 s61, 0
s_mov_b32 s62, 0
s_mov_b32 s63, 0
s_mov_b32 s64, 0
s_mov_b32 s65, 0
s_mov_b32 s66, 0
s_mov_b32 s67, 0
s_mov_b32 s68, 0
s_mov_b32 s69, 0
s_mov_b32 s70, 0
s_mov_b32 s71, 0
s_mov_b32 s72, 0
s_mov_b32 s73, 0
s_mov_b32 s74, 0
s_mov_b32 s75, 0
s_mov_b32 s76, 0
s_mov_b32 s77, 0
s_mov_b32 s78, 0
s_mov_b32 s79, 0
s_waitcnt lgkmcnt(0)
s_add_u32 s48, s4, 59797504
s_addc_u32 s49, s5, 0
s_load_dword s35, s[48:49], 0
s_add_u32 s52, s4, 59768832
s_addc_u32 s53, s5, 0
s_mov_b32 s54, 28800
s_mov_b32 s55, 0x20000
s_add_u32 s40, s4, 59768832
s_addc_u32 s41, s5, 0
s_mov_b32 s42, 28800
s_mov_b32 s43, 0x20000
s_add_u32 s44, s4, 59768832
s_addc_u32 s45, s5, 0
s_mov_b32 s46, 28800
s_mov_b32 s47, 0x20000
s_mov_b32 s36, s18
s_mov_b32 s37, s19
s_mov_b32 s38, 4194304
s_mov_b32 s39, 0x20000
s_cmp_lg_u32 s28, 0
s_cbranch_scc1 L_interleave_layers__linear_kernel_hedgehog__mha_block__prompt_kernel_firstL
v_and_b32 v4, 31, v0
v_lshlrev_b32 v4, 11, v4
v_lshrrev_b32 v5, 5, v0
v_lshlrev_b32 v5, 3, v5
v_add_u32 v4, v4, v5
s_lshl_b32 s31, s20, 2
s_add_u32 s31, s31, s27
s_lshl_b32 s31, s31, 16
s_lshl_b32 s32, s21, 7
s_add_u32 s31, s31, s32
buffer_load_dwordx2 v[240:241], v4, s[36:39], s31 offen offset:0
buffer_load_dwordx2 v[242:243], v4, s[36:39], s31 offen offset:16
buffer_load_dwordx2 v[244:245], v4, s[36:39], s31 offen offset:32
buffer_load_dwordx2 v[246:247], v4, s[36:39], s31 offen offset:48
buffer_load_dwordx2 v[248:249], v4, s[36:39], s31 offen offset:64
buffer_load_dwordx2 v[250:251], v4, s[36:39], s31 offen offset:80
buffer_load_dwordx2 v[252:253], v4, s[36:39], s31 offen offset:96
buffer_load_dwordx2 v[254:255], v4, s[36:39], s31 offen offset:112
v_lshrrev_b32 v1, 5, v0
v_lshlrev_b32 v1, 2, v1
v_bfe_u32 v2, v0, 2, 2
v_add_u32 v1, v1, v2
v_lshlrev_b32 v1, 7, v1
v_bfe_u32 v2, v0, 4, 1
v_lshlrev_b32 v2, 1, v2
v_bfe_u32 v3, v0, 1, 1
v_add_u32 v2, v2, v3
v_add_u32 v2, 0, v2
v_bfe_u32 v3, v0, 3, 1
v_lshlrev_b32 v3, 2, v3
v_xor_b32 v2, v2, v3
v_lshlrev_b32 v2, 4, v2
v_add_u32 v1, v1, v2
v_and_b32 v2, 1, v0
v_lshlrev_b32 v2, 3, v2
v_add_u32 v1, v1, v2
v_add_u32 v237, 8192, v1
v_lshrrev_b32 v1, 5, v0
v_lshlrev_b32 v1, 2, v1
v_bfe_u32 v2, v0, 2, 2
v_add_u32 v1, v1, v2
v_lshlrev_b32 v1, 7, v1
v_bfe_u32 v2, v0, 4, 1
v_lshlrev_b32 v2, 1, v2
v_bfe_u32 v3, v0, 1, 1
v_add_u32 v2, v2, v3
v_add_u32 v2, 4, v2
v_bfe_u32 v3, v0, 3, 1
v_lshlrev_b32 v3, 2, v3
v_xor_b32 v2, v2, v3
v_lshlrev_b32 v2, 4, v2
v_add_u32 v1, v1, v2
v_and_b32 v2, 1, v0
v_lshlrev_b32 v2, 3, v2
v_add_u32 v1, v1, v2
v_add_u32 v238, 8192, v1
s_lshl_b32 s32, s23, 2
v_lshrrev_b32 v1, 5, v0
v_lshlrev_b32 v1, 2, v1
v_bfe_u32 v2, v0, 2, 2
v_add_u32 v1, v1, v2
v_lshlrev_b32 v1, 7, v1
v_bfe_u32 v2, v0, 4, 1
v_lshlrev_b32 v2, 1, v2
v_bfe_u32 v3, v0, 1, 1
v_add_u32 v2, v2, v3
v_add_u32 v2, s32, v2
v_bfe_u32 v3, v0, 3, 1
v_lshlrev_b32 v3, 2, v3
v_xor_b32 v2, v2, v3
v_lshlrev_b32 v2, 4, v2
v_add_u32 v1, v1, v2
v_and_b32 v2, 1, v0
v_lshlrev_b32 v2, 3, v2
v_add_u32 v1, v1, v2
v_add_u32 v233, 16384, v1
s_lshl_b32 s31, s26, 12
s_add_u32 s31, s31, 8192
v_add_u32 v232, s31, v239
s_lshl_b32 s31, s26, 8
v_lshrrev_b32 v1, 5, v0
v_lshlrev_b32 v1, 4, v1
v_add_u32 v234, s31, v1
v_and_b32 v1, 31, v0
v_lshlrev_b32 v1, 2, v1
v_add_u32 v235, s31, v1
s_barrier
s_waitcnt vmcnt(0) lgkmcnt(0)
s_add_u32 s35, s35, 1
s_add_u32 s48, s4, 59768832
s_addc_u32 s49, s5, 0
s_mov_b32 s50, 28800
s_mov_b32 s51, 0x20000
v_lshlrev_b32 v4, 16, v240
v_and_b32 v5, 0xffff0000, v240
v_lshlrev_b32 v6, 16, v241
v_and_b32 v7, 0xffff0000, v241
v_lshlrev_b32 v8, 16, v242
v_and_b32 v9, 0xffff0000, v242
v_lshlrev_b32 v10, 16, v243
v_and_b32 v11, 0xffff0000, v243
v_lshlrev_b32 v12, 16, v244
v_and_b32 v13, 0xffff0000, v244
v_lshlrev_b32 v14, 16, v245
v_and_b32 v15, 0xffff0000, v245
v_lshlrev_b32 v16, 16, v246
v_and_b32 v17, 0xffff0000, v246
v_lshlrev_b32 v18, 16, v247
v_and_b32 v19, 0xffff0000, v247
v_lshlrev_b32 v20, 16, v248
v_and_b32 v21, 0xffff0000, v248
v_lshlrev_b32 v22, 16, v249
v_and_b32 v23, 0xffff0000, v249
v_lshlrev_b32 v24, 16, v250
v_and_b32 v25, 0xffff0000, v250
v_lshlrev_b32 v26, 16, v251
v_and_b32 v27, 0xffff0000, v251
v_lshlrev_b32 v28, 16, v252
v_and_b32 v29, 0xffff0000, v252
v_lshlrev_b32 v30, 16, v253
v_and_b32 v31, 0xffff0000, v253
v_lshlrev_b32 v32, 16, v254
v_and_b32 v33, 0xffff0000, v254
v_lshlrev_b32 v34, 16, v255
v_and_b32 v35, 0xffff0000, v255
s_mov_b32 s65, 0
s_mul_i32 s31, s65, 4194304
s_add_u32 s31, s31, 0
s_add_u32 s36, s4, s31
s_addc_u32 s37, s5, 0
s_mov_b32 s38, 4194304
s_mov_b32 s39, 0x20000
s_lshl_b32 s31, s20, 2
s_add_u32 s31, s31, s27
s_lshl_b32 s31, s31, 16
s_lshl_b32 s32, s21, 12
s_add_u32 s31, s31, s32
buffer_store_dwordx4 v[240:243], v239, s[36:39], s31 offen offset:0 sc1
buffer_store_dwordx4 v[244:247], v239, s[36:39], s31 offen offset:1024 sc1
buffer_store_dwordx4 v[248:251], v239, s[36:39], s31 offen offset:2048 sc1
buffer_store_dwordx4 v[252:255], v239, s[36:39], s31 offen offset:3072 sc1
v_pk_mul_f32 v[190:191], v[4:5], v[4:5]
v_pk_add_f32 v[188:189], v[4:5], v[6:7]
v_pk_fma_f32 v[190:191], v[6:7], v[6:7], v[190:191]
v_pk_add_f32 v[188:189], v[188:189], v[8:9]
v_pk_fma_f32 v[190:191], v[8:9], v[8:9], v[190:191]
v_pk_add_f32 v[188:189], v[188:189], v[10:11]
v_pk_fma_f32 v[190:191], v[10:11], v[10:11], v[190:191]
v_pk_add_f32 v[188:189], v[188:189], v[12:13]
v_pk_fma_f32 v[190:191], v[12:13], v[12:13], v[190:191]
v_pk_add_f32 v[188:189], v[188:189], v[14:15]
v_pk_fma_f32 v[190:191], v[14:15], v[14:15], v[190:191]
v_pk_add_f32 v[188:189], v[188:189], v[16:17]
v_pk_fma_f32 v[190:191], v[16:17], v[16:17], v[190:191]
v_pk_add_f32 v[188:189], v[188:189], v[18:19]
v_pk_fma_f32 v[190:191], v[18:19], v[18:19], v[190:191]
v_pk_add_f32 v[188:189], v[188:189], v[20:21]
v_pk_fma_f32 v[190:191], v[20:21], v[20:21], v[190:191]
v_pk_add_f32 v[188:189], v[188:189], v[22:23]
v_pk_fma_f32 v[190:191], v[22:23], v[22:23], v[190:191]
v_pk_add_f32 v[188:189], v[188:189], v[24:25]
v_pk_fma_f32 v[190:191], v[24:25], v[24:25], v[190:191]
v_pk_add_f32 v[188:189], v[188:189], v[26:27]
v_pk_fma_f32 v[190:191], v[26:27], v[26:27], v[190:191]
v_pk_add_f32 v[188:189], v[188:189], v[28:29]
v_pk_fma_f32 v[190:191], v[28:29], v[28:29], v[190:191]
v_pk_add_f32 v[188:189], v[188:189], v[30:31]
v_pk_fma_f32 v[190:191], v[30:31], v[30:31], v[190:191]
v_pk_add_f32 v[188:189], v[188:189], v[32:33]
v_pk_fma_f32 v[190:191], v[32:33], v[32:33], v[190:191]
v_pk_add_f32 v[188:189], v[188:189], v[34:35]
v_pk_fma_f32 v[190:191], v[34:35], v[34:35], v[190:191]
v_add_f32 v186, v188, v189
v_add_f32 v187, v190, v191
v_mov_b32 v184, v186
s_nop 1
v_permlane32_swap_b32 v184, v186
v_add_f32 v186, v186, v184
v_mov_b32 v185, v187
s_nop 1
v_permlane32_swap_b32 v185, v187
v_add_f32 v187, v187, v185
s_mul_i32 s31, s65, 262144
s_add_u32 s31, s31, 55574528
s_add_u32 s48, s4, s31
s_addc_u32 s49, s5, 0
s_mov_b32 s50, 262144
s_mov_b32 s51, 0x20000
s_lshl_b32 s31, s21, 14
s_lshl_b32 s32, s20, 10
s_add_u32 s31, s31, s32
s_lshl_b32 s32, s27, 8
s_add_u32 s31, s31, s32
v_lshlrev_b32 v184, 3, v0
s_mov_b64 exec, 0xffffffff
buffer_store_dwordx2 v[186:187], v184, s[48:51], s31 offen sc1
s_mov_b64 exec, -1
s_waitcnt vmcnt(0)
s_barrier
s_cmp_lg_u32 s22, 0
s_cbranch_scc1 L_interleave_layers__linear_kernel_hedgehog__mha_block__prompt_kernel_st_x_npub
s_mul_i32 s31, s65, 2048
s_lshl_b32 s70, s20, 7
s_add_u32 s70, s70, s31
s_add_u32 s70, s70, 0
s_lshl_b32 s31, s21, 2
s_add_u32 s32, s70, s31
v_mov_b32 v1, s35
v_mov_b32 v2, 0
s_mov_b64 exec, 1
buffer_store_dword v1, v2, s[52:55], s32 offen sc1
s_mov_b64 exec, -1
L_interleave_layers__linear_kernel_hedgehog__mha_block__prompt_kernel_st_x_npub:
v_mov_b32 v210, v232
v_mov_b32 v211, v233
v_mov_b32 v52, 0
v_mov_b32 v53, 0
v_mov_b32 v54, 0
v_mov_b32 v55, 0
v_mov_b32 v56, 0
v_mov_b32 v57, 0
v_mov_b32 v58, 0
v_mov_b32 v59, 0
v_mov_b32 v60, 0
v_mov_b32 v61, 0
v_mov_b32 v62, 0
v_mov_b32 v63, 0
v_mov_b32 v64, 0
v_mov_b32 v65, 0
v_mov_b32 v66, 0
v_mov_b32 v67, 0
v_mov_b32 v68, 0
v_mov_b32 v69, 0
v_mov_b32 v70, 0
v_mov_b32 v71, 0
v_mov_b32 v72, 0
v_mov_b32 v73, 0
v_mov_b32 v74, 0
v_mov_b32 v75, 0
v_mov_b32 v76, 0
v_mov_b32 v77, 0
v_mov_b32 v78, 0
v_mov_b32 v79, 0
v_mov_b32 v80, 0
v_mov_b32 v81, 0
v_mov_b32 v82, 0
v_mov_b32 v83, 0
v_mov_b32 v84, 0
v_mov_b32 v85, 0
v_mov_b32 v86, 0
v_mov_b32 v87, 0
v_mov_b32 v88, 0
v_mov_b32 v89, 0
v_mov_b32 v90, 0
v_mov_b32 v91, 0
v_mov_b32 v92, 0
v_mov_b32 v93, 0
v_mov_b32 v94, 0
v_mov_b32 v95, 0
v_mov_b32 v96, 0
v_mov_b32 v97, 0
v_mov_b32 v98, 0
v_mov_b32 v99, 0
v_mov_b32 v100, 0
v_mov_b32 v101, 0
v_mov_b32 v102, 0
v_mov_b32 v103, 0
v_mov_b32 v104, 0
v_mov_b32 v105, 0
v_mov_b32 v106, 0
v_mov_b32 v107, 0
v_mov_b32 v108, 0
v_mov_b32 v109, 0
v_mov_b32 v110, 0
v_mov_b32 v111, 0
v_mov_b32 v112, 0
v_mov_b32 v113, 0
v_mov_b32 v114, 0
v_mov_b32 v115, 0
v_mov_b32 v116, 0
v_mov_b32 v117, 0
v_mov_b32 v118, 0
v_mov_b32 v119, 0
v_mov_b32 v120, 0
v_mov_b32 v121, 0
v_mov_b32 v122, 0
v_mov_b32 v123, 0
v_mov_b32 v124, 0
v_mov_b32 v125, 0
v_mov_b32 v126, 0
v_mov_b32 v127, 0
v_mov_b32 v128, 0
v_mov_b32 v129, 0
v_mov_b32 v130, 0
v_mov_b32 v131, 0
v_mov_b32 v132, 0
v_mov_b32 v133, 0
v_mov_b32 v134, 0
v_mov_b32 v135, 0
v_mov_b32 v136, 0
v_mov_b32 v137, 0
v_mov_b32 v138, 0
v_mov_b32 v139, 0
v_mov_b32 v140, 0
v_mov_b32 v141, 0
v_mov_b32 v142, 0
v_mov_b32 v143, 0
v_mov_b32 v144, 0
v_mov_b32 v145, 0
v_mov_b32 v146, 0
v_mov_b32 v147, 0
s_branch L_interleave_layers__linear_kernel_hedgehog__mha_block__prompt_kernel_loop
L_interleave_layers__linear_kernel_hedgehog__mha_block__prompt_kernel_firstL:
v_lshrrev_b32 v1, 3, v0
v_lshrrev_b32 v2, 4, v0
v_and_b32 v2, 1, v2
v_lshlrev_b32 v2, 2, v2
v_xor_b32 v2, v0, v2
v_and_b32 v2, 7, v2
v_lshlrev_b32 v2, 4, v2
s_lshl_b32 s31, s27, 3
v_add_u32 v3, s31, v1
v_mul_u32_u24 v3, 6144, v3
v_add_u32 v232, v3, v2
v_add_u32 v233, 2048, v232
v_add_u32 v235, 4096, v232
s_lshl_b32 s31, s27, 3
v_add_u32 v3, s31, v1
v_lshlrev_b32 v3, 11, v3
v_add_u32 v234, v3, v2
s_mov_b32 s40, s6
s_mov_b32 s41, s7
s_mov_b32 s42, 6291456
s_mov_b32 s43, 0x20000
s_lshl_b32 s61, s27, 11
s_lshl_b32 s62, s27, 10
s_add_u32 s62, s62, 8192
s_add_u32 s58, s62, 4096
s_add_u32 s78, s62, 8192
s_lshl_b32 s59, s21, 7
s_mov_b32 s60, 8192
s_mov_b32 s44, s10
s_mov_b32 s45, s11
s_mov_b32 s46, 65536
s_mov_b32 s47, 0x20000
s_lshl_b32 s31, s27, 10
s_add_u32 m0, s31, 4096
s_lshl_b32 s32, s21, 12
s_add_u32 s31, s31, s32
buffer_load_dwordx4 v239, s[44:47], s31 offen lds
s_mul_i32 s57, s21, 393216
s_add_u32 s57, s57, s59
s_add_u32 m0, s60, s62
s_nop 0
buffer_load_dwordx4 v232, s[40:43], s57 offen lds
s_add_u32 m0, s60, s58
s_nop 0
buffer_load_dwordx4 v233, s[40:43], s57 offen lds
s_add_u32 m0, s60, s78
s_nop 0
buffer_load_dwordx4 v235, s[40:43], s57 offen lds
s_add_u32 s57, s57, 196608
s_add_u32 s60, s60, 20480
s_cmp_eq_u32 s60, 151552
s_cselect_b32 s60, 8192, s60
s_add_u32 m0, s60, s62
s_nop 0
buffer_load_dwordx4 v232, s[40:43], s57 offen lds
s_add_u32 m0, s60, s58
s_nop 0
buffer_load_dwordx4 v233, s[40:43], s57 offen lds
s_add_u32 m0, s60, s78
s_nop 0
buffer_load_dwordx4 v235, s[40:43], s57 offen lds
s_add_u32 s57, s57, 196608
s_add_u32 s60, s60, 20480
s_cmp_eq_u32 s60, 151552
s_cselect_b32 s60, 8192, s60
s_mov_b32 s60, 110592
s_mul_i32 s57, s20, 393216
s_add_u32 s57, s57, s59
s_add_u32 m0, s60, s62
s_nop 0
buffer_load_dwordx4 v232, s[40:43], s57 offen lds
s_add_u32 m0, s60, s58
s_nop 0
buffer_load_dwordx4 v233, s[40:43], s57 offen lds
s_add_u32 m0, s60, s78
s_nop 0
buffer_load_dwordx4 v235, s[40:43], s57 offen lds
s_add_u32 s57, s57, 196608
s_add_u32 s60, s60, 20480
s_cmp_eq_u32 s60, 151552
s_cselect_b32 s60, 8192, s60
s_add_u32 m0, s60, s62
s_nop 0
buffer_load_dwordx4 v232, s[40:43], s57 offen lds
s_add_u32 m0, s60, s58
s_nop 0
buffer_load_dwordx4 v233, s[40:43], s57 offen lds
s_add_u32 m0, s60, s78
s_nop 0
buffer_load_dwordx4 v235, s[40:43], s57 offen lds
s_add_u32 s57, s57, 196608
s_add_u32 s60, s60, 20480
s_cmp_eq_u32 s60, 151552
s_cselect_b32 s60, 8192, s60
s_mov_b32 s60, 8192
v_lshlrev_b32 v1, 2, v0
v_mov_b32 v2, 0
ds_write_b32 v1, v2 offset:2048
s_waitcnt lgkmcnt(0)
s_add_u32 s35, s35, 1
s_barrier
s_add_u32 s48, s4, 59768832
s_addc_u32 s49, s5, 0
s_mov_b32 s50, 28800
s_mov_b32 s51, 0x20000
s_barrier
L_interleave_layers__linear_kernel_hedgehog__mha_block__prompt_kernel_loop:
s_cmp_lg_u32 s28, 0
s_cbranch_scc1 L_interleave_layers__linear_kernel_hedgehog__mha_block__prompt_kernel_gL
s_mov_b32 s67, 4294844416
s_mov_b32 s66, 0
s_mul_i32 s31, s29, 2048
s_lshl_b32 s70, s20, 7
s_add_u32 s70, s70, s31
s_add_u32 s70, s70, 0
s_lshl_b32 s31, s21, 2
s_add_u32 s68, s70, s31
s_cmp_eq_u32 s22, 0
s_cselect_b32 s69, 1, 0
s_mov_b32 s71, 0
s_lshl_b32 s75, s29, 1
s_add_u32 s75, s75, 1
s_lshl_b32 s75, s75, 16
s_barrier
s_cmp_ge_u32 s29, 2
s_cbranch_scc1 L_interleave_layers__linear_kernel_hedgehog__mha_block__prompt_kernel_g_cno
s_cmp_lg_u32 s26, 0
s_cbranch_scc1 L_interleave_layers__linear_kernel_hedgehog__mha_block__prompt_kernel_g_csb
v_add_u32 v230, 102400, v211
v_add_u32 v231, 122880, v211
ds_read_b64_tr_b16 v[4:5], v230 offset:0
ds_read_b64_tr_b16 v[6:7], v230 offset:1024
ds_read_b64_tr_b16 v[8:9], v230 offset:4096
ds_read_b64_tr_b16 v[10:11], v230 offset:5120
ds_read_b64_tr_b16 v[12:13], v230 offset:8192
ds_read_b64_tr_b16 v[14:15], v230 offset:9216
ds_read_b64_tr_b16 v[16:17], v230 offset:2048
ds_read_b64_tr_b16 v[18:19], v230 offset:3072
ds_read_b64_tr_b16 v[20:21], v230 offset:6144
ds_read_b64_tr_b16 v[22:23], v230 offset:7168
ds_read_b64_tr_b16 v[24:25], v230 offset:10240
ds_read_b64_tr_b16 v[26:27], v230 offset:11264
s_waitcnt lgkmcnt(6)
ds_read_b64_tr_b16 v[28:29], v231 offset:0
ds_read_b64_tr_b16 v[30:31], v231 offset:1024
ds_read_b64_tr_b16 v[32:33], v231 offset:4096
ds_read_b64_tr_b16 v[34:35], v231 offset:5120
ds_read_b64_tr_b16 v[36:37], v231 offset:8192
ds_read_b64_tr_b16 v[38:39], v231 offset:9216
s_waitcnt lgkmcnt(6)
ds_read_b64_tr_b16 v[40:41], v231 offset:2048
ds_read_b64_tr_b16 v[42:43], v231 offset:3072
ds_read_b64_tr_b16 v[44:45], v231 offset:6144
ds_read_b64_tr_b16 v[46:47], v231 offset:7168
ds_read_b64_tr_b16 v[48:49], v231 offset:10240
ds_read_b64_tr_b16 v[50:51], v231 offset:11264
v_and_b32 v1, 7, v0
v_bfe_u32 v2, v0, 4, 1
v_lshlrev_b32 v2, 2, v2
v_cmp_eq_u32 vcc, v1, v2
v_mov_b32 v1, 0
v_mov_b32 v2, 0x3f803f80
v_cndmask_b32 v214, v1, v2, vcc
v_mov_b32 v215, v214
v_mov_b32 v216, v214
v_mov_b32 v217, v214
s_waitcnt lgkmcnt(0)
s_barrier
v_mfma_f32_16x16x32_bf16 v[218:221], v[214:217], v[4:7], 0
v_mfma_f32_16x16x32_bf16 v[222:225], v[214:217], v[8:11], 0
v_mfma_f32_16x16x32_bf16 v[226:229], v[214:217], v[12:15], 0
v_mfma_f32_16x16x32_bf16 v[218:221], v[214:217], v[16:19], v[218:221]
v_mfma_f32_16x16x32_bf16 v[222:225], v[214:217], v[20:23], v[222:225]
v_mfma_f32_16x16x32_bf16 v[226:229], v[214:217], v[24:27], v[226:229]
v_mfma_f32_16x16x32_bf16 v[218:221], v[214:217], v[28:31], v[218:221]
v_mfma_f32_16x16x32_bf16 v[222:225], v[214:217], v[32:35], v[222:225]
v_mfma_f32_16x16x32_bf16 v[226:229], v[214:217], v[36:39], v[226:229]
v_mfma_f32_16x16x32_bf16 v[218:221], v[214:217], v[40:43], v[218:221]
v_mfma_f32_16x16x32_bf16 v[222:225], v[214:217], v[44:47], v[222:225]
v_mfma_f32_16x16x32_bf16 v[226:229], v[214:217], v[48:51], v[226:229]
s_add_u32 s48, s4, 58720256
s_addc_u32 s49, s5, 0
s_mov_b32 s50, 393216
s_mov_b32 s51, 0x20000
s_lshl_b32 s31, s29, 4
s_add_u32 s31, s31, s21
s_lshl_b32 s31, s31, 4
s_add_u32 s31, s31, s20
s_mul_i32 s31, s31, 768
s_lshl_b32 s32, s23, 7
s_add_u32 s31, s31, s32
v_lshlrev_b32 v1, 2, v0
s_mov_b64 exec, 0xffffffff
buffer_store_dword v218, v1, s[48:51], s31 offen offset:0 sc1
buffer_store_dword v222, v1, s[48:51], s31 offen offset:256 sc1
buffer_store_dword v226, v1, s[48:51], s31 offen offset:512 sc1
s_mov_b64 exec, -1
s_branch L_interleave_layers__linear_kernel_hedgehog__mha_block__prompt_kernel_g_cno
L_interleave_layers__linear_kernel_hedgehog__mha_block__prompt_kernel_g_csb:
s_barrier
L_interleave_layers__linear_kernel_hedgehog__mha_block__prompt_kernel_g_cno:
s_bitcmp1_b32 s29, 0
s_cselect_b32 s44, s8, s6
s_cselect_b32 s45, s9, s7
s_mov_b32 s46, 6291456
s_mov_b32 s47, 0x20000
s_and_b32 s68, s20, 7
s_cmp_eq_u32 s22, 0
s_cselect_b32 s68, 99, s68
s_and_b32 s31, s21, 7
s_cmp_eq_u32 s31, 3
s_cselect_b32 s68, s68, 99
v_mul_u32_u24 v46, 6144, v0
s_sub_u32 s31, s22, 1
s_lshl_b32 s31, s31, 11
s_lshl_b32 s32, s21, 7
s_add_u32 s31, s31, s32
v_add_u32 v46, s31, v46
ds_read_b128 v[148:151], v210 offset:0
ds_read_b64_tr_b16 v[164:165], v211 offset:0
ds_read_b64_tr_b16 v[166:167], v211 offset:1024
ds_read_b128 v[152:155], v210 offset:2048
ds_read_b64_tr_b16 v[168:169], v211 offset:4096
ds_read_b64_tr_b16 v[170:171], v211 offset:5120
ds_read_b64_tr_b16 v[172:173], v211 offset:8192
ds_read_b64_tr_b16 v[174:175], v211 offset:9216
s_waitcnt lgkmcnt(5)
v_mfma_f32_32x32x16_bf16 v[52:67], v[164:167], v[148:151], v[52:67]
ds_read_b128 v[156:159], v210 offset:1024
ds_read_b64_tr_b16 v[176:177], v211 offset:2048
s_add_u32 s66, s66, 20480
s_cmp_eq_u32 s66, 143360
s_cselect_b32 s65, s67, 20480
s_cselect_b32 s66, 0, s66
s_waitcnt lgkmcnt(6)
v_mfma_f32_32x32x16_bf16 v[68:83], v[164:167], v[152:155], v[68:83]
ds_read_b64_tr_b16 v[178:179], v211 offset:3072
ds_read_b128 v[160:163], v210 offset:3072
s_cmp_lg_u32 s69, 0
s_cbranch_scc1 L_interleave_layers__linear_kernel_hedgehog__mha_block__prompt_kernel_g_k0_keep
L_interleave_layers__linear_kernel_hedgehog__mha_block__prompt_kernel_g_k0_nokeep:
s_waitcnt lgkmcnt(6)
v_mfma_f32_32x32x16_bf16 v[84:99], v[168:171], v[148:151], v[84:99]
ds_read_b64_tr_b16 v[180:181], v211 offset:6144
ds_read_b64_tr_b16 v[182:183], v211 offset:7168
v_mfma_f32_32x32x16_bf16 v[100:115], v[168:171], v[152:155], v[100:115]
ds_read_b64_tr_b16 v[184:185], v211 offset:10240
ds_read_b64_tr_b16 v[186:187], v211 offset:11264
s_waitcnt lgkmcnt(8)
v_mfma_f32_32x32x16_bf16 v[116:131], v[148:151], v[172:175], v[116:131]
v_add_u32 v210, s65, v210
v_add_u32 v211, s65, v211
v_mfma_f32_32x32x16_bf16 v[132:147], v[152:155], v[172:175], v[132:147]
s_waitcnt lgkmcnt(5)
v_mfma_f32_32x32x16_bf16 v[52:67], v[176:179], v[156:159], v[52:67]
ds_read_b128 v[148:151], v210 offset:0
ds_read_b64_tr_b16 v[164:165], v211 offset:0
s_add_u32 s66, s66, 20480
s_cmp_eq_u32 s66, 143360
s_cselect_b32 s65, s67, 20480
s_cselect_b32 s66, 0, s66
s_waitcnt lgkmcnt(6)
v_mfma_f32_32x32x16_bf16 v[68:83], v[176:179], v[160:163], v[68:83]
ds_read_b64_tr_b16 v[166:167], v211 offset:1024
ds_read_b128 v[152:155], v210 offset:2048
s_waitcnt lgkmcnt(6)
v_mfma_f32_32x32x16_bf16 v[84:99], v[180:183], v[156:159], v[84:99]
ds_read_b64_tr_b16 v[168:169], v211 offset:4096
ds_read_b64_tr_b16 v[170:171], v211 offset:5120
s_cmp_eq_u32 s68, 0
s_cbranch_scc1 L_interleave_layers__linear_kernel_hedgehog__mha_block__prompt_kernel_g_t0
L_interleave_layers__linear_kernel_hedgehog__mha_block__prompt_kernel_g_t0_r:
v_mfma_f32_32x32x16_bf16 v[100:115], v[180:183], v[160:163], v[100:115]
ds_read_b64_tr_b16 v[172:173], v211 offset:8192
ds_read_b64_tr_b16 v[174:175], v211 offset:9216
s_waitcnt lgkmcnt(8)
v_mfma_f32_32x32x16_bf16 v[116:131], v[156:159], v[184:187], v[116:131]
v_mfma_f32_32x32x16_bf16 v[132:147], v[160:163], v[184:187], v[132:147]
s_waitcnt lgkmcnt(5)
v_mfma_f32_32x32x16_bf16 v[52:67], v[164:167], v[148:151], v[52:67]
ds_read_b128 v[156:159], v210 offset:1024
ds_read_b64_tr_b16 v[176:177], v211 offset:2048
s_waitcnt lgkmcnt(6)
v_mfma_f32_32x32x16_bf16 v[68:83], v[164:167], v[152:155], v[68:83]
ds_read_b64_tr_b16 v[178:179], v211 offset:3072
ds_read_b128 v[160:163], v210 offset:3072
s_waitcnt lgkmcnt(6)
v_mfma_f32_32x32x16_bf16 v[84:99], v[168:171], v[148:151], v[84:99]
ds_read_b64_tr_b16 v[180:181], v211 offset:6144
ds_read_b64_tr_b16 v[182:183], v211 offset:7168
v_mfma_f32_32x32x16_bf16 v[100:115], v[168:171], v[152:155], v[100:115]
ds_read_b64_tr_b16 v[184:185], v211 offset:10240
ds_read_b64_tr_b16 v[186:187], v211 offset:11264
s_waitcnt lgkmcnt(8)
v_mfma_f32_32x32x16_bf16 v[116:131], v[148:151], v[172:175], v[116:131]
v_mfma_f32_32x32x16_bf16 v[132:147], v[152:155], v[172:175], v[132:147]
s_waitcnt lgkmcnt(5)
v_mfma_f32_32x32x16_bf16 v[52:67], v[176:179], v[156:159], v[52:67]
s_waitcnt lgkmcnt(4)
v_mfma_f32_32x32x16_bf16 v[68:83], v[176:179], v[160:163], v[68:83]
s_waitcnt vmcnt(0) lgkmcnt(0)
s_barrier
v_add_u32 v210, s65, v210
v_add_u32 v211, s65, v211
v_mfma_f32_32x32x16_bf16 v[84:99], v[180:183], v[156:159], v[84:99]
ds_read_b128 v[148:151], v210 offset:0
ds_read_b64_tr_b16 v[164:165], v211 offset:0
v_mfma_f32_32x32x16_bf16 v[100:115], v[180:183], v[160:163], v[100:115]
ds_read_b64_tr_b16 v[166:167], v211 offset:1024
ds_read_b128 v[152:155], v210 offset:2048
v_mfma_f32_32x32x16_bf16 v[116:131], v[156:159], v[184:187], v[116:131]
ds_read_b64_tr_b16 v[168:169], v211 offset:4096
ds_read_b64_tr_b16 v[170:171], v211 offset:5120
v_mfma_f32_32x32x16_bf16 v[132:147], v[160:163], v[184:187], v[132:147]
ds_read_b64_tr_b16 v[172:173], v211 offset:8192
ds_read_b64_tr_b16 v[174:175], v211 offset:9216
s_waitcnt lgkmcnt(5)
v_mfma_f32_32x32x16_bf16 v[52:67], v[164:167], v[148:151], v[52:67]
ds_read_b128 v[156:159], v210 offset:1024
ds_read_b64_tr_b16 v[176:177], v211 offset:2048
s_add_u32 s66, s66, 20480
s_cmp_eq_u32 s66, 143360
s_cselect_b32 s65, s67, 20480
s_cselect_b32 s66, 0, s66
s_waitcnt lgkmcnt(6)
v_mfma_f32_32x32x16_bf16 v[68:83], v[164:167], v[152:155], v[68:83]
ds_read_b64_tr_b16 v[178:179], v211 offset:3072
ds_read_b128 v[160:163], v210 offset:3072
s_cmp_lg_u32 s69, 0
s_cbranch_scc1 L_interleave_layers__linear_kernel_hedgehog__mha_block__prompt_kernel_g_k1_keep
L_interleave_layers__linear_kernel_hedgehog__mha_block__prompt_kernel_g_k1_nokeep:
s_waitcnt lgkmcnt(6)
v_mfma_f32_32x32x16_bf16 v[84:99], v[168:171], v[148:151], v[84:99]
ds_read_b64_tr_b16 v[180:181], v211 offset:6144
ds_read_b64_tr_b16 v[182:183], v211 offset:7168
v_mfma_f32_32x32x16_bf16 v[100:115], v[168:171], v[152:155], v[100:115]
ds_read_b64_tr_b16 v[184:185], v211 offset:10240
ds_read_b64_tr_b16 v[186:187], v211 offset:11264
s_waitcnt lgkmcnt(8)
v_mfma_f32_32x32x16_bf16 v[116:131], v[148:151], v[172:175], v[116:131]
v_add_u32 v210, s65, v210
v_add_u32 v211, s65, v211
v_mfma_f32_32x32x16_bf16 v[132:147], v[152:155], v[172:175], v[132:147]
s_waitcnt lgkmcnt(5)
v_mfma_f32_32x32x16_bf16 v[52:67], v[176:179], v[156:159], v[52:67]
ds_read_b128 v[148:151], v210 offset:0
ds_read_b64_tr_b16 v[164:165], v211 offset:0
s_add_u32 s66, s66, 20480
s_cmp_eq_u32 s66, 143360
s_cselect_b32 s65, s67, 20480
s_cselect_b32 s66, 0, s66
s_waitcnt lgkmcnt(6)
v_mfma_f32_32x32x16_bf16 v[68:83], v[176:179], v[160:163], v[68:83]
ds_read_b64_tr_b16 v[166:167], v211 offset:1024
ds_read_b128 v[152:155], v210 offset:2048
s_waitcnt lgkmcnt(6)
v_mfma_f32_32x32x16_bf16 v[84:99], v[180:183], v[156:159], v[84:99]
ds_read_b64_tr_b16 v[168:169], v211 offset:4096
ds_read_b64_tr_b16 v[170:171], v211 offset:5120
s_cmp_eq_u32 s68, 1
s_cbranch_scc1 L_interleave_layers__linear_kernel_hedgehog__mha_block__prompt_kernel_g_t1
L_interleave_layers__linear_kernel_hedgehog__mha_block__prompt_kernel_g_t1_r:
v_mfma_f32_32x32x16_bf16 v[100:115], v[180:183], v[160:163], v[100:115]
ds_read_b64_tr_b16 v[172:173], v211 offset:8192
ds_read_b64_tr_b16 v[174:175], v211 offset:9216
s_waitcnt lgkmcnt(8)
v_mfma_f32_32x32x16_bf16 v[116:131], v[156:159], v[184:187], v[116:131]
v_mfma_f32_32x32x16_bf16 v[132:147], v[160:163], v[184:187], v[132:147]
s_waitcnt lgkmcnt(5)
v_mfma_f32_32x32x16_bf16 v[52:67], v[164:167], v[148:151], v[52:67]
ds_read_b128 v[156:159], v210 offset:1024
ds_read_b64_tr_b16 v[176:177], v211 offset:2048
s_waitcnt lgkmcnt(6)
v_mfma_f32_32x32x16_bf16 v[68:83], v[164:167], v[152:155], v[68:83]
ds_read_b64_tr_b16 v[178:179], v211 offset:3072
ds_read_b128 v[160:163], v210 offset:3072
s_waitcnt lgkmcnt(6)
v_mfma_f32_32x32x16_bf16 v[84:99], v[168:171], v[148:151], v[84:99]
ds_read_b64_tr_b16 v[180:181], v211 offset:6144
ds_read_b64_tr_b16 v[182:183], v211 offset:7168
v_mfma_f32_32x32x16_bf16 v[100:115], v[168:171], v[152:155], v[100:115]
ds_read_b64_tr_b16 v[184:185], v211 offset:10240
ds_read_b64_tr_b16 v[186:187], v211 offset:11264
s_waitcnt lgkmcnt(8)
v_mfma_f32_32x32x16_bf16 v[116:131], v[148:151], v[172:175], v[116:131]
v_mfma_f32_32x32x16_bf16 v[132:147], v[152:155], v[172:175], v[132:147]
s_waitcnt lgkmcnt(5)
v_mfma_f32_32x32x16_bf16 v[52:67], v[176:179], v[156:159], v[52:67]
s_waitcnt lgkmcnt(4)
v_mfma_f32_32x32x16_bf16 v[68:83], v[176:179], v[160:163], v[68:83]
s_waitcnt lgkmcnt(0)
s_barrier
v_add_u32 v210, s65, v210
v_add_u32 v211, s65, v211
v_mfma_f32_32x32x16_bf16 v[84:99], v[180:183], v[156:159], v[84:99]
ds_read_b128 v[148:151], v210 offset:0
ds_read_b64_tr_b16 v[164:165], v211 offset:0
v_mfma_f32_32x32x16_bf16 v[100:115], v[180:183], v[160:163], v[100:115]
ds_read_b64_tr_b16 v[166:167], v211 offset:1024
ds_read_b128 v[152:155], v210 offset:2048
v_mfma_f32_32x32x16_bf16 v[116:131], v[156:159], v[184:187], v[116:131]
ds_read_b64_tr_b16 v[168:169], v211 offset:4096
ds_read_b64_tr_b16 v[170:171], v211 offset:5120
v_mfma_f32_32x32x16_bf16 v[132:147], v[160:163], v[184:187], v[132:147]
ds_read_b64_tr_b16 v[172:173], v211 offset:8192
ds_read_b64_tr_b16 v[174:175], v211 offset:9216
s_waitcnt lgkmcnt(5)
v_mfma_f32_32x32x16_bf16 v[52:67], v[164:167], v[148:151], v[52:67]
ds_read_b128 v[156:159], v210 offset:1024
ds_read_b64_tr_b16 v[176:177], v211 offset:2048
s_add_u32 s66, s66, 20480
s_cmp_eq_u32 s66, 143360
s_cselect_b32 s65, s67, 20480
s_cselect_b32 s66, 0, s66
s_waitcnt lgkmcnt(6)
v_mfma_f32_32x32x16_bf16 v[68:83], v[164:167], v[152:155], v[68:83]
ds_read_b64_tr_b16 v[178:179], v211 offset:3072
ds_read_b128 v[160:163], v210 offset:3072
s_cmp_lg_u32 s69, 0
s_cbranch_scc1 L_interleave_layers__linear_kernel_hedgehog__mha_block__prompt_kernel_g_k2_keep
L_interleave_layers__linear_kernel_hedgehog__mha_block__prompt_kernel_g_k2_nokeep:
s_waitcnt lgkmcnt(6)
v_mfma_f32_32x32x16_bf16 v[84:99], v[168:171], v[148:151], v[84:99]
ds_read_b64_tr_b16 v[180:181], v211 offset:6144
ds_read_b64_tr_b16 v[182:183], v211 offset:7168
v_mfma_f32_32x32x16_bf16 v[100:115], v[168:171], v[152:155], v[100:115]
ds_read_b64_tr_b16 v[184:185], v211 offset:10240
ds_read_b64_tr_b16 v[186:187], v211 offset:11264
s_waitcnt lgkmcnt(8)
v_mfma_f32_32x32x16_bf16 v[116:131], v[148:151], v[172:175], v[116:131]
v_add_u32 v210, s65, v210
v_add_u32 v211, s65, v211
v_mfma_f32_32x32x16_bf16 v[132:147], v[152:155], v[172:175], v[132:147]
s_waitcnt lgkmcnt(5)
v_mfma_f32_32x32x16_bf16 v[52:67], v[176:179], v[156:159], v[52:67]
ds_read_b128 v[148:151], v210 offset:0
ds_read_b64_tr_b16 v[164:165], v211 offset:0
s_add_u32 s66, s66, 20480
s_cmp_eq_u32 s66, 143360
s_cselect_b32 s65, s67, 20480
s_cselect_b32 s66, 0, s66
s_waitcnt lgkmcnt(6)
v_mfma_f32_32x32x16_bf16 v[68:83], v[176:179], v[160:163], v[68:83]
ds_read_b64_tr_b16 v[166:167], v211 offset:1024
ds_read_b128 v[152:155], v210 offset:2048
s_waitcnt lgkmcnt(6)
v_mfma_f32_32x32x16_bf16 v[84:99], v[180:183], v[156:159], v[84:99]
ds_read_b64_tr_b16 v[168:169], v211 offset:4096
ds_read_b64_tr_b16 v[170:171], v211 offset:5120
s_cmp_eq_u32 s68, 2
s_cbranch_scc1 L_interleave_layers__linear_kernel_hedgehog__mha_block__prompt_kernel_g_t2
L_interleave_layers__linear_kernel_hedgehog__mha_block__prompt_kernel_g_t2_r:
v_mfma_f32_32x32x16_bf16 v[100:115], v[180:183], v[160:163], v[100:115]
ds_read_b64_tr_b16 v[172:173], v211 offset:8192
ds_read_b64_tr_b16 v[174:175], v211 offset:9216
s_waitcnt lgkmcnt(8)
v_mfma_f32_32x32x16_bf16 v[116:131], v[156:159], v[184:187], v[116:131]
v_mfma_f32_32x32x16_bf16 v[132:147], v[160:163], v[184:187], v[132:147]
s_waitcnt lgkmcnt(5)
v_mfma_f32_32x32x16_bf16 v[52:67], v[164:167], v[148:151], v[52:67]
ds_read_b128 v[156:159], v210 offset:1024
ds_read_b64_tr_b16 v[176:177], v211 offset:2048
s_waitcnt lgkmcnt(6)
v_mfma_f32_32x32x16_bf16 v[68:83], v[164:167], v[152:155], v[68:83]
ds_read_b64_tr_b16 v[178:179], v211 offset:3072
ds_read_b128 v[160:163], v210 offset:3072
s_waitcnt lgkmcnt(6)
v_mfma_f32_32x32x16_bf16 v[84:99], v[168:171], v[148:151], v[84:99]
ds_read_b64_tr_b16 v[180:181], v211 offset:6144
ds_read_b64_tr_b16 v[182:183], v211 offset:7168
v_mfma_f32_32x32x16_bf16 v[100:115], v[168:171], v[152:155], v[100:115]
ds_read_b64_tr_b16 v[184:185], v211 offset:10240
ds_read_b64_tr_b16 v[186:187], v211 offset:11264
s_waitcnt lgkmcnt(8)
v_mfma_f32_32x32x16_bf16 v[116:131], v[148:151], v[172:175], v[116:131]
v_mfma_f32_32x32x16_bf16 v[132:147], v[152:155], v[172:175], v[132:147]
s_waitcnt lgkmcnt(5)
v_mfma_f32_32x32x16_bf16 v[52:67], v[176:179], v[156:159], v[52:67]
s_waitcnt lgkmcnt(4)
v_mfma_f32_32x32x16_bf16 v[68:83], v[176:179], v[160:163], v[68:83]
s_waitcnt lgkmcnt(0)
s_barrier
v_add_u32 v210, s65, v210
v_add_u32 v211, s65, v211
v_mfma_f32_32x32x16_bf16 v[84:99], v[180:183], v[156:159], v[84:99]
ds_read_b128 v[148:151], v210 offset:0
ds_read_b64_tr_b16 v[164:165], v211 offset:0
v_mfma_f32_32x32x16_bf16 v[100:115], v[180:183], v[160:163], v[100:115]
ds_read_b64_tr_b16 v[166:167], v211 offset:1024
ds_read_b128 v[152:155], v210 offset:2048
v_mfma_f32_32x32x16_bf16 v[116:131], v[156:159], v[184:187], v[116:131]
ds_read_b64_tr_b16 v[168:169], v211 offset:4096
ds_read_b64_tr_b16 v[170:171], v211 offset:5120
v_mfma_f32_32x32x16_bf16 v[132:147], v[160:163], v[184:187], v[132:147]
ds_read_b64_tr_b16 v[172:173], v211 offset:8192
ds_read_b64_tr_b16 v[174:175], v211 offset:9216
s_waitcnt lgkmcnt(5)
v_mfma_f32_32x32x16_bf16 v[52:67], v[164:167], v[148:151], v[52:67]
ds_read_b128 v[156:159], v210 offset:1024
ds_read_b64_tr_b16 v[176:177], v211 offset:2048
s_add_u32 s66, s66, 20480
s_cmp_eq_u32 s66, 143360
s_cselect_b32 s65, s67, 20480
s_cselect_b32 s66, 0, s66
s_waitcnt lgkmcnt(6)
v_mfma_f32_32x32x16_bf16 v[68:83], v[164:167], v[152:155], v[68:83]
ds_read_b64_tr_b16 v[178:179], v211 offset:3072
ds_read_b128 v[160:163], v210 offset:3072
s_cmp_lg_u32 s69, 0
s_cbranch_scc1 L_interleave_layers__linear_kernel_hedgehog__mha_block__prompt_kernel_g_k3_keep
L_interleave_layers__linear_kernel_hedgehog__mha_block__prompt_kernel_g_k3_nokeep:
s_waitcnt lgkmcnt(6)
v_mfma_f32_32x32x16_bf16 v[84:99], v[168:171], v[148:151], v[84:99]
ds_read_b64_tr_b16 v[180:181], v211 offset:6144
ds_read_b64_tr_b16 v[182:183], v211 offset:7168
v_mfma_f32_32x32x16_bf16 v[100:115], v[168:171], v[152:155], v[100:115]
ds_read_b64_tr_b16 v[184:185], v211 offset:10240
ds_read_b64_tr_b16 v[186:187], v211 offset:11264
s_waitcnt lgkmcnt(8)
v_mfma_f32_32x32x16_bf16 v[116:131], v[148:151], v[172:175], v[116:131]
v_add_u32 v210, s65, v210
v_add_u32 v211, s65, v211
v_mfma_f32_32x32x16_bf16 v[132:147], v[152:155], v[172:175], v[132:147]
s_waitcnt lgkmcnt(5)
v_mfma_f32_32x32x16_bf16 v[52:67], v[176:179], v[156:159], v[52:67]
ds_read_b128 v[148:151], v210 offset:0
ds_read_b64_tr_b16 v[164:165], v211 offset:0
s_add_u32 s66, s66, 20480
s_cmp_eq_u32 s66, 143360
s_cselect_b32 s65, s67, 20480
s_cselect_b32 s66, 0, s66
s_waitcnt lgkmcnt(6)
v_mfma_f32_32x32x16_bf16 v[68:83], v[176:179], v[160:163], v[68:83]
ds_read_b64_tr_b16 v[166:167], v211 offset:1024
ds_read_b128 v[152:155], v210 offset:2048
s_waitcnt lgkmcnt(6)
v_mfma_f32_32x32x16_bf16 v[84:99], v[180:183], v[156:159], v[84:99]
ds_read_b64_tr_b16 v[168:169], v211 offset:4096
ds_read_b64_tr_b16 v[170:171], v211 offset:5120
s_cmp_eq_u32 s68, 3
s_cbranch_scc1 L_interleave_layers__linear_kernel_hedgehog__mha_block__prompt_kernel_g_t3
L_interleave_layers__linear_kernel_hedgehog__mha_block__prompt_kernel_g_t3_r:
v_mfma_f32_32x32x16_bf16 v[100:115], v[180:183], v[160:163], v[100:115]
ds_read_b64_tr_b16 v[172:173], v211 offset:8192
ds_read_b64_tr_b16 v[174:175], v211 offset:9216
s_waitcnt lgkmcnt(8)
v_mfma_f32_32x32x16_bf16 v[116:131], v[156:159], v[184:187], v[116:131]
v_mfma_f32_32x32x16_bf16 v[132:147], v[160:163], v[184:187], v[132:147]
s_waitcnt lgkmcnt(5)
v_mfma_f32_32x32x16_bf16 v[52:67], v[164:167], v[148:151], v[52:67]
ds_read_b128 v[156:159], v210 offset:1024
ds_read_b64_tr_b16 v[176:177], v211 offset:2048
s_waitcnt lgkmcnt(6)
v_mfma_f32_32x32x16_bf16 v[68:83], v[164:167], v[152:155], v[68:83]
ds_read_b64_tr_b16 v[178:179], v211 offset:3072
ds_read_b128 v[160:163], v210 offset:3072
s_waitcnt lgkmcnt(6)
v_mfma_f32_32x32x16_bf16 v[84:99], v[168:171], v[148:151], v[84:99]
ds_read_b64_tr_b16 v[180:181], v211 offset:6144
ds_read_b64_tr_b16 v[182:183], v211 offset:7168
v_mfma_f32_32x32x16_bf16 v[100:115], v[168:171], v[152:155], v[100:115]
ds_read_b64_tr_b16 v[184:185], v211 offset:10240
ds_read_b64_tr_b16 v[186:187], v211 offset:11264
s_waitcnt lgkmcnt(8)
v_mfma_f32_32x32x16_bf16 v[116:131], v[148:151], v[172:175], v[116:131]
v_mfma_f32_32x32x16_bf16 v[132:147], v[152:155], v[172:175], v[132:147]
s_waitcnt lgkmcnt(5)
v_mfma_f32_32x32x16_bf16 v[52:67], v[176:179], v[156:159], v[52:67]
s_waitcnt lgkmcnt(4)
v_mfma_f32_32x32x16_bf16 v[68:83], v[176:179], v[160:163], v[68:83]
s_waitcnt lgkmcnt(0)
s_barrier
v_add_u32 v210, s65, v210
v_add_u32 v211, s65, v211
v_mfma_f32_32x32x16_bf16 v[84:99], v[180:183], v[156:159], v[84:99]
ds_read_b128 v[148:151], v210 offset:0
ds_read_b64_tr_b16 v[164:165], v211 offset:0
v_mfma_f32_32x32x16_bf16 v[100:115], v[180:183], v[160:163], v[100:115]
ds_read_b64_tr_b16 v[166:167], v211 offset:1024
ds_read_b128 v[152:155], v210 offset:2048
v_mfma_f32_32x32x16_bf16 v[116:131], v[156:159], v[184:187], v[116:131]
ds_read_b64_tr_b16 v[168:169], v211 offset:4096
ds_read_b64_tr_b16 v[170:171], v211 offset:5120
v_mfma_f32_32x32x16_bf16 v[132:147], v[160:163], v[184:187], v[132:147]
ds_read_b64_tr_b16 v[172:173], v211 offset:8192
ds_read_b64_tr_b16 v[174:175], v211 offset:9216
s_waitcnt lgkmcnt(5)
v_mfma_f32_32x32x16_bf16 v[52:67], v[164:167], v[148:151], v[52:67]
ds_read_b128 v[156:159], v210 offset:1024
ds_read_b64_tr_b16 v[176:177], v211 offset:2048
s_add_u32 s66, s66, 20480
s_cmp_eq_u32 s66, 143360
s_cselect_b32 s65, s67, 20480
s_cselect_b32 s66, 0, s66
s_waitcnt lgkmcnt(6)
v_mfma_f32_32x32x16_bf16 v[68:83], v[164:167], v[152:155], v[68:83]
ds_read_b64_tr_b16 v[178:179], v211 offset:3072
ds_read_b128 v[160:163], v210 offset:3072
s_cmp_lg_u32 s69, 0
s_cbranch_scc1 L_interleave_layers__linear_kernel_hedgehog__mha_block__prompt_kernel_g_k4_keep
L_interleave_layers__linear_kernel_hedgehog__mha_block__prompt_kernel_g_k4_nokeep:
s_waitcnt lgkmcnt(6)
v_mfma_f32_32x32x16_bf16 v[84:99], v[168:171], v[148:151], v[84:99]
ds_read_b64_tr_b16 v[180:181], v211 offset:6144
ds_read_b64_tr_b16 v[182:183], v211 offset:7168
v_mfma_f32_32x32x16_bf16 v[100:115], v[168:171], v[152:155], v[100:115]
ds_read_b64_tr_b16 v[184:185], v211 offset:10240
ds_read_b64_tr_b16 v[186:187], v211 offset:11264
s_waitcnt lgkmcnt(8)
v_mfma_f32_32x32x16_bf16 v[116:131], v[148:151], v[172:175], v[116:131]
v_add_u32 v210, s65, v210
v_add_u32 v211, s65, v211
v_mfma_f32_32x32x16_bf16 v[132:147], v[152:155], v[172:175], v[132:147]
s_waitcnt lgkmcnt(5)
v_mfma_f32_32x32x16_bf16 v[52:67], v[176:179], v[156:159], v[52:67]
ds_read_b128 v[148:151], v210 offset:0
ds_read_b64_tr_b16 v[164:165], v211 offset:0
s_add_u32 s66, s66, 20480
s_cmp_eq_u32 s66, 143360
s_cselect_b32 s65, s67, 20480
s_cselect_b32 s66, 0, s66
s_waitcnt lgkmcnt(6)
v_mfma_f32_32x32x16_bf16 v[68:83], v[176:179], v[160:163], v[68:83]
ds_read_b64_tr_b16 v[166:167], v211 offset:1024
ds_read_b128 v[152:155], v210 offset:2048
s_waitcnt lgkmcnt(6)
v_mfma_f32_32x32x16_bf16 v[84:99], v[180:183], v[156:159], v[84:99]
ds_read_b64_tr_b16 v[168:169], v211 offset:4096
ds_read_b64_tr_b16 v[170:171], v211 offset:5120
s_cmp_eq_u32 s68, 4
s_cbranch_scc1 L_interleave_layers__linear_kernel_hedgehog__mha_block__prompt_kernel_g_t4
L_interleave_layers__linear_kernel_hedgehog__mha_block__prompt_kernel_g_t4_r:
v_mfma_f32_32x32x16_bf16 v[100:115], v[180:183], v[160:163], v[100:115]
ds_read_b64_tr_b16 v[172:173], v211 offset:8192
ds_read_b64_tr_b16 v[174:175], v211 offset:9216
s_waitcnt lgkmcnt(8)
v_mfma_f32_32x32x16_bf16 v[116:131], v[156:159], v[184:187], v[116:131]
v_mfma_f32_32x32x16_bf16 v[132:147], v[160:163], v[184:187], v[132:147]
s_waitcnt lgkmcnt(5)
v_mfma_f32_32x32x16_bf16 v[52:67], v[164:167], v[148:151], v[52:67]
ds_read_b128 v[156:159], v210 offset:1024
ds_read_b64_tr_b16 v[176:177], v211 offset:2048
s_waitcnt lgkmcnt(6)
v_mfma_f32_32x32x16_bf16 v[68:83], v[164:167], v[152:155], v[68:83]
ds_read_b64_tr_b16 v[178:179], v211 offset:3072
ds_read_b128 v[160:163], v210 offset:3072
s_waitcnt lgkmcnt(6)
v_mfma_f32_32x32x16_bf16 v[84:99], v[168:171], v[148:151], v[84:99]
ds_read_b64_tr_b16 v[180:181], v211 offset:6144
ds_read_b64_tr_b16 v[182:183], v211 offset:7168
v_mfma_f32_32x32x16_bf16 v[100:115], v[168:171], v[152:155], v[100:115]
ds_read_b64_tr_b16 v[184:185], v211 offset:10240
ds_read_b64_tr_b16 v[186:187], v211 offset:11264
s_waitcnt lgkmcnt(8)
v_mfma_f32_32x32x16_bf16 v[116:131], v[148:151], v[172:175], v[116:131]
v_mfma_f32_32x32x16_bf16 v[132:147], v[152:155], v[172:175], v[132:147]
s_waitcnt lgkmcnt(5)
v_mfma_f32_32x32x16_bf16 v[52:67], v[176:179], v[156:159], v[52:67]
s_waitcnt lgkmcnt(4)
v_mfma_f32_32x32x16_bf16 v[68:83], v[176:179], v[160:163], v[68:83]
s_waitcnt lgkmcnt(0)
s_barrier
v_add_u32 v210, s65, v210
v_add_u32 v211, s65, v211
v_mfma_f32_32x32x16_bf16 v[84:99], v[180:183], v[156:159], v[84:99]
ds_read_b128 v[148:151], v210 offset:0
ds_read_b64_tr_b16 v[164:165], v211 offset:0
v_mfma_f32_32x32x16_bf16 v[100:115], v[180:183], v[160:163], v[100:115]
ds_read_b64_tr_b16 v[166:167], v211 offset:1024
ds_read_b128 v[152:155], v210 offset:2048
v_mfma_f32_32x32x16_bf16 v[116:131], v[156:159], v[184:187], v[116:131]
ds_read_b64_tr_b16 v[168:169], v211 offset:4096
ds_read_b64_tr_b16 v[170:171], v211 offset:5120
v_mfma_f32_32x32x16_bf16 v[132:147], v[160:163], v[184:187], v[132:147]
ds_read_b64_tr_b16 v[172:173], v211 offset:8192
ds_read_b64_tr_b16 v[174:175], v211 offset:9216
s_waitcnt lgkmcnt(5)
v_mfma_f32_32x32x16_bf16 v[52:67], v[164:167], v[148:151], v[52:67]
ds_read_b128 v[156:159], v210 offset:1024
ds_read_b64_tr_b16 v[176:177], v211 offset:2048
s_add_u32 s66, s66, 20480
s_cmp_eq_u32 s66, 143360
s_cselect_b32 s65, s67, 20480
s_cselect_b32 s66, 0, s66
s_waitcnt lgkmcnt(6)
v_mfma_f32_32x32x16_bf16 v[68:83], v[164:167], v[152:155], v[68:83]
ds_read_b64_tr_b16 v[178:179], v211 offset:3072
ds_read_b128 v[160:163], v210 offset:3072
s_cmp_lg_u32 s69, 0
s_cbranch_scc1 L_interleave_layers__linear_kernel_hedgehog__mha_block__prompt_kernel_g_k5_keep
L_interleave_layers__linear_kernel_hedgehog__mha_block__prompt_kernel_g_k5_nokeep:
s_waitcnt lgkmcnt(6)
v_mfma_f32_32x32x16_bf16 v[84:99], v[168:171], v[148:151], v[84:99]
ds_read_b64_tr_b16 v[180:181], v211 offset:6144
ds_read_b64_tr_b16 v[182:183], v211 offset:7168
v_mfma_f32_32x32x16_bf16 v[100:115], v[168:171], v[152:155], v[100:115]
ds_read_b64_tr_b16 v[184:185], v211 offset:10240
ds_read_b64_tr_b16 v[186:187], v211 offset:11264
s_waitcnt lgkmcnt(8)
v_mfma_f32_32x32x16_bf16 v[116:131], v[148:151], v[172:175], v[116:131]
v_add_u32 v210, s65, v210
v_add_u32 v211, s65, v211
v_mfma_f32_32x32x16_bf16 v[132:147], v[152:155], v[172:175], v[132:147]
s_waitcnt lgkmcnt(5)
v_mfma_f32_32x32x16_bf16 v[52:67], v[176:179], v[156:159], v[52:67]
ds_read_b128 v[148:151], v210 offset:0
ds_read_b64_tr_b16 v[164:165], v211 offset:0
s_add_u32 s66, s66, 20480
s_cmp_eq_u32 s66, 143360
s_cselect_b32 s65, s67, 20480
s_cselect_b32 s66, 0, s66
s_waitcnt lgkmcnt(6)
v_mfma_f32_32x32x16_bf16 v[68:83], v[176:179], v[160:163], v[68:83]
ds_read_b64_tr_b16 v[166:167], v211 offset:1024
ds_read_b128 v[152:155], v210 offset:2048
s_waitcnt lgkmcnt(6)
v_mfma_f32_32x32x16_bf16 v[84:99], v[180:183], v[156:159], v[84:99]
ds_read_b64_tr_b16 v[168:169], v211 offset:4096
ds_read_b64_tr_b16 v[170:171], v211 offset:5120
s_cmp_eq_u32 s68, 5
s_cbranch_scc1 L_interleave_layers__linear_kernel_hedgehog__mha_block__prompt_kernel_g_t5
L_interleave_layers__linear_kernel_hedgehog__mha_block__prompt_kernel_g_t5_r:
v_mfma_f32_32x32x16_bf16 v[100:115], v[180:183], v[160:163], v[100:115]
ds_read_b64_tr_b16 v[172:173], v211 offset:8192
ds_read_b64_tr_b16 v[174:175], v211 offset:9216
s_waitcnt lgkmcnt(8)
v_mfma_f32_32x32x16_bf16 v[116:131], v[156:159], v[184:187], v[116:131]
v_mfma_f32_32x32x16_bf16 v[132:147], v[160:163], v[184:187], v[132:147]
s_waitcnt lgkmcnt(5)
v_mfma_f32_32x32x16_bf16 v[52:67], v[164:167], v[148:151], v[52:67]
ds_read_b128 v[156:159], v210 offset:1024
ds_read_b64_tr_b16 v[176:177], v211 offset:2048
s_waitcnt lgkmcnt(6)
v_mfma_f32_32x32x16_bf16 v[68:83], v[164:167], v[152:155], v[68:83]
ds_read_b64_tr_b16 v[178:179], v211 offset:3072
ds_read_b128 v[160:163], v210 offset:3072
s_waitcnt lgkmcnt(6)
v_mfma_f32_32x32x16_bf16 v[84:99], v[168:171], v[148:151], v[84:99]
ds_read_b64_tr_b16 v[180:181], v211 offset:6144
ds_read_b64_tr_b16 v[182:183], v211 offset:7168
v_mfma_f32_32x32x16_bf16 v[100:115], v[168:171], v[152:155], v[100:115]
ds_read_b64_tr_b16 v[184:185], v211 offset:10240
ds_read_b64_tr_b16 v[186:187], v211 offset:11264
s_waitcnt lgkmcnt(8)
v_mfma_f32_32x32x16_bf16 v[116:131], v[148:151], v[172:175], v[116:131]
v_mfma_f32_32x32x16_bf16 v[132:147], v[152:155], v[172:175], v[132:147]
s_waitcnt lgkmcnt(5)
v_mfma_f32_32x32x16_bf16 v[52:67], v[176:179], v[156:159], v[52:67]
s_waitcnt lgkmcnt(4)
v_mfma_f32_32x32x16_bf16 v[68:83], v[176:179], v[160:163], v[68:83]
s_waitcnt lgkmcnt(0)
s_barrier
v_add_u32 v210, s65, v210
v_add_u32 v211, s65, v211
v_mfma_f32_32x32x16_bf16 v[84:99], v[180:183], v[156:159], v[84:99]
ds_read_b128 v[148:151], v210 offset:0
ds_read_b64_tr_b16 v[164:165], v211 offset:0
v_mfma_f32_32x32x16_bf16 v[100:115], v[180:183], v[160:163], v[100:115]
ds_read_b64_tr_b16 v[166:167], v211 offset:1024
ds_read_b128 v[152:155], v210 offset:2048
v_mfma_f32_32x32x16_bf16 v[116:131], v[156:159], v[184:187], v[116:131]
ds_read_b64_tr_b16 v[168:169], v211 offset:4096
ds_read_b64_tr_b16 v[170:171], v211 offset:5120
v_mfma_f32_32x32x16_bf16 v[132:147], v[160:163], v[184:187], v[132:147]
ds_read_b64_tr_b16 v[172:173], v211 offset:8192
ds_read_b64_tr_b16 v[174:175], v211 offset:9216
s_waitcnt lgkmcnt(5)
v_mfma_f32_32x32x16_bf16 v[52:67], v[164:167], v[148:151], v[52:67]
ds_read_b128 v[156:159], v210 offset:1024
ds_read_b64_tr_b16 v[176:177], v211 offset:2048
s_add_u32 s66, s66, 20480
s_cmp_eq_u32 s66, 143360
s_cselect_b32 s65, s67, 20480
s_cselect_b32 s66, 0, s66
s_waitcnt lgkmcnt(6)
v_mfma_f32_32x32x16_bf16 v[68:83], v[164:167], v[152:155], v[68:83]
ds_read_b64_tr_b16 v[178:179], v211 offset:3072
ds_read_b128 v[160:163], v210 offset:3072
s_cmp_lg_u32 s69, 0
s_cbranch_scc1 L_interleave_layers__linear_kernel_hedgehog__mha_block__prompt_kernel_g_k6_keep
L_interleave_layers__linear_kernel_hedgehog__mha_block__prompt_kernel_g_k6_nokeep:
s_waitcnt lgkmcnt(6)
v_mfma_f32_32x32x16_bf16 v[84:99], v[168:171], v[148:151], v[84:99]
ds_read_b64_tr_b16 v[180:181], v211 offset:6144
ds_read_b64_tr_b16 v[182:183], v211 offset:7168
v_mfma_f32_32x32x16_bf16 v[100:115], v[168:171], v[152:155], v[100:115]
ds_read_b64_tr_b16 v[184:185], v211 offset:10240
ds_read_b64_tr_b16 v[186:187], v211 offset:11264
s_waitcnt lgkmcnt(8)
v_mfma_f32_32x32x16_bf16 v[116:131], v[148:151], v[172:175], v[116:131]
v_add_u32 v210, s65, v210
v_add_u32 v211, s65, v211
v_mfma_f32_32x32x16_bf16 v[132:147], v[152:155], v[172:175], v[132:147]
s_waitcnt lgkmcnt(5)
v_mfma_f32_32x32x16_bf16 v[52:67], v[176:179], v[156:159], v[52:67]
ds_read_b128 v[148:151], v210 offset:0
ds_read_b64_tr_b16 v[164:165], v211 offset:0
s_add_u32 s66, s66, 20480
s_cmp_eq_u32 s66, 143360
s_cselect_b32 s65, s67, 20480
s_cselect_b32 s66, 0, s66
s_waitcnt lgkmcnt(6)
v_mfma_f32_32x32x16_bf16 v[68:83], v[176:179], v[160:163], v[68:83]
ds_read_b64_tr_b16 v[166:167], v211 offset:1024
ds_read_b128 v[152:155], v210 offset:2048
s_waitcnt lgkmcnt(6)
v_mfma_f32_32x32x16_bf16 v[84:99], v[180:183], v[156:159], v[84:99]
ds_read_b64_tr_b16 v[168:169], v211 offset:4096
ds_read_b64_tr_b16 v[170:171], v211 offset:5120
s_cmp_eq_u32 s68, 6
s_cbranch_scc1 L_interleave_layers__linear_kernel_hedgehog__mha_block__prompt_kernel_g_t6
L_interleave_layers__linear_kernel_hedgehog__mha_block__prompt_kernel_g_t6_r:
v_mfma_f32_32x32x16_bf16 v[100:115], v[180:183], v[160:163], v[100:115]
ds_read_b64_tr_b16 v[172:173], v211 offset:8192
ds_read_b64_tr_b16 v[174:175], v211 offset:9216
s_waitcnt lgkmcnt(8)
v_mfma_f32_32x32x16_bf16 v[116:131], v[156:159], v[184:187], v[116:131]
v_mfma_f32_32x32x16_bf16 v[132:147], v[160:163], v[184:187], v[132:147]
s_waitcnt lgkmcnt(5)
v_mfma_f32_32x32x16_bf16 v[52:67], v[164:167], v[148:151], v[52:67]
ds_read_b128 v[156:159], v210 offset:1024
ds_read_b64_tr_b16 v[176:177], v211 offset:2048
s_waitcnt lgkmcnt(6)
v_mfma_f32_32x32x16_bf16 v[68:83], v[164:167], v[152:155], v[68:83]
ds_read_b64_tr_b16 v[178:179], v211 offset:3072
ds_read_b128 v[160:163], v210 offset:3072
s_waitcnt lgkmcnt(6)
v_mfma_f32_32x32x16_bf16 v[84:99], v[168:171], v[148:151], v[84:99]
ds_read_b64_tr_b16 v[180:181], v211 offset:6144
ds_read_b64_tr_b16 v[182:183], v211 offset:7168
v_mfma_f32_32x32x16_bf16 v[100:115], v[168:171], v[152:155], v[100:115]
ds_read_b64_tr_b16 v[184:185], v211 offset:10240
ds_read_b64_tr_b16 v[186:187], v211 offset:11264
s_waitcnt lgkmcnt(8)
v_mfma_f32_32x32x16_bf16 v[116:131], v[148:151], v[172:175], v[116:131]
v_mfma_f32_32x32x16_bf16 v[132:147], v[152:155], v[172:175], v[132:147]
s_waitcnt lgkmcnt(5)
v_mfma_f32_32x32x16_bf16 v[52:67], v[176:179], v[156:159], v[52:67]
s_waitcnt lgkmcnt(4)
v_mfma_f32_32x32x16_bf16 v[68:83], v[176:179], v[160:163], v[68:83]
s_waitcnt lgkmcnt(0)
s_barrier
v_add_u32 v210, s65, v210
v_add_u32 v211, s65, v211
v_mfma_f32_32x32x16_bf16 v[84:99], v[180:183], v[156:159], v[84:99]
ds_read_b128 v[148:151], v210 offset:0
ds_read_b64_tr_b16 v[164:165], v211 offset:0
v_mfma_f32_32x32x16_bf16 v[100:115], v[180:183], v[160:163], v[100:115]
ds_read_b64_tr_b16 v[166:167], v211 offset:1024
ds_read_b128 v[152:155], v210 offset:2048
v_mfma_f32_32x32x16_bf16 v[116:131], v[156:159], v[184:187], v[116:131]
ds_read_b64_tr_b16 v[168:169], v211 offset:4096
ds_read_b64_tr_b16 v[170:171], v211 offset:5120
v_mfma_f32_32x32x16_bf16 v[132:147], v[160:163], v[184:187], v[132:147]
ds_read_b64_tr_b16 v[172:173], v211 offset:8192
ds_read_b64_tr_b16 v[174:175], v211 offset:9216
s_waitcnt lgkmcnt(5)
v_mfma_f32_32x32x16_bf16 v[52:67], v[164:167], v[148:151], v[52:67]
ds_read_b128 v[156:159], v210 offset:1024
ds_read_b64_tr_b16 v[176:177], v211 offset:2048
s_add_u32 s66, s66, 20480
s_cmp_eq_u32 s66, 143360
s_cselect_b32 s65, s67, 20480
s_cselect_b32 s66, 0, s66
s_waitcnt lgkmcnt(6)
v_mfma_f32_32x32x16_bf16 v[68:83], v[164:167], v[152:155], v[68:83]
ds_read_b64_tr_b16 v[178:179], v211 offset:3072
ds_read_b128 v[160:163], v210 offset:3072
s_cmp_lg_u32 s69, 0
s_cbranch_scc1 L_interleave_layers__linear_kernel_hedgehog__mha_block__prompt_kernel_g_k7_keep
L_interleave_layers__linear_kernel_hedgehog__mha_block__prompt_kernel_g_k7_nokeep:
s_waitcnt lgkmcnt(6)
v_mfma_f32_32x32x16_bf16 v[84:99], v[168:171], v[148:151], v[84:99]
ds_read_b64_tr_b16 v[180:181], v211 offset:6144
ds_read_b64_tr_b16 v[182:183], v211 offset:7168
v_mfma_f32_32x32x16_bf16 v[100:115], v[168:171], v[152:155], v[100:115]
ds_read_b64_tr_b16 v[184:185], v211 offset:10240
ds_read_b64_tr_b16 v[186:187], v211 offset:11264
s_waitcnt lgkmcnt(8)
v_mfma_f32_32x32x16_bf16 v[116:131], v[148:151], v[172:175], v[116:131]
v_add_u32 v210, s65, v210
v_add_u32 v211, s65, v211
v_mfma_f32_32x32x16_bf16 v[132:147], v[152:155], v[172:175], v[132:147]
s_waitcnt lgkmcnt(5)
v_mfma_f32_32x32x16_bf16 v[52:67], v[176:179], v[156:159], v[52:67]
ds_read_b128 v[148:151], v210 offset:0
ds_read_b64_tr_b16 v[164:165], v211 offset:0
s_add_u32 s66, s66, 20480
s_cmp_eq_u32 s66, 143360
s_cselect_b32 s65, s67, 20480
s_cselect_b32 s66, 0, s66
s_waitcnt lgkmcnt(6)
v_mfma_f32_32x32x16_bf16 v[68:83], v[176:179], v[160:163], v[68:83]
ds_read_b64_tr_b16 v[166:167], v211 offset:1024
ds_read_b128 v[152:155], v210 offset:2048
s_waitcnt lgkmcnt(6)
v_mfma_f32_32x32x16_bf16 v[84:99], v[180:183], v[156:159], v[84:99]
ds_read_b64_tr_b16 v[168:169], v211 offset:4096
ds_read_b64_tr_b16 v[170:171], v211 offset:5120
s_cmp_eq_u32 s68, 7
s_cbranch_scc1 L_interleave_layers__linear_kernel_hedgehog__mha_block__prompt_kernel_g_t7
L_interleave_layers__linear_kernel_hedgehog__mha_block__prompt_kernel_g_t7_r:
v_mfma_f32_32x32x16_bf16 v[100:115], v[180:183], v[160:163], v[100:115]
ds_read_b64_tr_b16 v[172:173], v211 offset:8192
ds_read_b64_tr_b16 v[174:175], v211 offset:9216
s_waitcnt lgkmcnt(8)
v_mfma_f32_32x32x16_bf16 v[116:131], v[156:159], v[184:187], v[116:131]
v_mfma_f32_32x32x16_bf16 v[132:147], v[160:163], v[184:187], v[132:147]
s_waitcnt lgkmcnt(5)
v_mfma_f32_32x32x16_bf16 v[52:67], v[164:167], v[148:151], v[52:67]
ds_read_b128 v[156:159], v210 offset:1024
ds_read_b64_tr_b16 v[176:177], v211 offset:2048
s_waitcnt lgkmcnt(6)
v_mfma_f32_32x32x16_bf16 v[68:83], v[164:167], v[152:155], v[68:83]
ds_read_b64_tr_b16 v[178:179], v211 offset:3072
ds_read_b128 v[160:163], v210 offset:3072
s_waitcnt lgkmcnt(6)
v_mfma_f32_32x32x16_bf16 v[84:99], v[168:171], v[148:151], v[84:99]
ds_read_b64_tr_b16 v[180:181], v211 offset:6144
ds_read_b64_tr_b16 v[182:183], v211 offset:7168
v_mfma_f32_32x32x16_bf16 v[100:115], v[168:171], v[152:155], v[100:115]
ds_read_b64_tr_b16 v[184:185], v211 offset:10240
ds_read_b64_tr_b16 v[186:187], v211 offset:11264
s_waitcnt lgkmcnt(8)
v_mfma_f32_32x32x16_bf16 v[116:131], v[148:151], v[172:175], v[116:131]
v_mfma_f32_32x32x16_bf16 v[132:147], v[152:155], v[172:175], v[132:147]
s_waitcnt lgkmcnt(5)
v_mfma_f32_32x32x16_bf16 v[52:67], v[176:179], v[156:159], v[52:67]
s_waitcnt lgkmcnt(4)
v_mfma_f32_32x32x16_bf16 v[68:83], v[176:179], v[160:163], v[68:83]
s_waitcnt lgkmcnt(0)
s_barrier
v_add_u32 v210, s65, v210
v_add_u32 v211, s65, v211
v_mfma_f32_32x32x16_bf16 v[84:99], v[180:183], v[156:159], v[84:99]
ds_read_b128 v[148:151], v210 offset:0
ds_read_b64_tr_b16 v[164:165], v211 offset:0
v_mfma_f32_32x32x16_bf16 v[100:115], v[180:183], v[160:163], v[100:115]
ds_read_b64_tr_b16 v[166:167], v211 offset:1024
ds_read_b128 v[152:155], v210 offset:2048
v_mfma_f32_32x32x16_bf16 v[116:131], v[156:159], v[184:187], v[116:131]
ds_read_b64_tr_b16 v[168:169], v211 offset:4096
ds_read_b64_tr_b16 v[170:171], v211 offset:5120
v_mfma_f32_32x32x16_bf16 v[132:147], v[160:163], v[184:187], v[132:147]
ds_read_b64_tr_b16 v[172:173], v211 offset:8192
ds_read_b64_tr_b16 v[174:175], v211 offset:9216
s_waitcnt lgkmcnt(5)
v_mfma_f32_32x32x16_bf16 v[52:67], v[164:167], v[148:151], v[52:67]
ds_read_b128 v[156:159], v210 offset:1024
ds_read_b64_tr_b16 v[176:177], v211 offset:2048
s_add_u32 s66, s66, 20480
s_cmp_eq_u32 s66, 143360
s_cselect_b32 s65, s67, 20480
s_cselect_b32 s66, 0, s66
s_waitcnt lgkmcnt(6)
v_mfma_f32_32x32x16_bf16 v[68:83], v[164:167], v[152:155], v[68:83]
ds_read_b64_tr_b16 v[178:179], v211 offset:3072
ds_read_b128 v[160:163], v210 offset:3072
s_waitcnt lgkmcnt(6)
v_mfma_f32_32x32x16_bf16 v[84:99], v[168:171], v[148:151], v[84:99]
ds_read_b64_tr_b16 v[180:181], v211 offset:6144
ds_read_b64_tr_b16 v[182:183], v211 offset:7168
v_mfma_f32_32x32x16_bf16 v[100:115], v[168:171], v[152:155], v[100:115]
ds_read_b64_tr_b16 v[184:185], v211 offset:10240
ds_read_b64_tr_b16 v[186:187], v211 offset:11264
s_waitcnt lgkmcnt(8)
v_mfma_f32_32x32x16_bf16 v[116:131], v[148:151], v[172:175], v[116:131]
v_add_u32 v210, s65, v210
v_add_u32 v211, s65, v211
v_mfma_f32_32x32x16_bf16 v[132:147], v[152:155], v[172:175], v[132:147]
s_waitcnt lgkmcnt(5)
v_mfma_f32_32x32x16_bf16 v[52:67], v[176:179], v[156:159], v[52:67]
ds_read_b128 v[148:151], v210 offset:0
ds_read_b64_tr_b16 v[164:165], v211 offset:0
s_add_u32 s66, s66, 20480
s_cmp_eq_u32 s66, 143360
s_cselect_b32 s65, s67, 20480
s_cselect_b32 s66, 0, s66
s_waitcnt lgkmcnt(6)
v_mfma_f32_32x32x16_bf16 v[68:83], v[176:179], v[160:163], v[68:83]
ds_read_b64_tr_b16 v[166:167], v211 offset:1024
ds_read_b128 v[152:155], v210 offset:2048
s_waitcnt lgkmcnt(6)
v_mfma_f32_32x32x16_bf16 v[84:99], v[180:183], v[156:159], v[84:99]
ds_read_b64_tr_b16 v[168:169], v211 offset:4096
ds_read_b64_tr_b16 v[170:171], v211 offset:5120
s_cmp_eq_u32 s68, 0
s_cbranch_scc1 L_interleave_layers__linear_kernel_hedgehog__mha_block__prompt_kernel_g_t8
L_interleave_layers__linear_kernel_hedgehog__mha_block__prompt_kernel_g_t8_r:
v_mfma_f32_32x32x16_bf16 v[100:115], v[180:183], v[160:163], v[100:115]
ds_read_b64_tr_b16 v[172:173], v211 offset:8192
ds_read_b64_tr_b16 v[174:175], v211 offset:9216
s_waitcnt lgkmcnt(8)
v_mfma_f32_32x32x16_bf16 v[116:131], v[156:159], v[184:187], v[116:131]
v_mfma_f32_32x32x16_bf16 v[132:147], v[160:163], v[184:187], v[132:147]
s_waitcnt lgkmcnt(5)
v_mfma_f32_32x32x16_bf16 v[52:67], v[164:167], v[148:151], v[52:67]
ds_read_b128 v[156:159], v210 offset:1024
ds_read_b64_tr_b16 v[176:177], v211 offset:2048
s_waitcnt lgkmcnt(6)
v_mfma_f32_32x32x16_bf16 v[68:83], v[164:167], v[152:155], v[68:83]
ds_read_b64_tr_b16 v[178:179], v211 offset:3072
ds_read_b128 v[160:163], v210 offset:3072
s_waitcnt lgkmcnt(6)
v_mfma_f32_32x32x16_bf16 v[84:99], v[168:171], v[148:151], v[84:99]
ds_read_b64_tr_b16 v[180:181], v211 offset:6144
ds_read_b64_tr_b16 v[182:183], v211 offset:7168
v_mfma_f32_32x32x16_bf16 v[100:115], v[168:171], v[152:155], v[100:115]
ds_read_b64_tr_b16 v[184:185], v211 offset:10240
ds_read_b64_tr_b16 v[186:187], v211 offset:11264
s_waitcnt lgkmcnt(8)
v_mfma_f32_32x32x16_bf16 v[116:131], v[148:151], v[172:175], v[116:131]
v_mfma_f32_32x32x16_bf16 v[132:147], v[152:155], v[172:175], v[132:147]
s_waitcnt lgkmcnt(5)
v_mfma_f32_32x32x16_bf16 v[52:67], v[176:179], v[156:159], v[52:67]
s_waitcnt lgkmcnt(4)
v_mfma_f32_32x32x16_bf16 v[68:83], v[176:179], v[160:163], v[68:83]
s_waitcnt lgkmcnt(0)
s_barrier
v_add_u32 v210, s65, v210
v_add_u32 v211, s65, v211
v_mfma_f32_32x32x16_bf16 v[84:99], v[180:183], v[156:159], v[84:99]
ds_read_b128 v[148:151], v210 offset:0
ds_read_b64_tr_b16 v[164:165], v211 offset:0
v_mfma_f32_32x32x16_bf16 v[100:115], v[180:183], v[160:163], v[100:115]
ds_read_b64_tr_b16 v[166:167], v211 offset:1024
ds_read_b128 v[152:155], v210 offset:2048
v_mfma_f32_32x32x16_bf16 v[116:131], v[156:159], v[184:187], v[116:131]
ds_read_b64_tr_b16 v[168:169], v211 offset:4096
ds_read_b64_tr_b16 v[170:171], v211 offset:5120
v_mfma_f32_32x32x16_bf16 v[132:147], v[160:163], v[184:187], v[132:147]
ds_read_b64_tr_b16 v[172:173], v211 offset:8192
ds_read_b64_tr_b16 v[174:175], v211 offset:9216
s_waitcnt lgkmcnt(5)
v_mfma_f32_32x32x16_bf16 v[52:67], v[164:167], v[148:151], v[52:67]
ds_read_b128 v[156:159], v210 offset:1024
ds_read_b64_tr_b16 v[176:177], v211 offset:2048
s_add_u32 s66, s66, 20480
s_cmp_eq_u32 s66, 143360
s_cselect_b32 s65, s67, 20480
s_cselect_b32 s66, 0, s66
s_waitcnt lgkmcnt(6)
v_mfma_f32_32x32x16_bf16 v[68:83], v[164:167], v[152:155], v[68:83]
ds_read_b64_tr_b16 v[178:179], v211 offset:3072
ds_read_b128 v[160:163], v210 offset:3072
s_waitcnt lgkmcnt(6)
v_mfma_f32_32x32x16_bf16 v[84:99], v[168:171], v[148:151], v[84:99]
ds_read_b64_tr_b16 v[180:181], v211 offset:6144
ds_read_b64_tr_b16 v[182:183], v211 offset:7168
v_mfma_f32_32x32x16_bf16 v[100:115], v[168:171], v[152:155], v[100:115]
ds_read_b64_tr_b16 v[184:185], v211 offset:10240
ds_read_b64_tr_b16 v[186:187], v211 offset:11264
s_waitcnt lgkmcnt(8)
v_mfma_f32_32x32x16_bf16 v[116:131], v[148:151], v[172:175], v[116:131]
v_add_u32 v210, s65, v210
v_add_u32 v211, s65, v211
v_mfma_f32_32x32x16_bf16 v[132:147], v[152:155], v[172:175], v[132:147]
s_waitcnt lgkmcnt(5)
v_mfma_f32_32x32x16_bf16 v[52:67], v[176:179], v[156:159], v[52:67]
ds_read_b128 v[148:151], v210 offset:0
ds_read_b64_tr_b16 v[164:165], v211 offset:0
s_add_u32 s66, s66, 20480
s_cmp_eq_u32 s66, 143360
s_cselect_b32 s65, s67, 20480
s_cselect_b32 s66, 0, s66
s_waitcnt lgkmcnt(6)
v_mfma_f32_32x32x16_bf16 v[68:83], v[176:179], v[160:163], v[68:83]
ds_read_b64_tr_b16 v[166:167], v211 offset:1024
ds_read_b128 v[152:155], v210 offset:2048
s_waitcnt lgkmcnt(6)
v_mfma_f32_32x32x16_bf16 v[84:99], v[180:183], v[156:159], v[84:99]
ds_read_b64_tr_b16 v[168:169], v211 offset:4096
ds_read_b64_tr_b16 v[170:171], v211 offset:5120
s_cmp_eq_u32 s68, 1
s_cbranch_scc1 L_interleave_layers__linear_kernel_hedgehog__mha_block__prompt_kernel_g_t9
L_interleave_layers__linear_kernel_hedgehog__mha_block__prompt_kernel_g_t9_r:
v_mfma_f32_32x32x16_bf16 v[100:115], v[180:183], v[160:163], v[100:115]
ds_read_b64_tr_b16 v[172:173], v211 offset:8192
ds_read_b64_tr_b16 v[174:175], v211 offset:9216
s_waitcnt lgkmcnt(8)
v_mfma_f32_32x32x16_bf16 v[116:131], v[156:159], v[184:187], v[116:131]
v_mfma_f32_32x32x16_bf16 v[132:147], v[160:163], v[184:187], v[132:147]
s_waitcnt lgkmcnt(5)
v_mfma_f32_32x32x16_bf16 v[52:67], v[164:167], v[148:151], v[52:67]
ds_read_b128 v[156:159], v210 offset:1024
ds_read_b64_tr_b16 v[176:177], v211 offset:2048
s_waitcnt lgkmcnt(6)
v_mfma_f32_32x32x16_bf16 v[68:83], v[164:167], v[152:155], v[68:83]
ds_read_b64_tr_b16 v[178:179], v211 offset:3072
ds_read_b128 v[160:163], v210 offset:3072
s_waitcnt lgkmcnt(6)
v_mfma_f32_32x32x16_bf16 v[84:99], v[168:171], v[148:151], v[84:99]
ds_read_b64_tr_b16 v[180:181], v211 offset:6144
ds_read_b64_tr_b16 v[182:183], v211 offset:7168
v_mfma_f32_32x32x16_bf16 v[100:115], v[168:171], v[152:155], v[100:115]
ds_read_b64_tr_b16 v[184:185], v211 offset:10240
ds_read_b64_tr_b16 v[186:187], v211 offset:11264
s_waitcnt lgkmcnt(8)
v_mfma_f32_32x32x16_bf16 v[116:131], v[148:151], v[172:175], v[116:131]
v_mfma_f32_32x32x16_bf16 v[132:147], v[152:155], v[172:175], v[132:147]
s_waitcnt lgkmcnt(5)
v_mfma_f32_32x32x16_bf16 v[52:67], v[176:179], v[156:159], v[52:67]
s_waitcnt lgkmcnt(4)
v_mfma_f32_32x32x16_bf16 v[68:83], v[176:179], v[160:163], v[68:83]
s_waitcnt lgkmcnt(0)
s_barrier
v_add_u32 v210, s65, v210
v_add_u32 v211, s65, v211
v_mfma_f32_32x32x16_bf16 v[84:99], v[180:183], v[156:159], v[84:99]
ds_read_b128 v[148:151], v210 offset:0
ds_read_b64_tr_b16 v[164:165], v211 offset:0
v_mfma_f32_32x32x16_bf16 v[100:115], v[180:183], v[160:163], v[100:115]
ds_read_b64_tr_b16 v[166:167], v211 offset:1024
ds_read_b128 v[152:155], v210 offset:2048
v_mfma_f32_32x32x16_bf16 v[116:131], v[156:159], v[184:187], v[116:131]
ds_read_b64_tr_b16 v[168:169], v211 offset:4096
ds_read_b64_tr_b16 v[170:171], v211 offset:5120
v_mfma_f32_32x32x16_bf16 v[132:147], v[160:163], v[184:187], v[132:147]
ds_read_b64_tr_b16 v[172:173], v211 offset:8192
ds_read_b64_tr_b16 v[174:175], v211 offset:9216
s_waitcnt lgkmcnt(5)
v_mfma_f32_32x32x16_bf16 v[52:67], v[164:167], v[148:151], v[52:67]
ds_read_b128 v[156:159], v210 offset:1024
ds_read_b64_tr_b16 v[176:177], v211 offset:2048
s_add_u32 s66, s66, 20480
s_cmp_eq_u32 s66, 143360
s_cselect_b32 s65, s67, 20480
s_cselect_b32 s66, 0, s66
s_waitcnt lgkmcnt(6)
v_mfma_f32_32x32x16_bf16 v[68:83], v[164:167], v[152:155], v[68:83]
ds_read_b64_tr_b16 v[178:179], v211 offset:3072
ds_read_b128 v[160:163], v210 offset:3072
s_waitcnt lgkmcnt(6)
v_mfma_f32_32x32x16_bf16 v[84:99], v[168:171], v[148:151], v[84:99]
ds_read_b64_tr_b16 v[180:181], v211 offset:6144
ds_read_b64_tr_b16 v[182:183], v211 offset:7168
v_mfma_f32_32x32x16_bf16 v[100:115], v[168:171], v[152:155], v[100:115]
ds_read_b64_tr_b16 v[184:185], v211 offset:10240
ds_read_b64_tr_b16 v[186:187], v211 offset:11264
s_waitcnt lgkmcnt(8)
v_mfma_f32_32x32x16_bf16 v[116:131], v[148:151], v[172:175], v[116:131]
v_add_u32 v210, s65, v210
v_add_u32 v211, s65, v211
v_mfma_f32_32x32x16_bf16 v[132:147], v[152:155], v[172:175], v[132:147]
s_waitcnt lgkmcnt(5)
v_mfma_f32_32x32x16_bf16 v[52:67], v[176:179], v[156:159], v[52:67]
ds_read_b128 v[148:151], v210 offset:0
ds_read_b64_tr_b16 v[164:165], v211 offset:0
s_add_u32 s66, s66, 20480
s_cmp_eq_u32 s66, 143360
s_cselect_b32 s65, s67, 20480
s_cselect_b32 s66, 0, s66
s_waitcnt lgkmcnt(6)
v_mfma_f32_32x32x16_bf16 v[68:83], v[176:179], v[160:163], v[68:83]
ds_read_b64_tr_b16 v[166:167], v211 offset:1024
ds_read_b128 v[152:155], v210 offset:2048
s_waitcnt lgkmcnt(6)
v_mfma_f32_32x32x16_bf16 v[84:99], v[180:183], v[156:159], v[84:99]
ds_read_b64_tr_b16 v[168:169], v211 offset:4096
ds_read_b64_tr_b16 v[170:171], v211 offset:5120
s_cmp_eq_u32 s68, 2
s_cbranch_scc1 L_interleave_layers__linear_kernel_hedgehog__mha_block__prompt_kernel_g_t10
L_interleave_layers__linear_kernel_hedgehog__mha_block__prompt_kernel_g_t10_r:
v_mfma_f32_32x32x16_bf16 v[100:115], v[180:183], v[160:163], v[100:115]
ds_read_b64_tr_b16 v[172:173], v211 offset:8192
ds_read_b64_tr_b16 v[174:175], v211 offset:9216
s_waitcnt lgkmcnt(8)
v_mfma_f32_32x32x16_bf16 v[116:131], v[156:159], v[184:187], v[116:131]
v_mfma_f32_32x32x16_bf16 v[132:147], v[160:163], v[184:187], v[132:147]
s_waitcnt lgkmcnt(5)
v_mfma_f32_32x32x16_bf16 v[52:67], v[164:167], v[148:151], v[52:67]
ds_read_b128 v[156:159], v210 offset:1024
ds_read_b64_tr_b16 v[176:177], v211 offset:2048
s_waitcnt lgkmcnt(6)
v_mfma_f32_32x32x16_bf16 v[68:83], v[164:167], v[152:155], v[68:83]
ds_read_b64_tr_b16 v[178:179], v211 offset:3072
ds_read_b128 v[160:163], v210 offset:3072
s_waitcnt lgkmcnt(6)
v_mfma_f32_32x32x16_bf16 v[84:99], v[168:171], v[148:151], v[84:99]
ds_read_b64_tr_b16 v[180:181], v211 offset:6144
ds_read_b64_tr_b16 v[182:183], v211 offset:7168
v_mfma_f32_32x32x16_bf16 v[100:115], v[168:171], v[152:155], v[100:115]
ds_read_b64_tr_b16 v[184:185], v211 offset:10240
ds_read_b64_tr_b16 v[186:187], v211 offset:11264
s_waitcnt lgkmcnt(8)
v_mfma_f32_32x32x16_bf16 v[116:131], v[148:151], v[172:175], v[116:131]
v_mfma_f32_32x32x16_bf16 v[132:147], v[152:155], v[172:175], v[132:147]
s_waitcnt lgkmcnt(5)
v_mfma_f32_32x32x16_bf16 v[52:67], v[176:179], v[156:159], v[52:67]
s_waitcnt lgkmcnt(4)
v_mfma_f32_32x32x16_bf16 v[68:83], v[176:179], v[160:163], v[68:83]
s_waitcnt lgkmcnt(0)
s_barrier
v_add_u32 v210, s65, v210
v_add_u32 v211, s65, v211
v_mfma_f32_32x32x16_bf16 v[84:99], v[180:183], v[156:159], v[84:99]
ds_read_b128 v[148:151], v210 offset:0
ds_read_b64_tr_b16 v[164:165], v211 offset:0
v_mfma_f32_32x32x16_bf16 v[100:115], v[180:183], v[160:163], v[100:115]
ds_read_b64_tr_b16 v[166:167], v211 offset:1024
ds_read_b128 v[152:155], v210 offset:2048
v_mfma_f32_32x32x16_bf16 v[116:131], v[156:159], v[184:187], v[116:131]
ds_read_b64_tr_b16 v[168:169], v211 offset:4096
ds_read_b64_tr_b16 v[170:171], v211 offset:5120
v_mfma_f32_32x32x16_bf16 v[132:147], v[160:163], v[184:187], v[132:147]
ds_read_b64_tr_b16 v[172:173], v211 offset:8192
ds_read_b64_tr_b16 v[174:175], v211 offset:9216
s_waitcnt lgkmcnt(5)
v_mfma_f32_32x32x16_bf16 v[52:67], v[164:167], v[148:151], v[52:67]
ds_read_b128 v[156:159], v210 offset:1024
ds_read_b64_tr_b16 v[176:177], v211 offset:2048
s_add_u32 s66, s66, 20480
s_cmp_eq_u32 s66, 143360
s_cselect_b32 s65, s67, 20480
s_cselect_b32 s66, 0, s66
s_waitcnt lgkmcnt(6)
v_mfma_f32_32x32x16_bf16 v[68:83], v[164:167], v[152:155], v[68:83]
ds_read_b64_tr_b16 v[178:179], v211 offset:3072
ds_read_b128 v[160:163], v210 offset:3072
s_waitcnt lgkmcnt(6)
v_mfma_f32_32x32x16_bf16 v[84:99], v[168:171], v[148:151], v[84:99]
ds_read_b64_tr_b16 v[180:181], v211 offset:6144
ds_read_b64_tr_b16 v[182:183], v211 offset:7168
v_mfma_f32_32x32x16_bf16 v[100:115], v[168:171], v[152:155], v[100:115]
ds_read_b64_tr_b16 v[184:185], v211 offset:10240
ds_read_b64_tr_b16 v[186:187], v211 offset:11264
s_waitcnt lgkmcnt(8)
v_mfma_f32_32x32x16_bf16 v[116:131], v[148:151], v[172:175], v[116:131]
v_add_u32 v210, s65, v210
v_add_u32 v211, s65, v211
v_mfma_f32_32x32x16_bf16 v[132:147], v[152:155], v[172:175], v[132:147]
s_waitcnt lgkmcnt(5)
v_mfma_f32_32x32x16_bf16 v[52:67], v[176:179], v[156:159], v[52:67]
ds_read_b128 v[148:151], v210 offset:0
ds_read_b64_tr_b16 v[164:165], v211 offset:0
s_add_u32 s66, s66, 20480
s_cmp_eq_u32 s66, 143360
s_cselect_b32 s65, s67, 20480
s_cselect_b32 s66, 0, s66
s_waitcnt lgkmcnt(6)
v_mfma_f32_32x32x16_bf16 v[68:83], v[176:179], v[160:163], v[68:83]
ds_read_b64_tr_b16 v[166:167], v211 offset:1024
ds_read_b128 v[152:155], v210 offset:2048
s_waitcnt lgkmcnt(6)
v_mfma_f32_32x32x16_bf16 v[84:99], v[180:183], v[156:159], v[84:99]
ds_read_b64_tr_b16 v[168:169], v211 offset:4096
ds_read_b64_tr_b16 v[170:171], v211 offset:5120
v_mfma_f32_32x32x16_bf16 v[100:115], v[180:183], v[160:163], v[100:115]
ds_read_b64_tr_b16 v[172:173], v211 offset:8192
ds_read_b64_tr_b16 v[174:175], v211 offset:9216
s_waitcnt lgkmcnt(8)
v_mfma_f32_32x32x16_bf16 v[116:131], v[156:159], v[184:187], v[116:131]
v_mfma_f32_32x32x16_bf16 v[132:147], v[160:163], v[184:187], v[132:147]
s_waitcnt lgkmcnt(5)
v_mfma_f32_32x32x16_bf16 v[52:67], v[164:167], v[148:151], v[52:67]
ds_read_b128 v[156:159], v210 offset:1024
ds_read_b64_tr_b16 v[176:177], v211 offset:2048
s_waitcnt lgkmcnt(6)
v_mfma_f32_32x32x16_bf16 v[68:83], v[164:167], v[152:155], v[68:83]
ds_read_b64_tr_b16 v[178:179], v211 offset:3072
ds_read_b128 v[160:163], v210 offset:3072
s_waitcnt lgkmcnt(6)
v_mfma_f32_32x32x16_bf16 v[84:99], v[168:171], v[148:151], v[84:99]
ds_read_b64_tr_b16 v[180:181], v211 offset:6144
ds_read_b64_tr_b16 v[182:183], v211 offset:7168
v_mfma_f32_32x32x16_bf16 v[100:115], v[168:171], v[152:155], v[100:115]
ds_read_b64_tr_b16 v[184:185], v211 offset:10240
ds_read_b64_tr_b16 v[186:187], v211 offset:11264
s_waitcnt lgkmcnt(8)
v_mfma_f32_32x32x16_bf16 v[116:131], v[148:151], v[172:175], v[116:131]
v_mfma_f32_32x32x16_bf16 v[132:147], v[152:155], v[172:175], v[132:147]
s_waitcnt lgkmcnt(5)
v_mfma_f32_32x32x16_bf16 v[52:67], v[176:179], v[156:159], v[52:67]
s_waitcnt lgkmcnt(4)
v_mfma_f32_32x32x16_bf16 v[68:83], v[176:179], v[160:163], v[68:83]
s_waitcnt lgkmcnt(0)
s_barrier
v_add_u32 v210, s65, v210
v_add_u32 v211, s65, v211
v_mfma_f32_32x32x16_bf16 v[84:99], v[180:183], v[156:159], v[84:99]
ds_read_b128 v[148:151], v210 offset:0
ds_read_b64_tr_b16 v[164:165], v211 offset:0
v_mfma_f32_32x32x16_bf16 v[100:115], v[180:183], v[160:163], v[100:115]
ds_read_b64_tr_b16 v[166:167], v211 offset:1024
ds_read_b128 v[152:155], v210 offset:2048
v_mfma_f32_32x32x16_bf16 v[116:131], v[156:159], v[184:187], v[116:131]
ds_read_b64_tr_b16 v[168:169], v211 offset:4096
ds_read_b64_tr_b16 v[170:171], v211 offset:5120
v_mfma_f32_32x32x16_bf16 v[132:147], v[160:163], v[184:187], v[132:147]
ds_read_b64_tr_b16 v[172:173], v211 offset:8192
ds_read_b64_tr_b16 v[174:175], v211 offset:9216
s_waitcnt lgkmcnt(5)
v_mfma_f32_32x32x16_bf16 v[52:67], v[164:167], v[148:151], v[52:67]
ds_read_b128 v[156:159], v210 offset:1024
ds_read_b64_tr_b16 v[176:177], v211 offset:2048
s_add_u32 s66, s66, 20480
s_cmp_eq_u32 s66, 143360
s_cselect_b32 s65, s67, 20480
s_cselect_b32 s66, 0, s66
s_waitcnt lgkmcnt(6)
v_mfma_f32_32x32x16_bf16 v[68:83], v[164:167], v[152:155], v[68:83]
ds_read_b64_tr_b16 v[178:179], v211 offset:3072
ds_read_b128 v[160:163], v210 offset:3072
s_waitcnt lgkmcnt(6)
v_mfma_f32_32x32x16_bf16 v[84:99], v[168:171], v[148:151], v[84:99]
ds_read_b64_tr_b16 v[180:181], v211 offset:6144
ds_read_b64_tr_b16 v[182:183], v211 offset:7168
v_mfma_f32_32x32x16_bf16 v[100:115], v[168:171], v[152:155], v[100:115]
ds_read_b64_tr_b16 v[184:185], v211 offset:10240
ds_read_b64_tr_b16 v[186:187], v211 offset:11264
s_waitcnt lgkmcnt(8)
v_mfma_f32_32x32x16_bf16 v[116:131], v[148:151], v[172:175], v[116:131]
v_add_u32 v210, s65, v210
v_add_u32 v211, s65, v211
v_mfma_f32_32x32x16_bf16 v[132:147], v[152:155], v[172:175], v[132:147]
s_waitcnt lgkmcnt(5)
v_mfma_f32_32x32x16_bf16 v[52:67], v[176:179], v[156:159], v[52:67]
ds_read_b128 v[148:151], v210 offset:0
ds_read_b64_tr_b16 v[164:165], v211 offset:0
s_add_u32 s66, s66, 20480
s_cmp_eq_u32 s66, 143360
s_cselect_b32 s65, s67, 20480
s_cselect_b32 s66, 0, s66
s_waitcnt lgkmcnt(6)
v_mfma_f32_32x32x16_bf16 v[68:83], v[176:179], v[160:163], v[68:83]
ds_read_b64_tr_b16 v[166:167], v211 offset:1024
ds_read_b128 v[152:155], v210 offset:2048
s_waitcnt lgkmcnt(6)
v_mfma_f32_32x32x16_bf16 v[84:99], v[180:183], v[156:159], v[84:99]
ds_read_b64_tr_b16 v[168:169], v211 offset:4096
ds_read_b64_tr_b16 v[170:171], v211 offset:5120
v_mfma_f32_32x32x16_bf16 v[100:115], v[180:183], v[160:163], v[100:115]
ds_read_b64_tr_b16 v[172:173], v211 offset:8192
ds_read_b64_tr_b16 v[174:175], v211 offset:9216
s_waitcnt lgkmcnt(8)
v_mfma_f32_32x32x16_bf16 v[116:131], v[156:159], v[184:187], v[116:131]
v_mfma_f32_32x32x16_bf16 v[132:147], v[160:163], v[184:187], v[132:147]
s_waitcnt lgkmcnt(5)
v_mfma_f32_32x32x16_bf16 v[52:67], v[164:167], v[148:151], v[52:67]
ds_read_b128 v[156:159], v210 offset:1024
ds_read_b64_tr_b16 v[176:177], v211 offset:2048
s_waitcnt lgkmcnt(6)
v_mfma_f32_32x32x16_bf16 v[68:83], v[164:167], v[152:155], v[68:83]
ds_read_b64_tr_b16 v[178:179], v211 offset:3072
ds_read_b128 v[160:163], v210 offset:3072
s_waitcnt lgkmcnt(6)
v_mfma_f32_32x32x16_bf16 v[84:99], v[168:171], v[148:151], v[84:99]
ds_read_b64_tr_b16 v[180:181], v211 offset:6144
ds_read_b64_tr_b16 v[182:183], v211 offset:7168
v_mfma_f32_32x32x16_bf16 v[100:115], v[168:171], v[152:155], v[100:115]
ds_read_b64_tr_b16 v[184:185], v211 offset:10240
ds_read_b64_tr_b16 v[186:187], v211 offset:11264
s_waitcnt lgkmcnt(8)
v_mfma_f32_32x32x16_bf16 v[116:131], v[148:151], v[172:175], v[116:131]
v_mfma_f32_32x32x16_bf16 v[132:147], v[152:155], v[172:175], v[132:147]
s_waitcnt lgkmcnt(5)
v_mfma_f32_32x32x16_bf16 v[52:67], v[176:179], v[156:159], v[52:67]
s_waitcnt lgkmcnt(4)
v_mfma_f32_32x32x16_bf16 v[68:83], v[176:179], v[160:163], v[68:83]
s_waitcnt lgkmcnt(0)
s_barrier
v_add_u32 v210, s65, v210
v_add_u32 v211, s65, v211
v_mfma_f32_32x32x16_bf16 v[84:99], v[180:183], v[156:159], v[84:99]
ds_read_b128 v[148:151], v210 offset:0
ds_read_b64_tr_b16 v[164:165], v211 offset:0
v_mfma_f32_32x32x16_bf16 v[100:115], v[180:183], v[160:163], v[100:115]
ds_read_b64_tr_b16 v[166:167], v211 offset:1024
ds_read_b128 v[152:155], v210 offset:2048
v_mfma_f32_32x32x16_bf16 v[116:131], v[156:159], v[184:187], v[116:131]
ds_read_b64_tr_b16 v[168:169], v211 offset:4096
ds_read_b64_tr_b16 v[170:171], v211 offset:5120
v_mfma_f32_32x32x16_bf16 v[132:147], v[160:163], v[184:187], v[132:147]
ds_read_b64_tr_b16 v[172:173], v211 offset:8192
ds_read_b64_tr_b16 v[174:175], v211 offset:9216
s_waitcnt lgkmcnt(5)
v_mfma_f32_32x32x16_bf16 v[52:67], v[164:167], v[148:151], v[52:67]
ds_read_b128 v[156:159], v210 offset:1024
ds_read_b64_tr_b16 v[176:177], v211 offset:2048
s_add_u32 s66, s66, 20480
s_cmp_eq_u32 s66, 143360
s_cselect_b32 s65, s67, 20480
s_cselect_b32 s66, 0, s66
s_waitcnt lgkmcnt(6)
v_mfma_f32_32x32x16_bf16 v[68:83], v[164:167], v[152:155], v[68:83]
ds_read_b64_tr_b16 v[178:179], v211 offset:3072
ds_read_b128 v[160:163], v210 offset:3072
s_waitcnt lgkmcnt(6)
v_mfma_f32_32x32x16_bf16 v[84:99], v[168:171], v[148:151], v[84:99]
ds_read_b64_tr_b16 v[180:181], v211 offset:6144
ds_read_b64_tr_b16 v[182:183], v211 offset:7168
v_mfma_f32_32x32x16_bf16 v[100:115], v[168:171], v[152:155], v[100:115]
ds_read_b64_tr_b16 v[184:185], v211 offset:10240
ds_read_b64_tr_b16 v[186:187], v211 offset:11264
s_waitcnt lgkmcnt(8)
v_mfma_f32_32x32x16_bf16 v[116:131], v[148:151], v[172:175], v[116:131]
v_add_u32 v210, s65, v210
v_add_u32 v211, s65, v211
v_mfma_f32_32x32x16_bf16 v[132:147], v[152:155], v[172:175], v[132:147]
s_waitcnt lgkmcnt(5)
v_mfma_f32_32x32x16_bf16 v[52:67], v[176:179], v[156:159], v[52:67]
ds_read_b128 v[148:151], v210 offset:0
ds_read_b64_tr_b16 v[164:165], v211 offset:0
s_add_u32 s66, s66, 20480
s_cmp_eq_u32 s66, 143360
s_cselect_b32 s65, s67, 20480
s_cselect_b32 s66, 0, s66
s_waitcnt lgkmcnt(6)
v_mfma_f32_32x32x16_bf16 v[68:83], v[176:179], v[160:163], v[68:83]
ds_read_b64_tr_b16 v[166:167], v211 offset:1024
ds_read_b128 v[152:155], v210 offset:2048
s_waitcnt lgkmcnt(6)
v_mfma_f32_32x32x16_bf16 v[84:99], v[180:183], v[156:159], v[84:99]
ds_read_b64_tr_b16 v[168:169], v211 offset:4096
ds_read_b64_tr_b16 v[170:171], v211 offset:5120
v_mfma_f32_32x32x16_bf16 v[100:115], v[180:183], v[160:163], v[100:115]
ds_read_b64_tr_b16 v[172:173], v211 offset:8192
ds_read_b64_tr_b16 v[174:175], v211 offset:9216
s_waitcnt lgkmcnt(8)
v_mfma_f32_32x32x16_bf16 v[116:131], v[156:159], v[184:187], v[116:131]
v_mfma_f32_32x32x16_bf16 v[132:147], v[160:163], v[184:187], v[132:147]
s_waitcnt lgkmcnt(5)
v_mfma_f32_32x32x16_bf16 v[52:67], v[164:167], v[148:151], v[52:67]
ds_read_b128 v[156:159], v210 offset:1024
ds_read_b64_tr_b16 v[176:177], v211 offset:2048
s_waitcnt lgkmcnt(6)
v_mfma_f32_32x32x16_bf16 v[68:83], v[164:167], v[152:155], v[68:83]
ds_read_b64_tr_b16 v[178:179], v211 offset:3072
ds_read_b128 v[160:163], v210 offset:3072
s_waitcnt lgkmcnt(6)
v_mfma_f32_32x32x16_bf16 v[84:99], v[168:171], v[148:151], v[84:99]
ds_read_b64_tr_b16 v[180:181], v211 offset:6144
ds_read_b64_tr_b16 v[182:183], v211 offset:7168
v_mfma_f32_32x32x16_bf16 v[100:115], v[168:171], v[152:155], v[100:115]
ds_read_b64_tr_b16 v[184:185], v211 offset:10240
ds_read_b64_tr_b16 v[186:187], v211 offset:11264
s_waitcnt lgkmcnt(8)
v_mfma_f32_32x32x16_bf16 v[116:131], v[148:151], v[172:175], v[116:131]
v_mfma_f32_32x32x16_bf16 v[132:147], v[152:155], v[172:175], v[132:147]
s_waitcnt lgkmcnt(5)
v_mfma_f32_32x32x16_bf16 v[52:67], v[176:179], v[156:159], v[52:67]
s_waitcnt lgkmcnt(4)
v_mfma_f32_32x32x16_bf16 v[68:83], v[176:179], v[160:163], v[68:83]
s_waitcnt lgkmcnt(0)
s_barrier
v_add_u32 v210, s65, v210
v_add_u32 v211, s65, v211
v_mfma_f32_32x32x16_bf16 v[84:99], v[180:183], v[156:159], v[84:99]
ds_read_b128 v[148:151], v210 offset:0
ds_read_b64_tr_b16 v[164:165], v211 offset:0
v_mfma_f32_32x32x16_bf16 v[100:115], v[180:183], v[160:163], v[100:115]
ds_read_b64_tr_b16 v[166:167], v211 offset:1024
ds_read_b128 v[152:155], v210 offset:2048
v_mfma_f32_32x32x16_bf16 v[116:131], v[156:159], v[184:187], v[116:131]
ds_read_b64_tr_b16 v[168:169], v211 offset:4096
ds_read_b64_tr_b16 v[170:171], v211 offset:5120
v_mfma_f32_32x32x16_bf16 v[132:147], v[160:163], v[184:187], v[132:147]
ds_read_b64_tr_b16 v[172:173], v211 offset:8192
ds_read_b64_tr_b16 v[174:175], v211 offset:9216
s_waitcnt lgkmcnt(5)
v_mfma_f32_32x32x16_bf16 v[52:67], v[164:167], v[148:151], v[52:67]
ds_read_b128 v[156:159], v210 offset:1024
ds_read_b64_tr_b16 v[176:177], v211 offset:2048
s_add_u32 s66, s66, 20480
s_cmp_eq_u32 s66, 143360
s_cselect_b32 s65, s67, 20480
s_cselect_b32 s66, 0, s66
s_waitcnt lgkmcnt(6)
v_mfma_f32_32x32x16_bf16 v[68:83], v[164:167], v[152:155], v[68:83]
ds_read_b64_tr_b16 v[178:179], v211 offset:3072
ds_read_b128 v[160:163], v210 offset:3072
s_waitcnt lgkmcnt(6)
v_mfma_f32_32x32x16_bf16 v[84:99], v[168:171], v[148:151], v[84:99]
ds_read_b64_tr_b16 v[180:181], v211 offset:6144
ds_read_b64_tr_b16 v[182:183], v211 offset:7168
v_mfma_f32_32x32x16_bf16 v[100:115], v[168:171], v[152:155], v[100:115]
ds_read_b64_tr_b16 v[184:185], v211 offset:10240
ds_read_b64_tr_b16 v[186:187], v211 offset:11264
s_waitcnt lgkmcnt(8)
v_mfma_f32_32x32x16_bf16 v[116:131], v[148:151], v[172:175], v[116:131]
v_add_u32 v210, s65, v210
v_add_u32 v211, s65, v211
v_mfma_f32_32x32x16_bf16 v[132:147], v[152:155], v[172:175], v[132:147]
s_waitcnt lgkmcnt(5)
v_mfma_f32_32x32x16_bf16 v[52:67], v[176:179], v[156:159], v[52:67]
ds_read_b128 v[148:151], v210 offset:0
ds_read_b64_tr_b16 v[164:165], v211 offset:0
s_add_u32 s66, s66, 20480
s_cmp_eq_u32 s66, 143360
s_cselect_b32 s65, s67, 20480
s_cselect_b32 s66, 0, s66
s_waitcnt lgkmcnt(6)
v_mfma_f32_32x32x16_bf16 v[68:83], v[176:179], v[160:163], v[68:83]
ds_read_b64_tr_b16 v[166:167], v211 offset:1024
ds_read_b128 v[152:155], v210 offset:2048
s_waitcnt lgkmcnt(6)
v_mfma_f32_32x32x16_bf16 v[84:99], v[180:183], v[156:159], v[84:99]
ds_read_b64_tr_b16 v[168:169], v211 offset:4096
ds_read_b64_tr_b16 v[170:171], v211 offset:5120
v_mfma_f32_32x32x16_bf16 v[100:115], v[180:183], v[160:163], v[100:115]
ds_read_b64_tr_b16 v[172:173], v211 offset:8192
ds_read_b64_tr_b16 v[174:175], v211 offset:9216
s_waitcnt lgkmcnt(8)
v_mfma_f32_32x32x16_bf16 v[116:131], v[156:159], v[184:187], v[116:131]
v_mfma_f32_32x32x16_bf16 v[132:147], v[160:163], v[184:187], v[132:147]
s_waitcnt lgkmcnt(5)
v_mfma_f32_32x32x16_bf16 v[52:67], v[164:167], v[148:151], v[52:67]
ds_read_b128 v[156:159], v210 offset:1024
ds_read_b64_tr_b16 v[176:177], v211 offset:2048
s_waitcnt lgkmcnt(6)
v_mfma_f32_32x32x16_bf16 v[68:83], v[164:167], v[152:155], v[68:83]
ds_read_b64_tr_b16 v[178:179], v211 offset:3072
ds_read_b128 v[160:163], v210 offset:3072
s_waitcnt lgkmcnt(6)
v_mfma_f32_32x32x16_bf16 v[84:99], v[168:171], v[148:151], v[84:99]
ds_read_b64_tr_b16 v[180:181], v211 offset:6144
ds_read_b64_tr_b16 v[182:183], v211 offset:7168
v_mfma_f32_32x32x16_bf16 v[100:115], v[168:171], v[152:155], v[100:115]
ds_read_b64_tr_b16 v[184:185], v211 offset:10240
ds_read_b64_tr_b16 v[186:187], v211 offset:11264
s_waitcnt lgkmcnt(8)
v_mfma_f32_32x32x16_bf16 v[116:131], v[148:151], v[172:175], v[116:131]
v_mfma_f32_32x32x16_bf16 v[132:147], v[152:155], v[172:175], v[132:147]
s_waitcnt lgkmcnt(5)
v_mfma_f32_32x32x16_bf16 v[52:67], v[176:179], v[156:159], v[52:67]
s_waitcnt lgkmcnt(4)
v_mfma_f32_32x32x16_bf16 v[68:83], v[176:179], v[160:163], v[68:83]
s_waitcnt lgkmcnt(0)
s_barrier
v_add_u32 v210, s65, v210
v_add_u32 v211, s65, v211
v_mfma_f32_32x32x16_bf16 v[84:99], v[180:183], v[156:159], v[84:99]
ds_read_b128 v[148:151], v210 offset:0
ds_read_b64_tr_b16 v[164:165], v211 offset:0
v_mfma_f32_32x32x16_bf16 v[100:115], v[180:183], v[160:163], v[100:115]
ds_read_b64_tr_b16 v[166:167], v211 offset:1024
ds_read_b128 v[152:155], v210 offset:2048
v_mfma_f32_32x32x16_bf16 v[116:131], v[156:159], v[184:187], v[116:131]
ds_read_b64_tr_b16 v[168:169], v211 offset:4096
ds_read_b64_tr_b16 v[170:171], v211 offset:5120
v_mfma_f32_32x32x16_bf16 v[132:147], v[160:163], v[184:187], v[132:147]
ds_read_b64_tr_b16 v[172:173], v211 offset:8192
ds_read_b64_tr_b16 v[174:175], v211 offset:9216
s_waitcnt vmcnt(0)
ds_read_b32 v8, v235 offset:0
ds_read_b32 v208, v235 offset:512
ds_read_b32 v9, v235 offset:128
ds_read_b32 v209, v235 offset:640
v_and_b32 v17, 31, v0
v_lshlrev_b32 v17, 2, v17
s_lshl_b32 s31, s23, 7
s_and_b32 s32, s29, 1
s_mul_i32 s32, s32, 2048
s_add_u32 s31, s31, s32
v_add_u32 v17, s31, v17
ds_read_b32 v14, v17 offset:1024
ds_read_b32 v15, v17 offset:1280
ds_read_b32 v16, v17 offset:1536
s_waitcnt lgkmcnt(5)
v_mfma_f32_32x32x16_bf16 v[52:67], v[164:167], v[148:151], v[52:67]
ds_read_b128 v[156:159], v210 offset:1024
ds_read_b64_tr_b16 v[176:177], v211 offset:2048
s_add_u32 s66, s66, 20480
s_cmp_eq_u32 s66, 143360
s_cselect_b32 s65, s67, 20480
s_cselect_b32 s66, 0, s66
s_waitcnt lgkmcnt(6)
v_mfma_f32_32x32x16_bf16 v[68:83], v[164:167], v[152:155], v[68:83]
ds_read_b64_tr_b16 v[178:179], v211 offset:3072
ds_read_b128 v[160:163], v210 offset:3072
s_waitcnt lgkmcnt(6)
v_mfma_f32_32x32x16_bf16 v[84:99], v[168:171], v[148:151], v[84:99]
ds_read_b64_tr_b16 v[180:181], v211 offset:6144
ds_read_b64_tr_b16 v[182:183], v211 offset:7168
v_mfma_f32_32x32x16_bf16 v[100:115], v[168:171], v[152:155], v[100:115]
ds_read_b64_tr_b16 v[184:185], v211 offset:10240
ds_read_b64_tr_b16 v[186:187], v211 offset:11264
s_waitcnt lgkmcnt(8)
v_mfma_f32_32x32x16_bf16 v[116:131], v[148:151], v[172:175], v[116:131]
v_add_u32 v210, s65, v210
v_add_u32 v211, s65, v211
v_mfma_f32_32x32x16_bf16 v[132:147], v[152:155], v[172:175], v[132:147]
s_waitcnt lgkmcnt(5)
v_mfma_f32_32x32x16_bf16 v[52:67], v[176:179], v[156:159], v[52:67]
ds_read_b128 v[148:151], v210 offset:0
ds_read_b64_tr_b16 v[164:165], v211 offset:0
v_cvt_pk_bf16_f32 v10, v8, v8
v_and_b32 v11, 0xffff0000, v10
v_sub_f32 v11, v8, v11
s_waitcnt lgkmcnt(6)
v_mfma_f32_32x32x16_bf16 v[68:83], v[176:179], v[160:163], v[68:83]
ds_read_b64_tr_b16 v[166:167], v211 offset:1024
ds_read_b128 v[152:155], v210 offset:2048
v_cvt_pk_bf16_f32 v200, v8, v11
v_and_b32 v202, 0xffff, v10
v_mov_b32 v203, 0
s_waitcnt lgkmcnt(6)
v_mfma_f32_32x32x16_bf16 v[84:99], v[180:183], v[156:159], v[84:99]
ds_read_b64_tr_b16 v[168:169], v211 offset:4096
ds_read_b64_tr_b16 v[170:171], v211 offset:5120
v_mov_b32 v201, v200
v_cvt_pk_bf16_f32 v12, v9, v9
v_and_b32 v13, 0xffff0000, v12
v_mfma_f32_32x32x16_bf16 v[100:115], v[180:183], v[160:163], v[100:115]
ds_read_b64_tr_b16 v[172:173], v211 offset:8192
ds_read_b64_tr_b16 v[174:175], v211 offset:9216
v_sub_f32 v13, v9, v13
v_cvt_pk_bf16_f32 v204, v9, v13
v_and_b32 v206, 0xffff, v12
s_waitcnt lgkmcnt(8)
v_mfma_f32_32x32x16_bf16 v[116:131], v[156:159], v[184:187], v[116:131]
v_mov_b32 v207, 0
v_mov_b32 v205, v204
v_cmp_gt_u32 vcc, 32, v0
v_mfma_f32_32x32x16_bf16 v[132:147], v[160:163], v[184:187], v[132:147]
v_mov_b32 v18, 0
v_cndmask_b32 v14, 0, v14, vcc
v_cvt_pk_bf16_f32 v188, v14, v14
s_waitcnt lgkmcnt(5)
v_mfma_f32_32x32x16_bf16 v[52:67], v[164:167], v[148:151], v[52:67]
ds_read_b128 v[156:159], v210 offset:1024
ds_read_b64_tr_b16 v[176:177], v211 offset:2048
v_and_b32 v19, 0xffff0000, v188
v_sub_f32 v14, v14, v19
v_cvt_pk_bf16_f32 v189, v14, v14
s_waitcnt lgkmcnt(6)
v_mfma_f32_32x32x16_bf16 v[68:83], v[164:167], v[152:155], v[68:83]
ds_read_b64_tr_b16 v[178:179], v211 offset:3072
ds_read_b128 v[160:163], v210 offset:3072
v_and_b32 v19, 0xffff0000, v189
v_sub_f32 v14, v14, v19
v_cvt_pk_bf16_f32 v190, v14, v18
s_waitcnt lgkmcnt(6)
v_mfma_f32_32x32x16_bf16 v[84:99], v[168:171], v[148:151], v[84:99]
ds_read_b64_tr_b16 v[180:181], v211 offset:6144
ds_read_b64_tr_b16 v[182:183], v211 offset:7168
v_mov_b32 v191, 0
v_cndmask_b32 v15, 0, v15, vcc
v_cvt_pk_bf16_f32 v192, v15, v15
v_mfma_f32_32x32x16_bf16 v[100:115], v[168:171], v[152:155], v[100:115]
ds_read_b64_tr_b16 v[184:185], v211 offset:10240
ds_read_b64_tr_b16 v[186:187], v211 offset:11264
v_and_b32 v20, 0xffff0000, v192
v_sub_f32 v15, v15, v20
v_cvt_pk_bf16_f32 v193, v15, v15
s_waitcnt lgkmcnt(8)
v_mfma_f32_32x32x16_bf16 v[116:131], v[148:151], v[172:175], v[116:131]
v_and_b32 v20, 0xffff0000, v193
v_sub_f32 v15, v15, v20
v_cvt_pk_bf16_f32 v194, v15, v18
v_mfma_f32_32x32x16_bf16 v[132:147], v[152:155], v[172:175], v[132:147]
v_mov_b32 v195, 0
v_cndmask_b32 v16, 0, v16, vcc
v_cvt_pk_bf16_f32 v196, v16, v16
s_waitcnt lgkmcnt(0)
v_mfma_f32_32x32x16_bf16 v[52:67], v[176:179], v[156:159], v[52:67]
v_and_b32 v21, 0xffff0000, v196
v_sub_f32 v16, v16, v21
v_cvt_pk_bf16_f32 v197, v16, v16
v_mfma_f32_32x32x16_bf16 v[68:83], v[176:179], v[160:163], v[68:83]
v_and_b32 v21, 0xffff0000, v197
v_sub_f32 v16, v16, v21
v_cvt_pk_bf16_f32 v198, v16, v18
v_mfma_f32_32x32x16_bf16 v[84:99], v[180:183], v[156:159], v[84:99]
v_mov_b32 v199, 0
v_mfma_f32_32x32x16_bf16 v[100:115], v[180:183], v[160:163], v[100:115]
v_mfma_f32_32x32x16_bf16 v[116:131], v[156:159], v[184:187], v[116:131]
v_mfma_f32_32x32x16_bf16 v[132:147], v[160:163], v[184:187], v[132:147]
v_mfma_f32_32x32x16_bf16 v[52:67], v[188:191], v[200:203], v[52:67]
v_mfma_f32_32x32x16_bf16 v[68:83], v[188:191], v[204:207], v[68:83]
v_mfma_f32_32x32x16_bf16 v[84:99], v[192:195], v[200:203], v[84:99]
v_mfma_f32_32x32x16_bf16 v[100:115], v[192:195], v[204:207], v[100:115]
v_mfma_f32_32x32x16_bf16 v[116:131], v[200:203], v[196:199], v[116:131]
v_mfma_f32_32x32x16_bf16 v[132:147], v[204:207], v[196:199], v[132:147]
s_bitcmp1_b32 s29, 0
s_cbranch_scc1 L_interleave_layers__linear_kernel_hedgehog__mha_block__prompt_kernel_cB
s_cmp_lg_u32 s29, 0
s_cbranch_scc1 L_interleave_layers__linear_kernel_hedgehog__mha_block__prompt_kernel_a_notouch
s_lshl_b32 s31, s20, 6
v_add_u32 v230, s31, v0
s_lshl_b32 s32, s21, 7
s_cmp_eq_u32 s22, 3
s_cbranch_scc1 L_interleave_layers__linear_kernel_hedgehog__mha_block__prompt_kernel_a_touchwo
v_mul_u32_u24 v230, 6144, v230
s_lshl_b32 s31, s22, 11
s_add_u32 s31, s31, s32
s_mov_b32 s44, s8
s_mov_b32 s45, s9
s_mov_b32 s46, 6291456
s_mov_b32 s47, 0x20000
buffer_load_dword v231, v230, s[44:47], s31 offen
s_branch L_interleave_layers__linear_kernel_hedgehog__mha_block__prompt_kernel_a_notouch
L_interleave_layers__linear_kernel_hedgehog__mha_block__prompt_kernel_a_touchwo:
v_lshlrev_b32 v230, 11, v230
s_mov_b32 s44, s12
s_mov_b32 s45, s13
s_mov_b32 s46, 2097152
s_mov_b32 s47, 0x20000
buffer_load_dword v231, v230, s[44:47], s32 offen
s_mov_b32 s44, s14
s_mov_b32 s45, s15
s_mov_b32 s46, 2097152
s_mov_b32 s47, 0x20000
buffer_load_dword v231, v230, s[44:47], s32 offen
L_interleave_layers__linear_kernel_hedgehog__mha_block__prompt_kernel_a_notouch:
ds_read_b128 v[148:151], v234 offset:512
ds_read_b128 v[152:155], v234 offset:544
ds_read_b128 v[156:159], v234 offset:576
ds_read_b128 v[160:163], v234 offset:608
ds_read_b128 v[164:167], v234 offset:640
ds_read_b128 v[168:171], v234 offset:672
ds_read_b128 v[172:175], v234 offset:704
ds_read_b128 v[176:179], v234 offset:736
v_pk_mul_f32 v[52:53], v[52:53], v[208:209] op_sel_hi:[1,0]
v_pk_mul_f32 v[54:55], v[54:55], v[208:209] op_sel_hi:[1,0]
v_pk_mul_f32 v[56:57], v[56:57], v[208:209] op_sel_hi:[1,0]
v_pk_mul_f32 v[58:59], v[58:59], v[208:209] op_sel_hi:[1,0]
v_pk_mul_f32 v[60:61], v[60:61], v[208:209] op_sel_hi:[1,0]
v_pk_mul_f32 v[62:63], v[62:63], v[208:209] op_sel_hi:[1,0]
v_pk_mul_f32 v[64:65], v[64:65], v[208:209] op_sel_hi:[1,0]
v_pk_mul_f32 v[66:67], v[66:67], v[208:209] op_sel_hi:[1,0]
v_cvt_pk_bf16_f32 v4, v52, v53
v_cvt_pk_bf16_f32 v5, v54, v55
v_cvt_pk_bf16_f32 v6, v56, v57
v_cvt_pk_bf16_f32 v7, v58, v59
v_cvt_pk_bf16_f32 v8, v60, v61
v_cvt_pk_bf16_f32 v9, v62, v63
v_cvt_pk_bf16_f32 v10, v64, v65
v_cvt_pk_bf16_f32 v11, v66, v67
v_pk_mul_f32 v[84:85], v[84:85], v[208:209] op_sel_hi:[1,0]
v_pk_mul_f32 v[86:87], v[86:87], v[208:209] op_sel_hi:[1,0]
v_pk_mul_f32 v[88:89], v[88:89], v[208:209] op_sel_hi:[1,0]
v_pk_mul_f32 v[90:91], v[90:91], v[208:209] op_sel_hi:[1,0]
v_pk_mul_f32 v[92:93], v[92:93], v[208:209] op_sel_hi:[1,0]
v_pk_mul_f32 v[94:95], v[94:95], v[208:209] op_sel_hi:[1,0]
v_pk_mul_f32 v[96:97], v[96:97], v[208:209] op_sel_hi:[1,0]
v_pk_mul_f32 v[98:99], v[98:99], v[208:209] op_sel_hi:[1,0]
v_cvt_pk_bf16_f32 v12, v84, v85
v_cvt_pk_bf16_f32 v13, v86, v87
v_cvt_pk_bf16_f32 v14, v88, v89
v_cvt_pk_bf16_f32 v15, v90, v91
v_cvt_pk_bf16_f32 v16, v92, v93
v_cvt_pk_bf16_f32 v17, v94, v95
v_cvt_pk_bf16_f32 v18, v96, v97
v_cvt_pk_bf16_f32 v19, v98, v99
v_pk_mul_f32 v[68:69], v[68:69], v[208:209] op_sel:[0,1] op_sel_hi:[1,1]
v_pk_mul_f32 v[70:71], v[70:71], v[208:209] op_sel:[0,1] op_sel_hi:[1,1]
v_pk_mul_f32 v[72:73], v[72:73], v[208:209] op_sel:[0,1] op_sel_hi:[1,1]
v_pk_mul_f32 v[74:75], v[74:75], v[208:209] op_sel:[0,1] op_sel_hi:[1,1]
v_pk_mul_f32 v[76:77], v[76:77], v[208:209] op_sel:[0,1] op_sel_hi:[1,1]
v_pk_mul_f32 v[78:79], v[78:79], v[208:209] op_sel:[0,1] op_sel_hi:[1,1]
v_pk_mul_f32 v[80:81], v[80:81], v[208:209] op_sel:[0,1] op_sel_hi:[1,1]
v_pk_mul_f32 v[82:83], v[82:83], v[208:209] op_sel:[0,1] op_sel_hi:[1,1]
v_cvt_pk_bf16_f32 v28, v68, v69
v_cvt_pk_bf16_f32 v29, v70, v71
v_cvt_pk_bf16_f32 v30, v72, v73
v_cvt_pk_bf16_f32 v31, v74, v75
v_cvt_pk_bf16_f32 v32, v76, v77
v_cvt_pk_bf16_f32 v33, v78, v79
v_cvt_pk_bf16_f32 v34, v80, v81
v_cvt_pk_bf16_f32 v35, v82, v83
v_pk_mul_f32 v[100:101], v[100:101], v[208:209] op_sel:[0,1] op_sel_hi:[1,1]
v_pk_mul_f32 v[102:103], v[102:103], v[208:209] op_sel:[0,1] op_sel_hi:[1,1]
v_pk_mul_f32 v[104:105], v[104:105], v[208:209] op_sel:[0,1] op_sel_hi:[1,1]
v_pk_mul_f32 v[106:107], v[106:107], v[208:209] op_sel:[0,1] op_sel_hi:[1,1]
v_pk_mul_f32 v[108:109], v[108:109], v[208:209] op_sel:[0,1] op_sel_hi:[1,1]
v_pk_mul_f32 v[110:111], v[110:111], v[208:209] op_sel:[0,1] op_sel_hi:[1,1]
v_pk_mul_f32 v[112:113], v[112:113], v[208:209] op_sel:[0,1] op_sel_hi:[1,1]
v_pk_mul_f32 v[114:115], v[114:115], v[208:209] op_sel:[0,1] op_sel_hi:[1,1]
v_cvt_pk_bf16_f32 v36, v100, v101
v_cvt_pk_bf16_f32 v37, v102, v103
v_cvt_pk_bf16_f32 v38, v104, v105
v_cvt_pk_bf16_f32 v39, v106, v107
v_cvt_pk_bf16_f32 v40, v108, v109
v_cvt_pk_bf16_f32 v41, v110, v111
v_cvt_pk_bf16_f32 v42, v112, v113
v_cvt_pk_bf16_f32 v43, v114, v115
s_waitcnt lgkmcnt(0)
v_pk_mul_f32 v[116:117], v[116:117], v[148:149]
v_pk_mul_f32 v[118:119], v[118:119], v[150:151]
v_pk_mul_f32 v[120:121], v[120:121], v[152:153]
v_pk_mul_f32 v[122:123], v[122:123], v[154:155]
v_pk_mul_f32 v[124:125], v[124:125], v[156:157]
v_pk_mul_f32 v[126:127], v[126:127], v[158:159]
v_pk_mul_f32 v[128:129], v[128:129], v[160:161]
v_pk_mul_f32 v[130:131], v[130:131], v[162:163]
v_cvt_pk_bf16_f32 v20, v116, v117
v_cvt_pk_bf16_f32 v21, v118, v119
v_cvt_pk_bf16_f32 v22, v120, v121
v_cvt_pk_bf16_f32 v23, v122, v123
v_cvt_pk_bf16_f32 v24, v124, v125
v_cvt_pk_bf16_f32 v25, v126, v127
v_cvt_pk_bf16_f32 v26, v128, v129
v_cvt_pk_bf16_f32 v27, v130, v131
v_pk_mul_f32 v[132:133], v[132:133], v[164:165]
v_pk_mul_f32 v[134:135], v[134:135], v[166:167]
v_pk_mul_f32 v[136:137], v[136:137], v[168:169]
v_pk_mul_f32 v[138:139], v[138:139], v[170:171]
v_pk_mul_f32 v[140:141], v[140:141], v[172:173]
v_pk_mul_f32 v[142:143], v[142:143], v[174:175]
v_pk_mul_f32 v[144:145], v[144:145], v[176:177]
v_pk_mul_f32 v[146:147], v[146:147], v[178:179]
v_cvt_pk_bf16_f32 v44, v132, v133
v_cvt_pk_bf16_f32 v45, v134, v135
v_cvt_pk_bf16_f32 v46, v136, v137
v_cvt_pk_bf16_f32 v47, v138, v139
v_cvt_pk_bf16_f32 v48, v140, v141
v_cvt_pk_bf16_f32 v49, v142, v143
v_cvt_pk_bf16_f32 v50, v144, v145
v_cvt_pk_bf16_f32 v51, v146, v147
s_mul_i32 s31, s22, 6144
s_add_u32 s31, s31, 8192
v_add_u32 v1, s31, v239
ds_write_b128 v1, v[28:31] offset:0
ds_write_b128 v1, v[32:35] offset:1024
ds_write_b128 v1, v[36:39] offset:2048
ds_write_b128 v1, v[40:43] offset:3072
ds_write_b128 v1, v[44:47] offset:4096
ds_write_b128 v1, v[48:51] offset:5120
s_waitcnt lgkmcnt(0)
s_barrier
s_branch L_interleave_layers__linear_kernel_hedgehog__mha_block__prompt_kernel_a_mix
L_interleave_layers__linear_kernel_hedgehog__mha_block__prompt_kernel_cB:
ds_read_b128 v[148:151], v234 offset:512
ds_read_b128 v[152:155], v234 offset:544
ds_read_b128 v[156:159], v234 offset:576
ds_read_b128 v[160:163], v234 offset:608
ds_read_b128 v[164:167], v234 offset:640
ds_read_b128 v[168:171], v234 offset:672
ds_read_b128 v[172:175], v234 offset:704
ds_read_b128 v[176:179], v234 offset:736
v_mul_f32 v212, 0x3e8293ee, v208
v_mul_f32 v213, 0x3e8293ee, v209
v_pk_mul_f32 v[84:85], v[84:85], v[208:209] op_sel_hi:[1,0]
v_pk_mul_f32 v[86:87], v[86:87], v[208:209] op_sel_hi:[1,0]
v_pk_mul_f32 v[88:89], v[88:89], v[208:209] op_sel_hi:[1,0]
v_pk_mul_f32 v[90:91], v[90:91], v[208:209] op_sel_hi:[1,0]
v_pk_mul_f32 v[92:93], v[92:93], v[208:209] op_sel_hi:[1,0]
v_pk_mul_f32 v[94:95], v[94:95], v[208:209] op_sel_hi:[1,0]
v_pk_mul_f32 v[96:97], v[96:97], v[208:209] op_sel_hi:[1,0]
v_pk_mul_f32 v[98:99], v[98:99], v[208:209] op_sel_hi:[1,0]
v_cvt_pk_bf16_f32 v12, v84, v85
v_cvt_pk_bf16_f32 v13, v86, v87
v_cvt_pk_bf16_f32 v14, v88, v89
v_cvt_pk_bf16_f32 v15, v90, v91
v_cvt_pk_bf16_f32 v16, v92, v93
v_cvt_pk_bf16_f32 v17, v94, v95
v_cvt_pk_bf16_f32 v18, v96, v97
v_cvt_pk_bf16_f32 v19, v98, v99
v_pk_mul_f32 v[100:101], v[100:101], v[208:209] op_sel:[0,1] op_sel_hi:[1,1]
v_pk_mul_f32 v[102:103], v[102:103], v[208:209] op_sel:[0,1] op_sel_hi:[1,1]
v_pk_mul_f32 v[104:105], v[104:105], v[208:209] op_sel:[0,1] op_sel_hi:[1,1]
v_pk_mul_f32 v[106:107], v[106:107], v[208:209] op_sel:[0,1] op_sel_hi:[1,1]
v_pk_mul_f32 v[108:109], v[108:109], v[208:209] op_sel:[0,1] op_sel_hi:[1,1]
v_pk_mul_f32 v[110:111], v[110:111], v[208:209] op_sel:[0,1] op_sel_hi:[1,1]
v_pk_mul_f32 v[112:113], v[112:113], v[208:209] op_sel:[0,1] op_sel_hi:[1,1]
v_pk_mul_f32 v[114:115], v[114:115], v[208:209] op_sel:[0,1] op_sel_hi:[1,1]
v_cvt_pk_bf16_f32 v36, v100, v101
v_cvt_pk_bf16_f32 v37, v102, v103
v_cvt_pk_bf16_f32 v38, v104, v105
v_cvt_pk_bf16_f32 v39, v106, v107
v_cvt_pk_bf16_f32 v40, v108, v109
v_cvt_pk_bf16_f32 v41, v110, v111
v_cvt_pk_bf16_f32 v42, v112, v113
v_cvt_pk_bf16_f32 v43, v114, v115
s_waitcnt lgkmcnt(0)
v_pk_mul_f32 v[116:117], v[116:117], v[148:149]
v_pk_mul_f32 v[118:119], v[118:119], v[150:151]
v_pk_mul_f32 v[120:121], v[120:121], v[152:153]
v_pk_mul_f32 v[122:123], v[122:123], v[154:155]
v_pk_mul_f32 v[124:125], v[124:125], v[156:157]
v_pk_mul_f32 v[126:127], v[126:127], v[158:159]
v_pk_mul_f32 v[128:129], v[128:129], v[160:161]
v_pk_mul_f32 v[130:131], v[130:131], v[162:163]
v_cvt_pk_bf16_f32 v20, v116, v117
v_cvt_pk_bf16_f32 v21, v118, v119
v_cvt_pk_bf16_f32 v22, v120, v121
v_cvt_pk_bf16_f32 v23, v122, v123
v_cvt_pk_bf16_f32 v24, v124, v125
v_cvt_pk_bf16_f32 v25, v126, v127
v_cvt_pk_bf16_f32 v26, v128, v129
v_cvt_pk_bf16_f32 v27, v130, v131
v_pk_mul_f32 v[132:133], v[132:133], v[164:165]
v_pk_mul_f32 v[134:135], v[134:135], v[166:167]
v_pk_mul_f32 v[136:137], v[136:137], v[168:169]
v_pk_mul_f32 v[138:139], v[138:139], v[170:171]
v_pk_mul_f32 v[140:141], v[140:141], v[172:173]
v_pk_mul_f32 v[142:143], v[142:143], v[174:175]
v_pk_mul_f32 v[144:145], v[144:145], v[176:177]
v_pk_mul_f32 v[146:147], v[146:147], v[178:179]
v_cvt_pk_bf16_f32 v44, v132, v133
v_cvt_pk_bf16_f32 v45, v134, v135
v_cvt_pk_bf16_f32 v46, v136, v137
v_cvt_pk_bf16_f32 v47, v138, v139
v_cvt_pk_bf16_f32 v48, v140, v141
v_cvt_pk_bf16_f32 v49, v142, v143
v_cvt_pk_bf16_f32 v50, v144, v145
v_cvt_pk_bf16_f32 v51, v146, v147
s_lshl_b32 s31, s23, 14
s_add_u32 s31, s31, 8192
v_add_u32 v210, s31, v239
s_lshl_b32 s32, s26, 13
v_add_u32 v211, s32, v210
s_mul_i32 s31, s30, 8388608
s_add_u32 s31, s31, 33554432
s_add_u32 s36, s4, s31
s_addc_u32 s37, s5, 0
s_mov_b32 s38, 8388608
s_mov_b32 s39, 0x20000
s_lshl_b32 s31, s25, 18
s_lshl_b32 s32, s20, 14
s_add_u32 s31, s31, s32
s_lshl_b32 s32, s26, 13
s_add_u32 s31, s31, s32
s_add_u32 s32, s31, 4096
buffer_store_dwordx4 v[12:15], v239, s[36:39], s31 offen offset:0 sc1
buffer_store_dwordx4 v[16:19], v239, s[36:39], s31 offen offset:1024 sc1
buffer_store_dwordx4 v[20:23], v239, s[36:39], s31 offen offset:2048 sc1
buffer_store_dwordx4 v[24:27], v239, s[36:39], s31 offen offset:3072 sc1
buffer_store_dwordx4 v[36:39], v239, s[36:39], s32 offen offset:0 sc1
buffer_store_dwordx4 v[40:43], v239, s[36:39], s32 offen offset:1024 sc1
buffer_store_dwordx4 v[44:47], v239, s[36:39], s32 offen offset:2048 sc1
buffer_store_dwordx4 v[48:51], v239, s[36:39], s32 offen offset:3072 sc1
ds_write_b128 v211, v[12:15] offset:0
ds_write_b128 v211, v[16:19] offset:1024
ds_write_b128 v211, v[20:23] offset:2048
ds_write_b128 v211, v[24:27] offset:3072
ds_write_b128 v211, v[36:39] offset:4096
ds_write_b128 v211, v[40:43] offset:5120
ds_write_b128 v211, v[44:47] offset:6144
ds_write_b128 v211, v[48:51] offset:7168
v_pk_mul_f32 v[52:53], v[52:53], v[212:213] op_sel_hi:[1,0]
v_pk_mul_f32 v[54:55], v[54:55], v[212:213] op_sel_hi:[1,0]
v_pk_mul_f32 v[56:57], v[56:57], v[212:213] op_sel_hi:[1,0]
v_pk_mul_f32 v[58:59], v[58:59], v[212:213] op_sel_hi:[1,0]
v_pk_mul_f32 v[60:61], v[60:61], v[212:213] op_sel_hi:[1,0]
v_pk_mul_f32 v[62:63], v[62:63], v[212:213] op_sel_hi:[1,0]
v_pk_mul_f32 v[64:65], v[64:65], v[212:213] op_sel_hi:[1,0]
v_pk_mul_f32 v[66:67], v[66:67], v[212:213] op_sel_hi:[1,0]
v_cvt_pk_bf16_f32 v4, v52, v53
v_cvt_pk_bf16_f32 v5, v54, v55
v_cvt_pk_bf16_f32 v6, v56, v57
v_cvt_pk_bf16_f32 v7, v58, v59
v_cvt_pk_bf16_f32 v8, v60, v61
v_cvt_pk_bf16_f32 v9, v62, v63
v_cvt_pk_bf16_f32 v10, v64, v65
v_cvt_pk_bf16_f32 v11, v66, v67
v_pk_mul_f32 v[68:69], v[68:69], v[212:213] op_sel:[0,1] op_sel_hi:[1,1]
v_pk_mul_f32 v[70:71], v[70:71], v[212:213] op_sel:[0,1] op_sel_hi:[1,1]
v_pk_mul_f32 v[72:73], v[72:73], v[212:213] op_sel:[0,1] op_sel_hi:[1,1]
v_pk_mul_f32 v[74:75], v[74:75], v[212:213] op_sel:[0,1] op_sel_hi:[1,1]
v_pk_mul_f32 v[76:77], v[76:77], v[212:213] op_sel:[0,1] op_sel_hi:[1,1]
v_pk_mul_f32 v[78:79], v[78:79], v[212:213] op_sel:[0,1] op_sel_hi:[1,1]
v_pk_mul_f32 v[80:81], v[80:81], v[212:213] op_sel:[0,1] op_sel_hi:[1,1]
v_pk_mul_f32 v[82:83], v[82:83], v[212:213] op_sel:[0,1] op_sel_hi:[1,1]
v_cvt_pk_bf16_f32 v28, v68, v69
v_cvt_pk_bf16_f32 v29, v70, v71
v_cvt_pk_bf16_f32 v30, v72, v73
v_cvt_pk_bf16_f32 v31, v74, v75
v_cvt_pk_bf16_f32 v32, v76, v77
v_cvt_pk_bf16_f32 v33, v78, v79
v_cvt_pk_bf16_f32 v34, v80, v81
v_cvt_pk_bf16_f32 v35, v82, v83
v_and_b32 v211, 7, v0
v_bfe_u32 v212, v0, 4, 1
v_lshlrev_b32 v212, 2, v212
v_cmp_eq_u32 vcc, v211, v212
v_mov_b32 v211, 0
v_mov_b32 v212, 0x3f803f80
v_cndmask_b32 v204, v211, v212, vcc
v_mov_b32 v205, v204
v_mov_b32 v206, v204
v_mov_b32 v207, v204
s_mov_b32 s69, 0
s_waitcnt lgkmcnt(0)
s_barrier
L_interleave_layers__linear_kernel_hedgehog__mha_block__prompt_kernel_b_att:
v_mov_b32 v132, 0
v_mov_b32 v133, 0
v_mov_b32 v134, 0
v_mov_b32 v135, 0
v_mov_b32 v136, 0
v_mov_b32 v137, 0
v_mov_b32 v138, 0
v_mov_b32 v139, 0
v_mov_b32 v140, 0
v_mov_b32 v141, 0
v_mov_b32 v142, 0
v_mov_b32 v143, 0
v_mov_b32 v144, 0
v_mov_b32 v145, 0
v_mov_b32 v146, 0
v_mov_b32 v147, 0
v_mov_b32 v196, 0
v_mov_b32 v197, 0
v_mov_b32 v198, 0
v_mov_b32 v199, 0
v_mov_b32 v148, 0
v_mov_b32 v149, 0
v_mov_b32 v150, 0
v_mov_b32 v151, 0
v_mov_b32 v152, 0
v_mov_b32 v153, 0
v_mov_b32 v154, 0
v_mov_b32 v155, 0
v_mov_b32 v156, 0
v_mov_b32 v157, 0
v_mov_b32 v158, 0
v_mov_b32 v159, 0
v_mov_b32 v160, 0
v_mov_b32 v161, 0
v_mov_b32 v162, 0
v_mov_b32 v163, 0
v_mov_b32 v200, 0
v_mov_b32 v201, 0
v_mov_b32 v202, 0
v_mov_b32 v203, 0
s_mov_b32 s65, 32768
v_mov_b32 v208, v210
v_add_u32 v209, s65, v210
ds_read_b128 v[12:15], v208 offset:0
ds_read_b128 v[16:19], v208 offset:1024
ds_read_b128 v[20:23], v208 offset:4096
ds_read_b128 v[24:27], v208 offset:5120
ds_read_b128 v[36:39], v208 offset:2048
ds_read_b128 v[40:43], v208 offset:3072
s_waitcnt lgkmcnt(0)
s_cmp_lg_u32 s69, 0
s_cbranch_scc1 L_interleave_layers__linear_kernel_hedgehog__mha_block__prompt_kernel_b_havec
v_mfma_f32_32x32x16_bf16 v[52:67], v[12:15], v[4:7], 0
v_mfma_f32_32x32x16_bf16 v[52:67], v[16:19], v[8:11], v[52:67]
v_mfma_f32_32x32x16_bf16 v[84:99], v[12:15], v[28:31], 0
v_mfma_f32_32x32x16_bf16 v[84:99], v[16:19], v[32:35], v[84:99]
s_nop 9
v_max3_f32 v211, v52, v53, v54
v_max3_f32 v211, v211, v55, v56
v_max3_f32 v211, v211, v57, v58
v_max3_f32 v211, v211, v59, v60
v_max3_f32 v211, v211, v61, v62
v_max3_f32 v211, v211, v63, v64
v_max3_f32 v211, v211, v65, v66
v_max_f32 v211, v211, v67
v_mov_b32 v212, v211
s_nop 1
v_permlane32_swap_b32 v212, v211
v_max_f32 v211, v211, v212
v_add_f32 v211, 0x42200000, v211
v_sub_f32 v164, 0, v211
v_sub_f32 v165, 0, v211
v_sub_f32 v166, 0, v211
v_sub_f32 v167, 0, v211
v_sub_f32 v168, 0, v211
v_sub_f32 v169, 0, v211
v_sub_f32 v170, 0, v211
v_sub_f32 v171, 0, v211
v_sub_f32 v172, 0, v211
v_sub_f32 v173, 0, v211
v_sub_f32 v174, 0, v211
v_sub_f32 v175, 0, v211
v_sub_f32 v176, 0, v211
v_sub_f32 v177, 0, v211
v_sub_f32 v178, 0, v211
v_sub_f32 v179, 0, v211
v_max3_f32 v211, v84, v85, v86
v_max3_f32 v211, v211, v87, v88
v_max3_f32 v211, v211, v89, v90
v_max3_f32 v211, v211, v91, v92
v_max3_f32 v211, v211, v93, v94
v_max3_f32 v211, v211, v95, v96
v_max3_f32 v211, v211, v97, v98
v_max_f32 v211, v211, v99
v_mov_b32 v212, v211
s_nop 1
v_permlane32_swap_b32 v212, v211
v_max_f32 v211, v211, v212
v_add_f32 v211, 0x42200000, v211
v_sub_f32 v180, 0, v211
v_sub_f32 v181, 0, v211
v_sub_f32 v182, 0, v211
v_sub_f32 v183, 0, v211
v_sub_f32 v184, 0, v211
v_sub_f32 v185, 0, v211
v_sub_f32 v186, 0, v211
v_sub_f32 v187, 0, v211
v_sub_f32 v188, 0, v211
v_sub_f32 v189, 0, v211
v_sub_f32 v190, 0, v211
v_sub_f32 v191, 0, v211
v_sub_f32 v192, 0, v211
v_sub_f32 v193, 0, v211
v_sub_f32 v194, 0, v211
v_sub_f32 v195, 0, v211
v_mov_b32 v211, 1
v_mov_b32 v212, 2112
s_waitcnt vmcnt(0)
s_mov_b64 exec, 1
ds_add_u32 v212, v211
s_mov_b64 exec, -1
L_interleave_layers__linear_kernel_hedgehog__mha_block__prompt_kernel_b_havec:
v_mfma_f32_32x32x16_bf16 v[52:67], v[12:15], v[4:7], v[164:179]
v_mfma_f32_32x32x16_bf16 v[52:67], v[16:19], v[8:11], v[52:67]
v_mfma_f32_32x32x16_bf16 v[84:99], v[12:15], v[28:31], v[180:195]
v_mfma_f32_32x32x16_bf16 v[84:99], v[16:19], v[32:35], v[84:99]
s_nop 11
s_waitcnt lgkmcnt(0)
v_exp_f32 v52, v52
ds_read_b128 v[12:15], v208 offset:8192
v_exp_f32 v53, v53
v_exp_f32 v54, v54
v_exp_f32 v55, v55
v_cvt_pk_bf16_f32 v116, v52, v53
v_exp_f32 v56, v56
v_mfma_f32_32x32x16_bf16 v[68:83], v[20:23], v[4:7], v[164:179]
ds_read_b128 v[16:19], v208 offset:9216
v_exp_f32 v57, v57
v_cvt_pk_bf16_f32 v117, v54, v55
v_exp_f32 v58, v58
v_exp_f32 v59, v59
v_mfma_f32_32x32x16_bf16 v[100:115], v[20:23], v[28:31], v[180:195]
ds_read_b128 v[44:47], v208 offset:6144
v_cvt_pk_bf16_f32 v118, v56, v57
v_cvt_pk_bf16_f32 v119, v58, v59
v_exp_f32 v84, v84
v_exp_f32 v85, v85
v_mfma_f32_32x32x16_bf16 v[132:147], v[36:39], v[116:119], v[132:147]
ds_read_b128 v[48:51], v208 offset:7168
v_exp_f32 v86, v86
v_exp_f32 v87, v87
v_exp_f32 v88, v88
v_mfma_f32_16x16x32_bf16 v[196:199], v[204:207], v[116:119], v[196:199]
v_cvt_pk_bf16_f32 v124, v84, v85
v_exp_f32 v89, v89
v_mfma_f32_32x32x16_bf16 v[68:83], v[24:27], v[8:11], v[68:83]
v_exp_f32 v90, v90
v_cvt_pk_bf16_f32 v125, v86, v87
v_exp_f32 v91, v91
v_cvt_pk_bf16_f32 v126, v88, v89
v_mfma_f32_32x32x16_bf16 v[100:115], v[24:27], v[32:35], v[100:115]
v_cvt_pk_bf16_f32 v127, v90, v91
v_exp_f32 v60, v60
v_exp_f32 v61, v61
v_exp_f32 v62, v62
v_mfma_f32_32x32x16_bf16 v[148:163], v[36:39], v[124:127], v[148:163]
v_exp_f32 v63, v63
v_cvt_pk_bf16_f32 v120, v60, v61
v_exp_f32 v64, v64
v_exp_f32 v65, v65
v_mfma_f32_16x16x32_bf16 v[200:203], v[204:207], v[124:127], v[200:203]
v_cvt_pk_bf16_f32 v121, v62, v63
v_exp_f32 v66, v66
v_exp_f32 v67, v67
v_cvt_pk_bf16_f32 v122, v64, v65
v_exp_f32 v92, v92
v_cvt_pk_bf16_f32 v123, v66, v67
v_exp_f32 v93, v93
v_exp_f32 v94, v94
v_mfma_f32_32x32x16_bf16 v[132:147], v[40:43], v[120:123], v[132:147]
v_exp_f32 v95, v95
v_cvt_pk_bf16_f32 v128, v92, v93
v_exp_f32 v96, v96
v_exp_f32 v97, v97
v_mfma_f32_16x16x32_bf16 v[196:199], v[204:207], v[120:123], v[196:199]
v_cvt_pk_bf16_f32 v129, v94, v95
v_exp_f32 v98, v98
v_exp_f32 v99, v99
v_cvt_pk_bf16_f32 v130, v96, v97
v_cvt_pk_bf16_f32 v131, v98, v99
s_waitcnt lgkmcnt(0)
v_exp_f32 v68, v68
v_mfma_f32_32x32x16_bf16 v[148:163], v[40:43], v[128:131], v[148:163]
ds_read_b128 v[20:23], v208 offset:12288
v_exp_f32 v69, v69
v_exp_f32 v70, v70
v_exp_f32 v71, v71
v_mfma_f32_16x16x32_bf16 v[200:203], v[204:207], v[128:131], v[200:203]
v_cvt_pk_bf16_f32 v116, v68, v69
v_exp_f32 v72, v72
v_mfma_f32_32x32x16_bf16 v[52:67], v[12:15], v[4:7], v[164:179]
ds_read_b128 v[24:27], v208 offset:13312
v_exp_f32 v73, v73
v_cvt_pk_bf16_f32 v117, v70, v71
v_exp_f32 v74, v74
v_exp_f32 v75, v75
v_mfma_f32_32x32x16_bf16 v[84:99], v[12:15], v[28:31], v[180:195]
ds_read_b128 v[36:39], v208 offset:10240
v_cvt_pk_bf16_f32 v118, v72, v73
v_cvt_pk_bf16_f32 v119, v74, v75
v_exp_f32 v100, v100
v_exp_f32 v101, v101
v_mfma_f32_32x32x16_bf16 v[132:147], v[44:47], v[116:119], v[132:147]
ds_read_b128 v[40:43], v208 offset:11264
v_exp_f32 v102, v102
v_exp_f32 v103, v103
v_exp_f32 v104, v104
v_mfma_f32_16x16x32_bf16 v[196:199], v[204:207], v[116:119], v[196:199]
v_cvt_pk_bf16_f32 v124, v100, v101
v_exp_f32 v105, v105
v_mfma_f32_32x32x16_bf16 v[52:67], v[16:19], v[8:11], v[52:67]
v_exp_f32 v106, v106
v_cvt_pk_bf16_f32 v125, v102, v103
v_exp_f32 v107, v107
v_cvt_pk_bf16_f32 v126, v104, v105
v_mfma_f32_32x32x16_bf16 v[84:99], v[16:19], v[32:35], v[84:99]
v_cvt_pk_bf16_f32 v127, v106, v107
v_exp_f32 v76, v76
v_exp_f32 v77, v77
v_exp_f32 v78, v78
v_mfma_f32_32x32x16_bf16 v[148:163], v[44:47], v[124:127], v[148:163]
v_exp_f32 v79, v79
v_cvt_pk_bf16_f32 v120, v76, v77
v_exp_f32 v80, v80
v_exp_f32 v81, v81
v_mfma_f32_16x16x32_bf16 v[200:203], v[204:207], v[124:127], v[200:203]
v_cvt_pk_bf16_f32 v121, v78, v79
v_exp_f32 v82, v82
v_exp_f32 v83, v83
v_cvt_pk_bf16_f32 v122, v80, v81
v_exp_f32 v108, v108
v_cvt_pk_bf16_f32 v123, v82, v83
v_exp_f32 v109, v109
v_exp_f32 v110, v110
v_mfma_f32_32x32x16_bf16 v[132:147], v[48:51], v[120:123], v[132:147]
v_exp_f32 v111, v111
v_cvt_pk_bf16_f32 v128, v108, v109
v_exp_f32 v112, v112
v_exp_f32 v113, v113
v_mfma_f32_16x16x32_bf16 v[196:199], v[204:207], v[120:123], v[196:199]
v_cvt_pk_bf16_f32 v129, v110, v111
v_exp_f32 v114, v114
v_exp_f32 v115, v115
v_cvt_pk_bf16_f32 v130, v112, v113
v_cvt_pk_bf16_f32 v131, v114, v115
s_waitcnt lgkmcnt(0)
v_exp_f32 v52, v52
v_mfma_f32_32x32x16_bf16 v[148:163], v[48:51], v[128:131], v[148:163]
v_exp_f32 v53, v53
v_exp_f32 v54, v54
v_exp_f32 v55, v55
v_mfma_f32_16x16x32_bf16 v[200:203], v[204:207], v[128:131], v[200:203]
v_cvt_pk_bf16_f32 v116, v52, v53
v_exp_f32 v56, v56
v_mfma_f32_32x32x16_bf16 v[68:83], v[20:23], v[4:7], v[164:179]
v_exp_f32 v57, v57
v_cvt_pk_bf16_f32 v117, v54, v55
v_exp_f32 v58, v58
v_exp_f32 v59, v59
v_mfma_f32_32x32x16_bf16 v[100:115], v[20:23], v[28:31], v[180:195]
ds_read_b128 v[44:47], v208 offset:14336
v_cvt_pk_bf16_f32 v118, v56, v57
v_cvt_pk_bf16_f32 v119, v58, v59
v_exp_f32 v84, v84
v_exp_f32 v85, v85
v_mfma_f32_32x32x16_bf16 v[132:147], v[36:39], v[116:119], v[132:147]
ds_read_b128 v[48:51], v208 offset:15360
v_exp_f32 v86, v86
v_exp_f32 v87, v87
v_exp_f32 v88, v88
v_mfma_f32_16x16x32_bf16 v[196:199], v[204:207], v[116:119], v[196:199]
v_cvt_pk_bf16_f32 v124, v84, v85
v_exp_f32 v89, v89
v_mfma_f32_32x32x16_bf16 v[68:83], v[24:27], v[8:11], v[68:83]
v_exp_f32 v90, v90
v_cvt_pk_bf16_f32 v125, v86, v87
v_exp_f32 v91, v91
v_cvt_pk_bf16_f32 v126, v88, v89
v_mfma_f32_32x32x16_bf16 v[100:115], v[24:27], v[32:35], v[100:115]
v_cvt_pk_bf16_f32 v127, v90, v91
v_exp_f32 v60, v60
v_exp_f32 v61, v61
v_exp_f32 v62, v62
v_mfma_f32_32x32x16_bf16 v[148:163], v[36:39], v[124:127], v[148:163]
v_exp_f32 v63, v63
v_cvt_pk_bf16_f32 v120, v60, v61
v_exp_f32 v64, v64
v_exp_f32 v65, v65
v_mfma_f32_16x16x32_bf16 v[200:203], v[204:207], v[124:127], v[200:203]
v_cvt_pk_bf16_f32 v121, v62, v63
v_exp_f32 v66, v66
v_exp_f32 v67, v67
v_cvt_pk_bf16_f32 v122, v64, v65
v_exp_f32 v92, v92
v_cvt_pk_bf16_f32 v123, v66, v67
v_exp_f32 v93, v93
v_exp_f32 v94, v94
v_mfma_f32_32x32x16_bf16 v[132:147], v[40:43], v[120:123], v[132:147]
v_exp_f32 v95, v95
v_cvt_pk_bf16_f32 v128, v92, v93
v_exp_f32 v96, v96
v_exp_f32 v97, v97
v_mfma_f32_16x16x32_bf16 v[196:199], v[204:207], v[120:123], v[196:199]
v_cvt_pk_bf16_f32 v129, v94, v95
v_exp_f32 v98, v98
v_exp_f32 v99, v99
v_cvt_pk_bf16_f32 v130, v96, v97
v_cvt_pk_bf16_f32 v131, v98, v99
s_waitcnt lgkmcnt(0)
v_exp_f32 v68, v68
v_mfma_f32_32x32x16_bf16 v[148:163], v[40:43], v[128:131], v[148:163]
v_exp_f32 v69, v69
v_exp_f32 v70, v70
v_exp_f32 v71, v71
v_mfma_f32_16x16x32_bf16 v[200:203], v[204:207], v[128:131], v[200:203]
v_cvt_pk_bf16_f32 v116, v68, v69
v_exp_f32 v72, v72
v_exp_f32 v73, v73
v_cvt_pk_bf16_f32 v117, v70, v71
v_exp_f32 v74, v74
v_exp_f32 v75, v75
v_cvt_pk_bf16_f32 v118, v72, v73
v_cvt_pk_bf16_f32 v119, v74, v75
v_exp_f32 v100, v100
v_exp_f32 v101, v101
v_mfma_f32_32x32x16_bf16 v[132:147], v[44:47], v[116:119], v[132:147]
v_exp_f32 v102, v102
v_exp_f32 v103, v103
v_exp_f32 v104, v104
v_mfma_f32_16x16x32_bf16 v[196:199], v[204:207], v[116:119], v[196:199]
v_cvt_pk_bf16_f32 v124, v100, v101
v_exp_f32 v105, v105
v_exp_f32 v106, v106
v_cvt_pk_bf16_f32 v125, v102, v103
v_exp_f32 v107, v107
v_cvt_pk_bf16_f32 v126, v104, v105
v_cvt_pk_bf16_f32 v127, v106, v107
v_exp_f32 v76, v76
v_exp_f32 v77, v77
v_exp_f32 v78, v78
v_mfma_f32_32x32x16_bf16 v[148:163], v[44:47], v[124:127], v[148:163]
v_exp_f32 v79, v79
v_cvt_pk_bf16_f32 v120, v76, v77
v_exp_f32 v80, v80
v_exp_f32 v81, v81
v_mfma_f32_16x16x32_bf16 v[200:203], v[204:207], v[124:127], v[200:203]
v_cvt_pk_bf16_f32 v121, v78, v79
v_exp_f32 v82, v82
v_exp_f32 v83, v83
v_cvt_pk_bf16_f32 v122, v80, v81
v_exp_f32 v108, v108
v_cvt_pk_bf16_f32 v123, v82, v83
v_exp_f32 v109, v109
v_exp_f32 v110, v110
v_mfma_f32_32x32x16_bf16 v[132:147], v[48:51], v[120:123], v[132:147]
v_exp_f32 v111, v111
v_cvt_pk_bf16_f32 v128, v108, v109
v_exp_f32 v112, v112
v_exp_f32 v113, v113
v_mfma_f32_16x16x32_bf16 v[196:199], v[204:207], v[120:123], v[196:199]
v_cvt_pk_bf16_f32 v129, v110, v111
v_exp_f32 v114, v114
v_exp_f32 v115, v115
v_cvt_pk_bf16_f32 v130, v112, v113
v_cvt_pk_bf16_f32 v131, v114, v115
s_nop 1
v_mfma_f32_32x32x16_bf16 v[148:163], v[48:51], v[128:131], v[148:163]
v_mfma_f32_16x16x32_bf16 v[200:203], v[204:207], v[128:131], v[200:203]
s_barrier
s_add_u32 s65, s65, 32768
s_and_b32 s65, s65, 0x1ffff
v_mov_b32 v208, v209
v_add_u32 v209, s65, v210
ds_read_b128 v[12:15], v208 offset:0
ds_read_b128 v[16:19], v208 offset:1024
ds_read_b128 v[20:23], v208 offset:4096
ds_read_b128 v[24:27], v208 offset:5120
ds_read_b128 v[36:39], v208 offset:2048
ds_read_b128 v[40:43], v208 offset:3072
s_waitcnt lgkmcnt(0)
v_mfma_f32_32x32x16_bf16 v[52:67], v[12:15], v[4:7], v[164:179]
v_mfma_f32_32x32x16_bf16 v[52:67], v[16:19], v[8:11], v[52:67]
v_mfma_f32_32x32x16_bf16 v[84:99], v[12:15], v[28:31], v[180:195]
v_mfma_f32_32x32x16_bf16 v[84:99], v[16:19], v[32:35], v[84:99]
s_nop 11
s_waitcnt lgkmcnt(0)
v_exp_f32 v52, v52
ds_read_b128 v[12:15], v208 offset:8192
v_exp_f32 v53, v53
v_exp_f32 v54, v54
v_exp_f32 v55, v55
v_cvt_pk_bf16_f32 v116, v52, v53
v_exp_f32 v56, v56
v_mfma_f32_32x32x16_bf16 v[68:83], v[20:23], v[4:7], v[164:179]
ds_read_b128 v[16:19], v208 offset:9216
v_exp_f32 v57, v57
v_cvt_pk_bf16_f32 v117, v54, v55
v_exp_f32 v58, v58
v_exp_f32 v59, v59
v_mfma_f32_32x32x16_bf16 v[100:115], v[20:23], v[28:31], v[180:195]
ds_read_b128 v[44:47], v208 offset:6144
v_cvt_pk_bf16_f32 v118, v56, v57
v_cvt_pk_bf16_f32 v119, v58, v59
v_exp_f32 v84, v84
v_exp_f32 v85, v85
v_mfma_f32_32x32x16_bf16 v[132:147], v[36:39], v[116:119], v[132:147]
ds_read_b128 v[48:51], v208 offset:7168
v_exp_f32 v86, v86
v_exp_f32 v87, v87
v_exp_f32 v88, v88
v_mfma_f32_16x16x32_bf16 v[196:199], v[204:207], v[116:119], v[196:199]
v_cvt_pk_bf16_f32 v124, v84, v85
v_exp_f32 v89, v89
v_mfma_f32_32x32x16_bf16 v[68:83], v[24:27], v[8:11], v[68:83]
v_exp_f32 v90, v90
v_cvt_pk_bf16_f32 v125, v86, v87
v_exp_f32 v91, v91
v_cvt_pk_bf16_f32 v126, v88, v89
v_mfma_f32_32x32x16_bf16 v[100:115], v[24:27], v[32:35], v[100:115]
v_cvt_pk_bf16_f32 v127, v90, v91
v_exp_f32 v60, v60
v_exp_f32 v61, v61
v_exp_f32 v62, v62
v_mfma_f32_32x32x16_bf16 v[148:163], v[36:39], v[124:127], v[148:163]
v_exp_f32 v63, v63
v_cvt_pk_bf16_f32 v120, v60, v61
v_exp_f32 v64, v64
v_exp_f32 v65, v65
v_mfma_f32_16x16x32_bf16 v[200:203], v[204:207], v[124:127], v[200:203]
v_cvt_pk_bf16_f32 v121, v62, v63
v_exp_f32 v66, v66
v_exp_f32 v67, v67
v_cvt_pk_bf16_f32 v122, v64, v65
v_exp_f32 v92, v92
v_cvt_pk_bf16_f32 v123, v66, v67
v_exp_f32 v93, v93
v_exp_f32 v94, v94
v_mfma_f32_32x32x16_bf16 v[132:147], v[40:43], v[120:123], v[132:147]
v_exp_f32 v95, v95
v_cvt_pk_bf16_f32 v128, v92, v93
v_exp_f32 v96, v96
v_exp_f32 v97, v97
v_mfma_f32_16x16x32_bf16 v[196:199], v[204:207], v[120:123], v[196:199]
v_cvt_pk_bf16_f32 v129, v94, v95
v_exp_f32 v98, v98
v_exp_f32 v99, v99
v_cvt_pk_bf16_f32 v130, v96, v97
v_cvt_pk_bf16_f32 v131, v98, v99
s_waitcnt lgkmcnt(0)
v_exp_f32 v68, v68
v_mfma_f32_32x32x16_bf16 v[148:163], v[40:43], v[128:131], v[148:163]
ds_read_b128 v[20:23], v208 offset:12288
v_exp_f32 v69, v69
v_exp_f32 v70, v70
v_exp_f32 v71, v71
v_mfma_f32_16x16x32_bf16 v[200:203], v[204:207], v[128:131], v[200:203]
v_cvt_pk_bf16_f32 v116, v68, v69
v_exp_f32 v72, v72
v_mfma_f32_32x32x16_bf16 v[52:67], v[12:15], v[4:7], v[164:179]
ds_read_b128 v[24:27], v208 offset:13312
v_exp_f32 v73, v73
v_cvt_pk_bf16_f32 v117, v70, v71
v_exp_f32 v74, v74
v_exp_f32 v75, v75
v_mfma_f32_32x32x16_bf16 v[84:99], v[12:15], v[28:31], v[180:195]
ds_read_b128 v[36:39], v208 offset:10240
v_cvt_pk_bf16_f32 v118, v72, v73
v_cvt_pk_bf16_f32 v119, v74, v75
v_exp_f32 v100, v100
v_exp_f32 v101, v101
v_mfma_f32_32x32x16_bf16 v[132:147], v[44:47], v[116:119], v[132:147]
ds_read_b128 v[40:43], v208 offset:11264
v_exp_f32 v102, v102
v_exp_f32 v103, v103
v_exp_f32 v104, v104
v_mfma_f32_16x16x32_bf16 v[196:199], v[204:207], v[116:119], v[196:199]
v_cvt_pk_bf16_f32 v124, v100, v101
v_exp_f32 v105, v105
v_mfma_f32_32x32x16_bf16 v[52:67], v[16:19], v[8:11], v[52:67]
v_exp_f32 v106, v106
v_cvt_pk_bf16_f32 v125, v102, v103
v_exp_f32 v107, v107
v_cvt_pk_bf16_f32 v126, v104, v105
v_mfma_f32_32x32x16_bf16 v[84:99], v[16:19], v[32:35], v[84:99]
v_cvt_pk_bf16_f32 v127, v106, v107
v_exp_f32 v76, v76
v_exp_f32 v77, v77
v_exp_f32 v78, v78
v_mfma_f32_32x32x16_bf16 v[148:163], v[44:47], v[124:127], v[148:163]
v_exp_f32 v79, v79
v_cvt_pk_bf16_f32 v120, v76, v77
v_exp_f32 v80, v80
v_exp_f32 v81, v81
v_mfma_f32_16x16x32_bf16 v[200:203], v[204:207], v[124:127], v[200:203]
v_cvt_pk_bf16_f32 v121, v78, v79
v_exp_f32 v82, v82
v_exp_f32 v83, v83
v_cvt_pk_bf16_f32 v122, v80, v81
v_exp_f32 v108, v108
v_cvt_pk_bf16_f32 v123, v82, v83
v_exp_f32 v109, v109
v_exp_f32 v110, v110
v_mfma_f32_32x32x16_bf16 v[132:147], v[48:51], v[120:123], v[132:147]
v_exp_f32 v111, v111
v_cvt_pk_bf16_f32 v128, v108, v109
v_exp_f32 v112, v112
v_exp_f32 v113, v113
v_mfma_f32_16x16x32_bf16 v[196:199], v[204:207], v[120:123], v[196:199]
v_cvt_pk_bf16_f32 v129, v110, v111
v_exp_f32 v114, v114
v_exp_f32 v115, v115
v_cvt_pk_bf16_f32 v130, v112, v113
v_cvt_pk_bf16_f32 v131, v114, v115
s_waitcnt lgkmcnt(0)
s_barrier
v_exp_f32 v52, v52
v_mfma_f32_32x32x16_bf16 v[148:163], v[48:51], v[128:131], v[148:163]
ds_read_b128 v[12:15], v209 offset:0
v_exp_f32 v53, v53
v_exp_f32 v54, v54
v_exp_f32 v55, v55
v_mfma_f32_16x16x32_bf16 v[200:203], v[204:207], v[128:131], v[200:203]
v_cvt_pk_bf16_f32 v116, v52, v53
v_exp_f32 v56, v56
v_mfma_f32_32x32x16_bf16 v[68:83], v[20:23], v[4:7], v[164:179]
ds_read_b128 v[16:19], v209 offset:1024
v_exp_f32 v57, v57
v_cvt_pk_bf16_f32 v117, v54, v55
v_exp_f32 v58, v58
v_exp_f32 v59, v59
v_mfma_f32_32x32x16_bf16 v[100:115], v[20:23], v[28:31], v[180:195]
ds_read_b128 v[44:47], v208 offset:14336
v_cvt_pk_bf16_f32 v118, v56, v57
v_cvt_pk_bf16_f32 v119, v58, v59
v_exp_f32 v84, v84
v_exp_f32 v85, v85
v_mfma_f32_32x32x16_bf16 v[132:147], v[36:39], v[116:119], v[132:147]
ds_read_b128 v[48:51], v208 offset:15360
v_exp_f32 v86, v86
v_exp_f32 v87, v87
v_exp_f32 v88, v88
v_mfma_f32_16x16x32_bf16 v[196:199], v[204:207], v[116:119], v[196:199]
v_cvt_pk_bf16_f32 v124, v84, v85
v_exp_f32 v89, v89
v_mfma_f32_32x32x16_bf16 v[68:83], v[24:27], v[8:11], v[68:83]
v_exp_f32 v90, v90
v_cvt_pk_bf16_f32 v125, v86, v87
v_exp_f32 v91, v91
v_cvt_pk_bf16_f32 v126, v88, v89
v_mfma_f32_32x32x16_bf16 v[100:115], v[24:27], v[32:35], v[100:115]
v_cvt_pk_bf16_f32 v127, v90, v91
v_exp_f32 v60, v60
v_exp_f32 v61, v61
v_exp_f32 v62, v62
v_mfma_f32_32x32x16_bf16 v[148:163], v[36:39], v[124:127], v[148:163]
v_exp_f32 v63, v63
v_cvt_pk_bf16_f32 v120, v60, v61
v_exp_f32 v64, v64
v_exp_f32 v65, v65
v_mfma_f32_16x16x32_bf16 v[200:203], v[204:207], v[124:127], v[200:203]
v_cvt_pk_bf16_f32 v121, v62, v63
v_exp_f32 v66, v66
v_exp_f32 v67, v67
v_cvt_pk_bf16_f32 v122, v64, v65
v_exp_f32 v92, v92
v_cvt_pk_bf16_f32 v123, v66, v67
v_exp_f32 v93, v93
v_exp_f32 v94, v94
v_mfma_f32_32x32x16_bf16 v[132:147], v[40:43], v[120:123], v[132:147]
v_exp_f32 v95, v95
v_cvt_pk_bf16_f32 v128, v92, v93
v_exp_f32 v96, v96
v_exp_f32 v97, v97
v_mfma_f32_16x16x32_bf16 v[196:199], v[204:207], v[120:123], v[196:199]
v_cvt_pk_bf16_f32 v129, v94, v95
v_exp_f32 v98, v98
v_exp_f32 v99, v99
v_cvt_pk_bf16_f32 v130, v96, v97
v_cvt_pk_bf16_f32 v131, v98, v99
s_waitcnt lgkmcnt(0)
v_exp_f32 v68, v68
v_mfma_f32_32x32x16_bf16 v[148:163], v[40:43], v[128:131], v[148:163]
ds_read_b128 v[20:23], v209 offset:4096
v_exp_f32 v69, v69
v_exp_f32 v70, v70
v_exp_f32 v71, v71
v_mfma_f32_16x16x32_bf16 v[200:203], v[204:207], v[128:131], v[200:203]
v_cvt_pk_bf16_f32 v116, v68, v69
v_exp_f32 v72, v72
v_mfma_f32_32x32x16_bf16 v[52:67], v[12:15], v[4:7], v[164:179]
ds_read_b128 v[24:27], v209 offset:5120
v_exp_f32 v73, v73
v_cvt_pk_bf16_f32 v117, v70, v71
v_exp_f32 v74, v74
v_exp_f32 v75, v75
v_mfma_f32_32x32x16_bf16 v[84:99], v[12:15], v[28:31], v[180:195]
ds_read_b128 v[36:39], v209 offset:2048
v_cvt_pk_bf16_f32 v118, v72, v73
v_cvt_pk_bf16_f32 v119, v74, v75
v_exp_f32 v100, v100
v_exp_f32 v101, v101
v_mfma_f32_32x32x16_bf16 v[132:147], v[44:47], v[116:119], v[132:147]
ds_read_b128 v[40:43], v209 offset:3072
v_exp_f32 v102, v102
v_exp_f32 v103, v103
v_exp_f32 v104, v104
v_mfma_f32_16x16x32_bf16 v[196:199], v[204:207], v[116:119], v[196:199]
v_cvt_pk_bf16_f32 v124, v100, v101
v_exp_f32 v105, v105
v_mfma_f32_32x32x16_bf16 v[52:67], v[16:19], v[8:11], v[52:67]
v_exp_f32 v106, v106
v_cvt_pk_bf16_f32 v125, v102, v103
v_exp_f32 v107, v107
v_cvt_pk_bf16_f32 v126, v104, v105
v_mfma_f32_32x32x16_bf16 v[84:99], v[16:19], v[32:35], v[84:99]
v_cvt_pk_bf16_f32 v127, v106, v107
v_exp_f32 v76, v76
v_exp_f32 v77, v77
v_exp_f32 v78, v78
v_mfma_f32_32x32x16_bf16 v[148:163], v[44:47], v[124:127], v[148:163]
v_exp_f32 v79, v79
v_cvt_pk_bf16_f32 v120, v76, v77
v_exp_f32 v80, v80
v_exp_f32 v81, v81
v_mfma_f32_16x16x32_bf16 v[200:203], v[204:207], v[124:127], v[200:203]
v_cvt_pk_bf16_f32 v121, v78, v79
v_exp_f32 v82, v82
v_exp_f32 v83, v83
v_cvt_pk_bf16_f32 v122, v80, v81
v_exp_f32 v108, v108
v_cvt_pk_bf16_f32 v123, v82, v83
v_exp_f32 v109, v109
v_exp_f32 v110, v110
v_mfma_f32_32x32x16_bf16 v[132:147], v[48:51], v[120:123], v[132:147]
v_exp_f32 v111, v111
v_cvt_pk_bf16_f32 v128, v108, v109
v_exp_f32 v112, v112
v_exp_f32 v113, v113
v_mfma_f32_16x16x32_bf16 v[196:199], v[204:207], v[120:123], v[196:199]
v_cvt_pk_bf16_f32 v129, v110, v111
v_exp_f32 v114, v114
v_exp_f32 v115, v115
v_cvt_pk_bf16_f32 v130, v112, v113
v_cvt_pk_bf16_f32 v131, v114, v115
s_add_u32 s65, s65, 32768
s_and_b32 s65, s65, 0x1ffff
v_mov_b32 v208, v209
v_add_u32 v209, s65, v210
s_mov_b32 s64, 13
L_interleave_layers__linear_kernel_hedgehog__mha_block__prompt_kernel_b_st:
s_waitcnt lgkmcnt(0)
v_exp_f32 v52, v52
v_mfma_f32_32x32x16_bf16 v[148:163], v[48:51], v[128:131], v[148:163]
ds_read_b128 v[12:15], v208 offset:8192
v_exp_f32 v53, v53
v_exp_f32 v54, v54
v_exp_f32 v55, v55
v_mfma_f32_16x16x32_bf16 v[200:203], v[204:207], v[128:131], v[200:203]
v_cvt_pk_bf16_f32 v116, v52, v53
v_exp_f32 v56, v56
v_mfma_f32_32x32x16_bf16 v[68:83], v[20:23], v[4:7], v[164:179]
ds_read_b128 v[16:19], v208 offset:9216
v_exp_f32 v57, v57
v_cvt_pk_bf16_f32 v117, v54, v55
v_exp_f32 v58, v58
v_exp_f32 v59, v59
v_mfma_f32_32x32x16_bf16 v[100:115], v[20:23], v[28:31], v[180:195]
ds_read_b128 v[44:47], v208 offset:6144
v_cvt_pk_bf16_f32 v118, v56, v57
v_cvt_pk_bf16_f32 v119, v58, v59
v_exp_f32 v84, v84
v_exp_f32 v85, v85
v_mfma_f32_32x32x16_bf16 v[132:147], v[36:39], v[116:119], v[132:147]
ds_read_b128 v[48:51], v208 offset:7168
v_exp_f32 v86, v86
v_exp_f32 v87, v87
v_exp_f32 v88, v88
v_mfma_f32_16x16x32_bf16 v[196:199], v[204:207], v[116:119], v[196:199]
v_cvt_pk_bf16_f32 v124, v84, v85
v_exp_f32 v89, v89
v_mfma_f32_32x32x16_bf16 v[68:83], v[24:27], v[8:11], v[68:83]
v_exp_f32 v90, v90
v_cvt_pk_bf16_f32 v125, v86, v87
v_exp_f32 v91, v91
v_cvt_pk_bf16_f32 v126, v88, v89
v_mfma_f32_32x32x16_bf16 v[100:115], v[24:27], v[32:35], v[100:115]
v_cvt_pk_bf16_f32 v127, v90, v91
v_exp_f32 v60, v60
v_exp_f32 v61, v61
v_exp_f32 v62, v62
v_mfma_f32_32x32x16_bf16 v[148:163], v[36:39], v[124:127], v[148:163]
v_exp_f32 v63, v63
v_cvt_pk_bf16_f32 v120, v60, v61
v_exp_f32 v64, v64
v_exp_f32 v65, v65
v_mfma_f32_16x16x32_bf16 v[200:203], v[204:207], v[124:127], v[200:203]
v_cvt_pk_bf16_f32 v121, v62, v63
v_exp_f32 v66, v66
v_exp_f32 v67, v67
v_cvt_pk_bf16_f32 v122, v64, v65
v_exp_f32 v92, v92
v_cvt_pk_bf16_f32 v123, v66, v67
v_exp_f32 v93, v93
v_exp_f32 v94, v94
v_mfma_f32_32x32x16_bf16 v[132:147], v[40:43], v[120:123], v[132:147]
v_exp_f32 v95, v95
v_cvt_pk_bf16_f32 v128, v92, v93
v_exp_f32 v96, v96
v_exp_f32 v97, v97
v_mfma_f32_16x16x32_bf16 v[196:199], v[204:207], v[120:123], v[196:199]
v_cvt_pk_bf16_f32 v129, v94, v95
v_exp_f32 v98, v98
v_exp_f32 v99, v99
v_cvt_pk_bf16_f32 v130, v96, v97
v_cvt_pk_bf16_f32 v131, v98, v99
s_waitcnt lgkmcnt(0)
v_exp_f32 v68, v68
v_mfma_f32_32x32x16_bf16 v[148:163], v[40:43], v[128:131], v[148:163]
ds_read_b128 v[20:23], v208 offset:12288
v_exp_f32 v69, v69
v_exp_f32 v70, v70
v_exp_f32 v71, v71
v_mfma_f32_16x16x32_bf16 v[200:203], v[204:207], v[128:131], v[200:203]
v_cvt_pk_bf16_f32 v116, v68, v69
v_exp_f32 v72, v72
v_mfma_f32_32x32x16_bf16 v[52:67], v[12:15], v[4:7], v[164:179]
ds_read_b128 v[24:27], v208 offset:13312
v_exp_f32 v73, v73
v_cvt_pk_bf16_f32 v117, v70, v71
v_exp_f32 v74, v74
v_exp_f32 v75, v75
v_mfma_f32_32x32x16_bf16 v[84:99], v[12:15], v[28:31], v[180:195]
ds_read_b128 v[36:39], v208 offset:10240
v_cvt_pk_bf16_f32 v118, v72, v73
v_cvt_pk_bf16_f32 v119, v74, v75
v_exp_f32 v100, v100
v_exp_f32 v101, v101
v_mfma_f32_32x32x16_bf16 v[132:147], v[44:47], v[116:119], v[132:147]
ds_read_b128 v[40:43], v208 offset:11264
v_exp_f32 v102, v102
v_exp_f32 v103, v103
v_exp_f32 v104, v104
v_mfma_f32_16x16x32_bf16 v[196:199], v[204:207], v[116:119], v[196:199]
v_cvt_pk_bf16_f32 v124, v100, v101
v_exp_f32 v105, v105
v_mfma_f32_32x32x16_bf16 v[52:67], v[16:19], v[8:11], v[52:67]
v_exp_f32 v106, v106
v_cvt_pk_bf16_f32 v125, v102, v103
v_exp_f32 v107, v107
v_cvt_pk_bf16_f32 v126, v104, v105
v_mfma_f32_32x32x16_bf16 v[84:99], v[16:19], v[32:35], v[84:99]
v_cvt_pk_bf16_f32 v127, v106, v107
v_exp_f32 v76, v76
v_exp_f32 v77, v77
v_exp_f32 v78, v78
v_mfma_f32_32x32x16_bf16 v[148:163], v[44:47], v[124:127], v[148:163]
v_exp_f32 v79, v79
v_cvt_pk_bf16_f32 v120, v76, v77
v_exp_f32 v80, v80
v_exp_f32 v81, v81
v_mfma_f32_16x16x32_bf16 v[200:203], v[204:207], v[124:127], v[200:203]
v_cvt_pk_bf16_f32 v121, v78, v79
v_exp_f32 v82, v82
v_exp_f32 v83, v83
v_cvt_pk_bf16_f32 v122, v80, v81
v_exp_f32 v108, v108
v_cvt_pk_bf16_f32 v123, v82, v83
v_exp_f32 v109, v109
v_exp_f32 v110, v110
v_mfma_f32_32x32x16_bf16 v[132:147], v[48:51], v[120:123], v[132:147]
v_exp_f32 v111, v111
v_cvt_pk_bf16_f32 v128, v108, v109
v_exp_f32 v112, v112
v_exp_f32 v113, v113
v_mfma_f32_16x16x32_bf16 v[196:199], v[204:207], v[120:123], v[196:199]
v_cvt_pk_bf16_f32 v129, v110, v111
v_exp_f32 v114, v114
v_exp_f32 v115, v115
v_cvt_pk_bf16_f32 v130, v112, v113
v_cvt_pk_bf16_f32 v131, v114, v115
s_waitcnt lgkmcnt(0)
s_barrier
v_exp_f32 v52, v52
v_mfma_f32_32x32x16_bf16 v[148:163], v[48:51], v[128:131], v[148:163]
ds_read_b128 v[12:15], v209 offset:0
v_exp_f32 v53, v53
v_exp_f32 v54, v54
v_exp_f32 v55, v55
v_mfma_f32_16x16x32_bf16 v[200:203], v[204:207], v[128:131], v[200:203]
v_cvt_pk_bf16_f32 v116, v52, v53
v_exp_f32 v56, v56
v_mfma_f32_32x32x16_bf16 v[68:83], v[20:23], v[4:7], v[164:179]
ds_read_b128 v[16:19], v209 offset:1024
v_exp_f32 v57, v57
v_cvt_pk_bf16_f32 v117, v54, v55
v_exp_f32 v58, v58
v_exp_f32 v59, v59
v_mfma_f32_32x32x16_bf16 v[100:115], v[20:23], v[28:31], v[180:195]
ds_read_b128 v[44:47], v208 offset:14336
v_cvt_pk_bf16_f32 v118, v56, v57
v_cvt_pk_bf16_f32 v119, v58, v59
v_exp_f32 v84, v84
v_exp_f32 v85, v85
v_mfma_f32_32x32x16_bf16 v[132:147], v[36:39], v[116:119], v[132:147]
ds_read_b128 v[48:51], v208 offset:15360
v_exp_f32 v86, v86
v_exp_f32 v87, v87
v_exp_f32 v88, v88
v_mfma_f32_16x16x32_bf16 v[196:199], v[204:207], v[116:119], v[196:199]
v_cvt_pk_bf16_f32 v124, v84, v85
v_exp_f32 v89, v89
v_mfma_f32_32x32x16_bf16 v[68:83], v[24:27], v[8:11], v[68:83]
v_exp_f32 v90, v90
v_cvt_pk_bf16_f32 v125, v86, v87
v_exp_f32 v91, v91
v_cvt_pk_bf16_f32 v126, v88, v89
v_mfma_f32_32x32x16_bf16 v[100:115], v[24:27], v[32:35], v[100:115]
v_cvt_pk_bf16_f32 v127, v90, v91
v_exp_f32 v60, v60
v_exp_f32 v61, v61
v_exp_f32 v62, v62
v_mfma_f32_32x32x16_bf16 v[148:163], v[36:39], v[124:127], v[148:163]
v_exp_f32 v63, v63
v_cvt_pk_bf16_f32 v120, v60, v61
v_exp_f32 v64, v64
v_exp_f32 v65, v65
v_mfma_f32_16x16x32_bf16 v[200:203], v[204:207], v[124:127], v[200:203]
v_cvt_pk_bf16_f32 v121, v62, v63
v_exp_f32 v66, v66
v_exp_f32 v67, v67
v_cvt_pk_bf16_f32 v122, v64, v65
v_exp_f32 v92, v92
v_cvt_pk_bf16_f32 v123, v66, v67
v_exp_f32 v93, v93
v_exp_f32 v94, v94
v_mfma_f32_32x32x16_bf16 v[132:147], v[40:43], v[120:123], v[132:147]
v_exp_f32 v95, v95
v_cvt_pk_bf16_f32 v128, v92, v93
v_exp_f32 v96, v96
v_exp_f32 v97, v97
v_mfma_f32_16x16x32_bf16 v[196:199], v[204:207], v[120:123], v[196:199]
v_cvt_pk_bf16_f32 v129, v94, v95
v_exp_f32 v98, v98
v_exp_f32 v99, v99
v_cvt_pk_bf16_f32 v130, v96, v97
v_cvt_pk_bf16_f32 v131, v98, v99
s_waitcnt lgkmcnt(0)
v_exp_f32 v68, v68
v_mfma_f32_32x32x16_bf16 v[148:163], v[40:43], v[128:131], v[148:163]
ds_read_b128 v[20:23], v209 offset:4096
v_exp_f32 v69, v69
v_exp_f32 v70, v70
v_exp_f32 v71, v71
v_mfma_f32_16x16x32_bf16 v[200:203], v[204:207], v[128:131], v[200:203]
v_cvt_pk_bf16_f32 v116, v68, v69
v_exp_f32 v72, v72
v_mfma_f32_32x32x16_bf16 v[52:67], v[12:15], v[4:7], v[164:179]
ds_read_b128 v[24:27], v209 offset:5120
v_exp_f32 v73, v73
v_cvt_pk_bf16_f32 v117, v70, v71
v_exp_f32 v74, v74
v_exp_f32 v75, v75
v_mfma_f32_32x32x16_bf16 v[84:99], v[12:15], v[28:31], v[180:195]
ds_read_b128 v[36:39], v209 offset:2048
v_cvt_pk_bf16_f32 v118, v72, v73
v_cvt_pk_bf16_f32 v119, v74, v75
v_exp_f32 v100, v100
v_exp_f32 v101, v101
v_mfma_f32_32x32x16_bf16 v[132:147], v[44:47], v[116:119], v[132:147]
ds_read_b128 v[40:43], v209 offset:3072
v_exp_f32 v102, v102
v_exp_f32 v103, v103
v_exp_f32 v104, v104
v_mfma_f32_16x16x32_bf16 v[196:199], v[204:207], v[116:119], v[196:199]
v_cvt_pk_bf16_f32 v124, v100, v101
v_exp_f32 v105, v105
v_mfma_f32_32x32x16_bf16 v[52:67], v[16:19], v[8:11], v[52:67]
v_exp_f32 v106, v106
v_cvt_pk_bf16_f32 v125, v102, v103
v_exp_f32 v107, v107
v_cvt_pk_bf16_f32 v126, v104, v105
v_mfma_f32_32x32x16_bf16 v[84:99], v[16:19], v[32:35], v[84:99]
v_cvt_pk_bf16_f32 v127, v106, v107
v_exp_f32 v76, v76
v_exp_f32 v77, v77
v_exp_f32 v78, v78
v_mfma_f32_32x32x16_bf16 v[148:163], v[44:47], v[124:127], v[148:163]
v_exp_f32 v79, v79
v_cvt_pk_bf16_f32 v120, v76, v77
v_exp_f32 v80, v80
v_exp_f32 v81, v81
v_mfma_f32_16x16x32_bf16 v[200:203], v[204:207], v[124:127], v[200:203]
v_cvt_pk_bf16_f32 v121, v78, v79
v_exp_f32 v82, v82
v_exp_f32 v83, v83
v_cvt_pk_bf16_f32 v122, v80, v81
v_exp_f32 v108, v108
v_cvt_pk_bf16_f32 v123, v82, v83
v_exp_f32 v109, v109
v_exp_f32 v110, v110
v_mfma_f32_32x32x16_bf16 v[132:147], v[48:51], v[120:123], v[132:147]
v_exp_f32 v111, v111
v_cvt_pk_bf16_f32 v128, v108, v109
v_exp_f32 v112, v112
v_exp_f32 v113, v113
v_mfma_f32_16x16x32_bf16 v[196:199], v[204:207], v[120:123], v[196:199]
v_cvt_pk_bf16_f32 v129, v110, v111
v_exp_f32 v114, v114
v_exp_f32 v115, v115
v_cvt_pk_bf16_f32 v130, v112, v113
v_cvt_pk_bf16_f32 v131, v114, v115
s_add_u32 s65, s65, 32768
s_and_b32 s65, s65, 0x1ffff
v_mov_b32 v208, v209
v_add_u32 v209, s65, v210
s_sub_u32 s64, s64, 1
s_cmp_lg_u32 s64, 0
s_cbranch_scc1 L_interleave_layers__linear_kernel_hedgehog__mha_block__prompt_kernel_b_st
s_waitcnt lgkmcnt(0)
v_exp_f32 v52, v52
v_mfma_f32_32x32x16_bf16 v[148:163], v[48:51], v[128:131], v[148:163]
ds_read_b128 v[12:15], v208 offset:8192
v_exp_f32 v53, v53
v_exp_f32 v54, v54
v_exp_f32 v55, v55
v_mfma_f32_16x16x32_bf16 v[200:203], v[204:207], v[128:131], v[200:203]
v_cvt_pk_bf16_f32 v116, v52, v53
v_exp_f32 v56, v56
v_mfma_f32_32x32x16_bf16 v[68:83], v[20:23], v[4:7], v[164:179]
ds_read_b128 v[16:19], v208 offset:9216
v_exp_f32 v57, v57
v_cvt_pk_bf16_f32 v117, v54, v55
v_exp_f32 v58, v58
v_exp_f32 v59, v59
v_mfma_f32_32x32x16_bf16 v[100:115], v[20:23], v[28:31], v[180:195]
ds_read_b128 v[44:47], v208 offset:6144
v_cvt_pk_bf16_f32 v118, v56, v57
v_cvt_pk_bf16_f32 v119, v58, v59
v_exp_f32 v84, v84
v_exp_f32 v85, v85
v_mfma_f32_32x32x16_bf16 v[132:147], v[36:39], v[116:119], v[132:147]
ds_read_b128 v[48:51], v208 offset:7168
v_exp_f32 v86, v86
v_exp_f32 v87, v87
v_exp_f32 v88, v88
v_mfma_f32_16x16x32_bf16 v[196:199], v[204:207], v[116:119], v[196:199]
v_cvt_pk_bf16_f32 v124, v84, v85
v_exp_f32 v89, v89
v_mfma_f32_32x32x16_bf16 v[68:83], v[24:27], v[8:11], v[68:83]
v_exp_f32 v90, v90
v_cvt_pk_bf16_f32 v125, v86, v87
v_exp_f32 v91, v91
v_cvt_pk_bf16_f32 v126, v88, v89
v_mfma_f32_32x32x16_bf16 v[100:115], v[24:27], v[32:35], v[100:115]
v_cvt_pk_bf16_f32 v127, v90, v91
v_exp_f32 v60, v60
v_exp_f32 v61, v61
v_exp_f32 v62, v62
v_mfma_f32_32x32x16_bf16 v[148:163], v[36:39], v[124:127], v[148:163]
v_exp_f32 v63, v63
v_cvt_pk_bf16_f32 v120, v60, v61
v_exp_f32 v64, v64
v_exp_f32 v65, v65
v_mfma_f32_16x16x32_bf16 v[200:203], v[204:207], v[124:127], v[200:203]
v_cvt_pk_bf16_f32 v121, v62, v63
v_exp_f32 v66, v66
v_exp_f32 v67, v67
v_cvt_pk_bf16_f32 v122, v64, v65
v_exp_f32 v92, v92
v_cvt_pk_bf16_f32 v123, v66, v67
v_exp_f32 v93, v93
v_exp_f32 v94, v94
v_mfma_f32_32x32x16_bf16 v[132:147], v[40:43], v[120:123], v[132:147]
v_exp_f32 v95, v95
v_cvt_pk_bf16_f32 v128, v92, v93
v_exp_f32 v96, v96
v_exp_f32 v97, v97
v_mfma_f32_16x16x32_bf16 v[196:199], v[204:207], v[120:123], v[196:199]
v_cvt_pk_bf16_f32 v129, v94, v95
v_exp_f32 v98, v98
v_exp_f32 v99, v99
v_cvt_pk_bf16_f32 v130, v96, v97
v_cvt_pk_bf16_f32 v131, v98, v99
s_waitcnt lgkmcnt(0)
v_exp_f32 v68, v68
v_mfma_f32_32x32x16_bf16 v[148:163], v[40:43], v[128:131], v[148:163]
ds_read_b128 v[20:23], v208 offset:12288
v_exp_f32 v69, v69
v_exp_f32 v70, v70
v_exp_f32 v71, v71
v_mfma_f32_16x16x32_bf16 v[200:203], v[204:207], v[128:131], v[200:203]
v_cvt_pk_bf16_f32 v116, v68, v69
v_exp_f32 v72, v72
v_mfma_f32_32x32x16_bf16 v[52:67], v[12:15], v[4:7], v[164:179]
ds_read_b128 v[24:27], v208 offset:13312
v_exp_f32 v73, v73
v_cvt_pk_bf16_f32 v117, v70, v71
v_exp_f32 v74, v74
v_exp_f32 v75, v75
v_mfma_f32_32x32x16_bf16 v[84:99], v[12:15], v[28:31], v[180:195]
ds_read_b128 v[36:39], v208 offset:10240
v_cvt_pk_bf16_f32 v118, v72, v73
v_cvt_pk_bf16_f32 v119, v74, v75
v_exp_f32 v100, v100
v_exp_f32 v101, v101
v_mfma_f32_32x32x16_bf16 v[132:147], v[44:47], v[116:119], v[132:147]
ds_read_b128 v[40:43], v208 offset:11264
v_exp_f32 v102, v102
v_exp_f32 v103, v103
v_exp_f32 v104, v104
v_mfma_f32_16x16x32_bf16 v[196:199], v[204:207], v[116:119], v[196:199]
v_cvt_pk_bf16_f32 v124, v100, v101
v_exp_f32 v105, v105
v_mfma_f32_32x32x16_bf16 v[52:67], v[16:19], v[8:11], v[52:67]
v_exp_f32 v106, v106
v_cvt_pk_bf16_f32 v125, v102, v103
v_exp_f32 v107, v107
v_cvt_pk_bf16_f32 v126, v104, v105
v_mfma_f32_32x32x16_bf16 v[84:99], v[16:19], v[32:35], v[84:99]
v_cvt_pk_bf16_f32 v127, v106, v107
v_exp_f32 v76, v76
v_exp_f32 v77, v77
v_exp_f32 v78, v78
v_mfma_f32_32x32x16_bf16 v[148:163], v[44:47], v[124:127], v[148:163]
v_exp_f32 v79, v79
v_cvt_pk_bf16_f32 v120, v76, v77
v_exp_f32 v80, v80
v_exp_f32 v81, v81
v_mfma_f32_16x16x32_bf16 v[200:203], v[204:207], v[124:127], v[200:203]
v_cvt_pk_bf16_f32 v121, v78, v79
v_exp_f32 v82, v82
v_exp_f32 v83, v83
v_cvt_pk_bf16_f32 v122, v80, v81
v_exp_f32 v108, v108
v_cvt_pk_bf16_f32 v123, v82, v83
v_exp_f32 v109, v109
v_exp_f32 v110, v110
v_mfma_f32_32x32x16_bf16 v[132:147], v[48:51], v[120:123], v[132:147]
v_exp_f32 v111, v111
v_cvt_pk_bf16_f32 v128, v108, v109
v_exp_f32 v112, v112
v_exp_f32 v113, v113
v_mfma_f32_16x16x32_bf16 v[196:199], v[204:207], v[120:123], v[196:199]
v_cvt_pk_bf16_f32 v129, v110, v111
v_exp_f32 v114, v114
v_exp_f32 v115, v115
v_cvt_pk_bf16_f32 v130, v112, v113
v_cvt_pk_bf16_f32 v131, v114, v115
s_waitcnt lgkmcnt(0)
s_barrier
v_exp_f32 v52, v52
v_mfma_f32_32x32x16_bf16 v[148:163], v[48:51], v[128:131], v[148:163]
v_exp_f32 v53, v53
v_exp_f32 v54, v54
v_exp_f32 v55, v55
v_mfma_f32_16x16x32_bf16 v[200:203], v[204:207], v[128:131], v[200:203]
v_cvt_pk_bf16_f32 v116, v52, v53
v_exp_f32 v56, v56
v_mfma_f32_32x32x16_bf16 v[68:83], v[20:23], v[4:7], v[164:179]
v_exp_f32 v57, v57
v_cvt_pk_bf16_f32 v117, v54, v55
v_exp_f32 v58, v58
v_exp_f32 v59, v59
v_mfma_f32_32x32x16_bf16 v[100:115], v[20:23], v[28:31], v[180:195]
ds_read_b128 v[44:47], v208 offset:14336
v_cvt_pk_bf16_f32 v118, v56, v57
v_cvt_pk_bf16_f32 v119, v58, v59
v_exp_f32 v84, v84
v_exp_f32 v85, v85
v_mfma_f32_32x32x16_bf16 v[132:147], v[36:39], v[116:119], v[132:147]
ds_read_b128 v[48:51], v208 offset:15360
v_exp_f32 v86, v86
v_exp_f32 v87, v87
v_exp_f32 v88, v88
v_mfma_f32_16x16x32_bf16 v[196:199], v[204:207], v[116:119], v[196:199]
v_cvt_pk_bf16_f32 v124, v84, v85
v_exp_f32 v89, v89
v_mfma_f32_32x32x16_bf16 v[68:83], v[24:27], v[8:11], v[68:83]
v_exp_f32 v90, v90
v_cvt_pk_bf16_f32 v125, v86, v87
v_exp_f32 v91, v91
v_cvt_pk_bf16_f32 v126, v88, v89
v_mfma_f32_32x32x16_bf16 v[100:115], v[24:27], v[32:35], v[100:115]
v_cvt_pk_bf16_f32 v127, v90, v91
v_exp_f32 v60, v60
v_exp_f32 v61, v61
v_exp_f32 v62, v62
v_mfma_f32_32x32x16_bf16 v[148:163], v[36:39], v[124:127], v[148:163]
v_exp_f32 v63, v63
v_cvt_pk_bf16_f32 v120, v60, v61
v_exp_f32 v64, v64
v_exp_f32 v65, v65
v_mfma_f32_16x16x32_bf16 v[200:203], v[204:207], v[124:127], v[200:203]
v_cvt_pk_bf16_f32 v121, v62, v63
v_exp_f32 v66, v66
v_exp_f32 v67, v67
v_cvt_pk_bf16_f32 v122, v64, v65
v_exp_f32 v92, v92
v_cvt_pk_bf16_f32 v123, v66, v67
v_exp_f32 v93, v93
v_exp_f32 v94, v94
v_mfma_f32_32x32x16_bf16 v[132:147], v[40:43], v[120:123], v[132:147]
v_exp_f32 v95, v95
v_cvt_pk_bf16_f32 v128, v92, v93
v_exp_f32 v96, v96
v_exp_f32 v97, v97
v_mfma_f32_16x16x32_bf16 v[196:199], v[204:207], v[120:123], v[196:199]
v_cvt_pk_bf16_f32 v129, v94, v95
v_exp_f32 v98, v98
v_exp_f32 v99, v99
v_cvt_pk_bf16_f32 v130, v96, v97
v_cvt_pk_bf16_f32 v131, v98, v99
s_waitcnt lgkmcnt(0)
v_exp_f32 v68, v68
v_mfma_f32_32x32x16_bf16 v[148:163], v[40:43], v[128:131], v[148:163]
v_exp_f32 v69, v69
v_exp_f32 v70, v70
v_exp_f32 v71, v71
v_mfma_f32_16x16x32_bf16 v[200:203], v[204:207], v[128:131], v[200:203]
v_cvt_pk_bf16_f32 v116, v68, v69
v_exp_f32 v72, v72
v_exp_f32 v73, v73
v_cvt_pk_bf16_f32 v117, v70, v71
v_exp_f32 v74, v74
v_exp_f32 v75, v75
v_cvt_pk_bf16_f32 v118, v72, v73
v_cvt_pk_bf16_f32 v119, v74, v75
v_exp_f32 v100, v100
v_exp_f32 v101, v101
v_mfma_f32_32x32x16_bf16 v[132:147], v[44:47], v[116:119], v[132:147]
v_exp_f32 v102, v102
v_exp_f32 v103, v103
v_exp_f32 v104, v104
v_mfma_f32_16x16x32_bf16 v[196:199], v[204:207], v[116:119], v[196:199]
v_cvt_pk_bf16_f32 v124, v100, v101
v_exp_f32 v105, v105
v_exp_f32 v106, v106
v_cvt_pk_bf16_f32 v125, v102, v103
v_exp_f32 v107, v107
v_cvt_pk_bf16_f32 v126, v104, v105
v_cvt_pk_bf16_f32 v127, v106, v107
v_exp_f32 v76, v76
v_exp_f32 v77, v77
v_exp_f32 v78, v78
v_mfma_f32_32x32x16_bf16 v[148:163], v[44:47], v[124:127], v[148:163]
v_exp_f32 v79, v79
v_cvt_pk_bf16_f32 v120, v76, v77
v_exp_f32 v80, v80
v_exp_f32 v81, v81
v_mfma_f32_16x16x32_bf16 v[200:203], v[204:207], v[124:127], v[200:203]
v_cvt_pk_bf16_f32 v121, v78, v79
v_exp_f32 v82, v82
v_exp_f32 v83, v83
v_cvt_pk_bf16_f32 v122, v80, v81
v_exp_f32 v108, v108
v_cvt_pk_bf16_f32 v123, v82, v83
v_exp_f32 v109, v109
v_exp_f32 v110, v110
v_mfma_f32_32x32x16_bf16 v[132:147], v[48:51], v[120:123], v[132:147]
v_exp_f32 v111, v111
v_cvt_pk_bf16_f32 v128, v108, v109
v_exp_f32 v112, v112
v_exp_f32 v113, v113
v_mfma_f32_16x16x32_bf16 v[196:199], v[204:207], v[120:123], v[196:199]
v_cvt_pk_bf16_f32 v129, v110, v111
v_exp_f32 v114, v114
v_exp_f32 v115, v115
v_cvt_pk_bf16_f32 v130, v112, v113
v_cvt_pk_bf16_f32 v131, v114, v115
s_nop 1
v_mfma_f32_32x32x16_bf16 v[148:163], v[48:51], v[128:131], v[148:163]
v_mfma_f32_16x16x32_bf16 v[200:203], v[204:207], v[128:131], v[200:203]
s_barrier
s_mov_b32 s31, 0
s_cmp_lg_u32 s69, 0
s_cbranch_scc1 L_interleave_layers__linear_kernel_hedgehog__mha_block__prompt_kernel_b_nochk
v_mov_b32 v211, 0x71800000
v_cmp_nlt_f32 vcc, v196, v211
s_nop 0
s_cmp_lg_u64 vcc, 0
s_cselect_b32 s31, 1, 0
v_cmp_nlt_f32 vcc, v200, v211
s_nop 0
s_cmp_lg_u64 vcc, 0
s_cselect_b32 s31, 1, s31
L_interleave_layers__linear_kernel_hedgehog__mha_block__prompt_kernel_b_nochk:
v_mov_b32 v213, s31
s_lshl_b32 s31, s22, 2
v_mov_b32 v211, s31
ds_write_b32 v211, v213 offset:2048
s_mul_i32 s31, s29, 4194304
s_add_u32 s31, s31, 16777216
s_add_u32 s36, s4, s31
s_addc_u32 s37, s5, 0
s_mov_b32 s38, 4194304
s_mov_b32 s39, 0x20000
s_lshl_b32 s31, s20, 2
s_lshl_b32 s32, s26, 1
s_add_u32 s31, s31, s32
s_lshl_b32 s31, s31, 16
s_lshl_b32 s32, s25, 11
s_add_u32 s65, s31, s32
v_rcp_f32 v211, v196
s_nop 0
v_pk_mul_f32 v[132:133], v[132:133], v[210:211] op_sel:[0,1] op_sel_hi:[1,1]
v_pk_mul_f32 v[134:135], v[134:135], v[210:211] op_sel:[0,1] op_sel_hi:[1,1]
v_pk_mul_f32 v[136:137], v[136:137], v[210:211] op_sel:[0,1] op_sel_hi:[1,1]
v_pk_mul_f32 v[138:139], v[138:139], v[210:211] op_sel:[0,1] op_sel_hi:[1,1]
v_pk_mul_f32 v[140:141], v[140:141], v[210:211] op_sel:[0,1] op_sel_hi:[1,1]
v_pk_mul_f32 v[142:143], v[142:143], v[210:211] op_sel:[0,1] op_sel_hi:[1,1]
v_pk_mul_f32 v[144:145], v[144:145], v[210:211] op_sel:[0,1] op_sel_hi:[1,1]
v_pk_mul_f32 v[146:147], v[146:147], v[210:211] op_sel:[0,1] op_sel_hi:[1,1]
v_cvt_pk_bf16_f32 v116, v132, v133
v_cvt_pk_bf16_f32 v117, v134, v135
v_cvt_pk_bf16_f32 v118, v136, v137
v_cvt_pk_bf16_f32 v119, v138, v139
v_cvt_pk_bf16_f32 v120, v140, v141
v_cvt_pk_bf16_f32 v121, v142, v143
v_cvt_pk_bf16_f32 v122, v144, v145
v_cvt_pk_bf16_f32 v123, v146, v147
buffer_store_dwordx4 v[116:119], v239, s[36:39], s65 offen sc1
buffer_store_dwordx4 v[120:123], v239, s[36:39], s65 offen offset:1024 sc1
s_add_u32 s65, s65, 65536
v_rcp_f32 v211, v200
s_nop 0
v_pk_mul_f32 v[148:149], v[148:149], v[210:211] op_sel:[0,1] op_sel_hi:[1,1]
v_pk_mul_f32 v[150:151], v[150:151], v[210:211] op_sel:[0,1] op_sel_hi:[1,1]
v_pk_mul_f32 v[152:153], v[152:153], v[210:211] op_sel:[0,1] op_sel_hi:[1,1]
v_pk_mul_f32 v[154:155], v[154:155], v[210:211] op_sel:[0,1] op_sel_hi:[1,1]
v_pk_mul_f32 v[156:157], v[156:157], v[210:211] op_sel:[0,1] op_sel_hi:[1,1]
v_pk_mul_f32 v[158:159], v[158:159], v[210:211] op_sel:[0,1] op_sel_hi:[1,1]
v_pk_mul_f32 v[160:161], v[160:161], v[210:211] op_sel:[0,1] op_sel_hi:[1,1]
v_pk_mul_f32 v[162:163], v[162:163], v[210:211] op_sel:[0,1] op_sel_hi:[1,1]
v_cvt_pk_bf16_f32 v124, v148, v149
v_cvt_pk_bf16_f32 v125, v150, v151
v_cvt_pk_bf16_f32 v126, v152, v153
v_cvt_pk_bf16_f32 v127, v154, v155
v_cvt_pk_bf16_f32 v128, v156, v157
v_cvt_pk_bf16_f32 v129, v158, v159
v_cvt_pk_bf16_f32 v130, v160, v161
v_cvt_pk_bf16_f32 v131, v162, v163
buffer_store_dwordx4 v[124:127], v239, s[36:39], s65 offen sc1
buffer_store_dwordx4 v[128:131], v239, s[36:39], s65 offen offset:1024 sc1
s_add_u32 s65, s65, 65536
s_waitcnt vmcnt(0) lgkmcnt(0)
s_barrier
v_and_b32 v211, 3, v0
v_lshlrev_b32 v211, 2, v211
ds_read_b32 v213, v211 offset:2048
s_waitcnt lgkmcnt(0)
v_cmp_ne_u32 vcc, 0, v213
s_nop 0
s_cmp_eq_u64 vcc, 0
s_cbranch_scc1 L_interleave_layers__linear_kernel_hedgehog__mha_block__prompt_kernel_b_cfin
s_mul_i32 s31, s30, 8388608
s_add_u32 s31, s31, 33554432
s_add_u32 s36, s4, s31
s_addc_u32 s37, s5, 0
s_mov_b32 s38, 8388608
s_mov_b32 s39, 0x20000
s_lshl_b32 s31, s25, 18
s_mov_b32 s64, 64
v_mov_b32 v213, 0xff800000
L_interleave_layers__linear_kernel_hedgehog__mha_block__prompt_kernel_b_mx0:
buffer_load_dwordx4 v[12:15], v239, s[36:39], s31 offen sc1
buffer_load_dwordx4 v[16:19], v239, s[36:39], s31 offen offset:1024 sc1
s_waitcnt vmcnt(0)
v_mfma_f32_32x32x16_bf16 v[52:67], v[12:15], v[4:7], 0
v_mfma_f32_32x32x16_bf16 v[52:67], v[16:19], v[8:11], v[52:67]
s_nop 11
v_max3_f32 v211, v52, v53, v54
v_max3_f32 v211, v211, v55, v56
v_max3_f32 v211, v211, v57, v58
v_max3_f32 v211, v211, v59, v60
v_max3_f32 v211, v211, v61, v62
v_max3_f32 v211, v211, v63, v64
v_max3_f32 v211, v211, v65, v66
v_max_f32 v211, v211, v67
v_max_f32 v213, v213, v211
s_add_u32 s31, s31, 4096
s_sub_u32 s64, s64, 1
s_cmp_lg_u32 s64, 0
s_cbranch_scc1 L_interleave_layers__linear_kernel_hedgehog__mha_block__prompt_kernel_b_mx0
v_mov_b32 v212, v213
s_nop 1
v_permlane32_swap_b32 v212, v213
v_max_f32 v213, v213, v212
v_add_f32 v213, 0x42200000, v213
v_sub_f32 v164, 0, v213
v_sub_f32 v165, 0, v213
v_sub_f32 v166, 0, v213
v_sub_f32 v167, 0, v213
v_sub_f32 v168, 0, v213
v_sub_f32 v169, 0, v213
v_sub_f32 v170, 0, v213
v_sub_f32 v171, 0, v213
v_sub_f32 v172, 0, v213
v_sub_f32 v173, 0, v213
v_sub_f32 v174, 0, v213
v_sub_f32 v175, 0, v213
v_sub_f32 v176, 0, v213
v_sub_f32 v177, 0, v213
v_sub_f32 v178, 0, v213
v_sub_f32 v179, 0, v213
s_lshl_b32 s31, s25, 18
s_mov_b32 s64, 64
v_mov_b32 v213, 0xff800000
L_interleave_layers__linear_kernel_hedgehog__mha_block__prompt_kernel_b_mx1:
buffer_load_dwordx4 v[12:15], v239, s[36:39], s31 offen sc1
buffer_load_dwordx4 v[16:19], v239, s[36:39], s31 offen offset:1024 sc1
s_waitcnt vmcnt(0)
v_mfma_f32_32x32x16_bf16 v[84:99], v[12:15], v[28:31], 0
v_mfma_f32_32x32x16_bf16 v[84:99], v[16:19], v[32:35], v[84:99]
s_nop 11
v_max3_f32 v211, v84, v85, v86
v_max3_f32 v211, v211, v87, v88
v_max3_f32 v211, v211, v89, v90
v_max3_f32 v211, v211, v91, v92
v_max3_f32 v211, v211, v93, v94
v_max3_f32 v211, v211, v95, v96
v_max3_f32 v211, v211, v97, v98
v_max_f32 v211, v211, v99
v_max_f32 v213, v213, v211
s_add_u32 s31, s31, 4096
s_sub_u32 s64, s64, 1
s_cmp_lg_u32 s64, 0
s_cbranch_scc1 L_interleave_layers__linear_kernel_hedgehog__mha_block__prompt_kernel_b_mx1
v_mov_b32 v212, v213
s_nop 1
v_permlane32_swap_b32 v212, v213
v_max_f32 v213, v213, v212
v_add_f32 v213, 0x42200000, v213
v_sub_f32 v180, 0, v213
v_sub_f32 v181, 0, v213
v_sub_f32 v182, 0, v213
v_sub_f32 v183, 0, v213
v_sub_f32 v184, 0, v213
v_sub_f32 v185, 0, v213
v_sub_f32 v186, 0, v213
v_sub_f32 v187, 0, v213
v_sub_f32 v188, 0, v213
v_sub_f32 v189, 0, v213
v_sub_f32 v190, 0, v213
v_sub_f32 v191, 0, v213
v_sub_f32 v192, 0, v213
v_sub_f32 v193, 0, v213
v_sub_f32 v194, 0, v213
v_sub_f32 v195, 0, v213
s_mov_b32 s69, 1
s_barrier
s_barrier
s_branch L_interleave_layers__linear_kernel_hedgehog__mha_block__prompt_kernel_b_att
L_interleave_layers__linear_kernel_hedgehog__mha_block__prompt_kernel_b_cfin:
s_branch L_interleave_layers__linear_kernel_hedgehog__mha_block__prompt_kernel_p
L_interleave_layers__linear_kernel_hedgehog__mha_block__prompt_kernel_gL:
s_mul_i32 s31, s29, 4194304
s_add_u32 s31, s31, 0
s_add_u32 s36, s4, s31
s_addc_u32 s37, s5, 0
s_mov_b32 s38, 4194304
s_mov_b32 s39, 0x20000
s_mul_i32 s31, s29, 2048
s_lshl_b32 s65, s20, 7
s_add_u32 s65, s65, s31
s_add_u32 s65, s65, 0
s_lshl_b32 s31, s21, 2
s_add_u32 s66, s65, s31
s_lshl_b32 s31, s20, 2
s_add_u32 s31, s31, s27
s_lshl_b32 s63, s31, 16
s_mov_b32 s72, 0
s_bitset1_b32 s72, s21
s_mov_b32 s71, s72
s_mov_b32 s66, 0
s_lshl_b32 s75, s29, 1
s_add_u32 s75, s75, 1
s_mov_b32 s74, 0
s_mov_b32 s76, 0
s_mov_b32 s68, 0
s_lshl_b32 s56, s21, 12
s_add_u32 s56, s56, s63
s_add_u32 m0, s60, s61
s_nop 0
buffer_load_dwordx4 v239, s[36:39], s56 offen offset:0 sc1 lds
buffer_load_dwordx4 v239, s[36:39], s56 offen offset:1024 sc1 lds
s_add_u32 s56, s56, 2048
s_add_u32 s60, s60, 20480
s_cmp_eq_u32 s60, 151552
s_cselect_b32 s60, 8192, s60
s_add_u32 m0, s60, s61
s_nop 0
buffer_load_dwordx4 v239, s[36:39], s56 offen offset:0 sc1 lds
buffer_load_dwordx4 v239, s[36:39], s56 offen offset:1024 sc1 lds
s_add_u32 s56, s56, 2048
s_add_u32 s60, s60, 20480
s_cmp_eq_u32 s60, 151552
s_cselect_b32 s60, 8192, s60
s_cmp_lg_u32 s68, 0
s_cbranch_scc1 L_interleave_layers__linear_kernel_hedgehog__mha_block__prompt_kernel_g_b1_go
s_cmp_eq_u32 s76, 0
s_cbranch_scc1 L_interleave_layers__linear_kernel_hedgehog__mha_block__prompt_kernel_g_b1_slow
s_andn2_b32 s32, 0xffff, s72
s_lshl_b32 s33, s32, 16
s_or_b32 s33, s33, s32
s_lshr_b32 s33, s33, s66
s_ff1_i32_b32 s33, s33
s_add_u32 s33, s33, s66
s_and_b32 s73, s33, 15
s_bitset1_b32 s72, s73
s_branch L_interleave_layers__linear_kernel_hedgehog__mha_block__prompt_kernel_g_b1_ok
L_interleave_layers__linear_kernel_hedgehog__mha_block__prompt_kernel_g_b1_slow:
s_mov_b32 s34, 2097152
s_cmp_lg_u32 s27, 0
s_cbranch_scc1 L_interleave_layers__linear_kernel_hedgehog__mha_block__prompt_kernel_g_b1_rd
v_mov_b32 v3, 2244
ds_read_b32 v1, v3
s_waitcnt lgkmcnt(0)
v_readfirstlane_b32 s31, v1
s_nop 0
s_lshr_b32 s32, s31, 16
s_cmp_eq_u32 s32, s75
s_cselect_b32 s31, s31, 0
s_and_b32 s31, s31, 0xffff
s_or_b32 s71, s71, s31
L_interleave_layers__linear_kernel_hedgehog__mha_block__prompt_kernel_g_b1_ch:
s_andn2_b32 s32, s71, s72
s_cbranch_scc1 L_interleave_layers__linear_kernel_hedgehog__mha_block__prompt_kernel_g_b1_hv
s_mov_b32 exec_lo, 0xffff
s_mov_b32 exec_hi, 0
v_lshlrev_b32 v2, 2, v0
buffer_load_dword v1, v2, s[52:55], s65 offen sc1
s_waitcnt vmcnt(0)
v_cmp_eq_u32 vcc, s35, v1
s_mov_b64 exec, -1
s_or_b32 s71, s71, vcc_lo
s_andn2_b32 s32, s71, s72
s_cbranch_scc1 L_interleave_layers__linear_kernel_hedgehog__mha_block__prompt_kernel_g_b1_hv
s_sub_u32 s34, s34, 1
s_cmp_lg_u32 s34, 0
s_cbranch_scc1 L_interleave_layers__linear_kernel_hedgehog__mha_block__prompt_kernel_g_b1_ch
s_orn2_b32 s32, 0, s72
s_and_b32 s32, s32, 0xffff
L_interleave_layers__linear_kernel_hedgehog__mha_block__prompt_kernel_g_b1_hv:
s_lshl_b32 s33, s32, 16
s_or_b32 s33, s33, s32
s_lshr_b32 s33, s33, s66
s_ff1_i32_b32 s33, s33
s_add_u32 s33, s33, s66
s_and_b32 s73, s33, 15
s_bitset1_b32 s72, s73
s_cmp_eq_u32 s71, 0xffff
s_cselect_b32 s77, 1, 0
s_lshl_b32 s31, s77, 7
s_or_b32 s31, s31, s73
s_lshl_b32 s33, s75, 8
s_or_b32 s31, s31, s33
v_mov_b32 v1, s31
s_lshl_b32 s31, s74, 2
v_mov_b32 v3, s31
ds_write_b32 v3, v1 offset:2176
L_interleave_layers__linear_kernel_hedgehog__mha_block__prompt_kernel_g_b1_got:
s_mov_b32 s76, s77
s_branch L_interleave_layers__linear_kernel_hedgehog__mha_block__prompt_kernel_g_b1_adv
L_interleave_layers__linear_kernel_hedgehog__mha_block__prompt_kernel_g_b1_rd:
s_lshl_b32 s31, s74, 2
v_mov_b32 v3, s31
L_interleave_layers__linear_kernel_hedgehog__mha_block__prompt_kernel_g_b1_rl:
ds_read_b32 v1, v3 offset:2176
s_waitcnt lgkmcnt(0)
v_readfirstlane_b32 s31, v1
s_nop 0
s_and_b32 s73, s31, 15
s_bfe_u32 s76, s31, 0x10007
s_lshr_b32 s31, s31, 8
s_cmp_eq_u32 s31, s75
s_cbranch_scc1 L_interleave_layers__linear_kernel_hedgehog__mha_block__prompt_kernel_g_b1_rok
s_sub_u32 s34, s34, 1
s_cmp_lg_u32 s34, 0
s_cbranch_scc1 L_interleave_layers__linear_kernel_hedgehog__mha_block__prompt_kernel_g_b1_rl
L_interleave_layers__linear_kernel_hedgehog__mha_block__prompt_kernel_g_b1_rok:
s_bitset1_b32 s72, s73
L_interleave_layers__linear_kernel_hedgehog__mha_block__prompt_kernel_g_b1_adv:
s_add_u32 s74, s74, 1
L_interleave_layers__linear_kernel_hedgehog__mha_block__prompt_kernel_g_b1_ok:
L_interleave_layers__linear_kernel_hedgehog__mha_block__prompt_kernel_g_b1_go:
s_mov_b32 s68, 0
s_lshl_b32 s56, s73, 12
s_add_u32 s56, s56, s63
s_mul_i32 s57, s73, 393216
s_add_u32 s57, s57, s59
s_add_u32 m0, s60, s61
s_nop 0
buffer_load_dwordx4 v239, s[36:39], s56 offen offset:0 sc1 lds
buffer_load_dwordx4 v239, s[36:39], s56 offen offset:1024 sc1 lds
s_add_u32 m0, s60, s62
s_add_u32 s56, s56, 2048
buffer_load_dwordx4 v232, s[40:43], s57 offen lds
s_add_u32 m0, s60, s58
s_nop 0
buffer_load_dwordx4 v233, s[40:43], s57 offen lds
s_add_u32 m0, s60, s78
s_nop 0
buffer_load_dwordx4 v235, s[40:43], s57 offen lds
s_add_u32 s57, s57, 196608
s_add_u32 s60, s60, 20480
s_cmp_eq_u32 s60, 151552
s_cselect_b32 s60, 8192, s60
s_add_u32 m0, s60, s61
s_nop 0
buffer_load_dwordx4 v239, s[36:39], s56 offen offset:0 sc1 lds
buffer_load_dwordx4 v239, s[36:39], s56 offen offset:1024 sc1 lds
s_add_u32 m0, s60, s62
s_add_u32 s56, s56, 2048
buffer_load_dwordx4 v232, s[40:43], s57 offen lds
s_add_u32 m0, s60, s58
s_nop 0
buffer_load_dwordx4 v233, s[40:43], s57 offen lds
s_add_u32 m0, s60, s78
s_nop 0
buffer_load_dwordx4 v235, s[40:43], s57 offen lds
s_add_u32 s57, s57, 196608
s_add_u32 s60, s60, 20480
s_cmp_eq_u32 s60, 151552
s_cselect_b32 s60, 8192, s60
s_waitcnt vmcnt(10)
s_barrier
s_cmp_ge_u32 s29, 2
s_cbranch_scc1 L_interleave_layers__linear_kernel_hedgehog__mha_block__prompt_kernel_g_nb0
s_barrier
L_interleave_layers__linear_kernel_hedgehog__mha_block__prompt_kernel_g_nb0:
s_cmp_lg_u32 s68, 0
s_cbranch_scc1 L_interleave_layers__linear_kernel_hedgehog__mha_block__prompt_kernel_g_b2_go
s_cmp_eq_u32 s76, 0
s_cbranch_scc1 L_interleave_layers__linear_kernel_hedgehog__mha_block__prompt_kernel_g_b2_slow
s_andn2_b32 s32, 0xffff, s72
s_lshl_b32 s33, s32, 16
s_or_b32 s33, s33, s32
s_lshr_b32 s33, s33, s66
s_ff1_i32_b32 s33, s33
s_add_u32 s33, s33, s66
s_and_b32 s73, s33, 15
s_bitset1_b32 s72, s73
s_branch L_interleave_layers__linear_kernel_hedgehog__mha_block__prompt_kernel_g_b2_ok
L_interleave_layers__linear_kernel_hedgehog__mha_block__prompt_kernel_g_b2_slow:
s_mov_b32 s34, 2097152
s_cmp_lg_u32 s27, 0
s_cbranch_scc1 L_interleave_layers__linear_kernel_hedgehog__mha_block__prompt_kernel_g_b2_rd
v_mov_b32 v3, 2244
ds_read_b32 v1, v3
s_waitcnt lgkmcnt(0)
v_readfirstlane_b32 s31, v1
s_nop 0
s_lshr_b32 s32, s31, 16
s_cmp_eq_u32 s32, s75
s_cselect_b32 s31, s31, 0
s_and_b32 s31, s31, 0xffff
s_or_b32 s71, s71, s31
L_interleave_layers__linear_kernel_hedgehog__mha_block__prompt_kernel_g_b2_ch:
s_andn2_b32 s32, s71, s72
s_cbranch_scc1 L_interleave_layers__linear_kernel_hedgehog__mha_block__prompt_kernel_g_b2_hv
s_mov_b32 exec_lo, 0xffff
s_mov_b32 exec_hi, 0
v_lshlrev_b32 v2, 2, v0
buffer_load_dword v1, v2, s[52:55], s65 offen sc1
s_waitcnt vmcnt(0)
v_cmp_eq_u32 vcc, s35, v1
s_mov_b64 exec, -1
s_or_b32 s71, s71, vcc_lo
s_andn2_b32 s32, s71, s72
s_cbranch_scc1 L_interleave_layers__linear_kernel_hedgehog__mha_block__prompt_kernel_g_b2_hv
s_sub_u32 s34, s34, 1
s_cmp_lg_u32 s34, 0
s_cbranch_scc1 L_interleave_layers__linear_kernel_hedgehog__mha_block__prompt_kernel_g_b2_ch
s_orn2_b32 s32, 0, s72
s_and_b32 s32, s32, 0xffff
L_interleave_layers__linear_kernel_hedgehog__mha_block__prompt_kernel_g_b2_hv:
s_lshl_b32 s33, s32, 16
s_or_b32 s33, s33, s32
s_lshr_b32 s33, s33, s66
s_ff1_i32_b32 s33, s33
s_add_u32 s33, s33, s66
s_and_b32 s73, s33, 15
s_bitset1_b32 s72, s73
s_cmp_eq_u32 s71, 0xffff
s_cselect_b32 s77, 1, 0
s_lshl_b32 s31, s77, 7
s_or_b32 s31, s31, s73
s_lshl_b32 s33, s75, 8
s_or_b32 s31, s31, s33
v_mov_b32 v1, s31
s_lshl_b32 s31, s74, 2
v_mov_b32 v3, s31
ds_write_b32 v3, v1 offset:2176
L_interleave_layers__linear_kernel_hedgehog__mha_block__prompt_kernel_g_b2_got:
s_mov_b32 s76, s77
s_branch L_interleave_layers__linear_kernel_hedgehog__mha_block__prompt_kernel_g_b2_adv
L_interleave_layers__linear_kernel_hedgehog__mha_block__prompt_kernel_g_b2_rd:
s_lshl_b32 s31, s74, 2
v_mov_b32 v3, s31
L_interleave_layers__linear_kernel_hedgehog__mha_block__prompt_kernel_g_b2_rl:
ds_read_b32 v1, v3 offset:2176
s_waitcnt lgkmcnt(0)
v_readfirstlane_b32 s31, v1
s_nop 0
s_and_b32 s73, s31, 15
s_bfe_u32 s76, s31, 0x10007
s_lshr_b32 s31, s31, 8
s_cmp_eq_u32 s31, s75
s_cbranch_scc1 L_interleave_layers__linear_kernel_hedgehog__mha_block__prompt_kernel_g_b2_rok
s_sub_u32 s34, s34, 1
s_cmp_lg_u32 s34, 0
s_cbranch_scc1 L_interleave_layers__linear_kernel_hedgehog__mha_block__prompt_kernel_g_b2_rl
L_interleave_layers__linear_kernel_hedgehog__mha_block__prompt_kernel_g_b2_rok:
s_bitset1_b32 s72, s73
L_interleave_layers__linear_kernel_hedgehog__mha_block__prompt_kernel_g_b2_adv:
s_add_u32 s74, s74, 1
L_interleave_layers__linear_kernel_hedgehog__mha_block__prompt_kernel_g_b2_ok:
L_interleave_layers__linear_kernel_hedgehog__mha_block__prompt_kernel_g_b2_go:
s_mov_b32 s68, 0
s_lshl_b32 s56, s73, 12
s_add_u32 s56, s56, s63
s_mul_i32 s57, s73, 393216
s_add_u32 s57, s57, s59
s_add_u32 m0, s60, s61
s_nop 0
buffer_load_dwordx4 v239, s[36:39], s56 offen offset:0 sc1 lds
buffer_load_dwordx4 v239, s[36:39], s56 offen offset:1024 sc1 lds
s_add_u32 m0, s60, s62
s_add_u32 s56, s56, 2048
buffer_load_dwordx4 v232, s[40:43], s57 offen lds
s_add_u32 m0, s60, s58
s_nop 0
buffer_load_dwordx4 v233, s[40:43], s57 offen lds
s_add_u32 m0, s60, s78
s_nop 0
buffer_load_dwordx4 v235, s[40:43], s57 offen lds
s_add_u32 s57, s57, 196608
s_add_u32 s60, s60, 20480
s_cmp_eq_u32 s60, 151552
s_cselect_b32 s60, 8192, s60
s_add_u32 m0, s60, s61
s_nop 0
buffer_load_dwordx4 v239, s[36:39], s56 offen offset:0 sc1 lds
buffer_load_dwordx4 v239, s[36:39], s56 offen offset:1024 sc1 lds
s_add_u32 m0, s60, s62
s_add_u32 s56, s56, 2048
buffer_load_dwordx4 v232, s[40:43], s57 offen lds
s_add_u32 m0, s60, s58
s_nop 0
buffer_load_dwordx4 v233, s[40:43], s57 offen lds
s_add_u32 m0, s60, s78
s_nop 0
buffer_load_dwordx4 v235, s[40:43], s57 offen lds
s_add_u32 s57, s57, 196608
s_add_u32 s60, s60, 20480
s_cmp_eq_u32 s60, 151552
s_cselect_b32 s60, 8192, s60
s_cmp_lg_u32 s68, 0
s_cbranch_scc1 L_interleave_layers__linear_kernel_hedgehog__mha_block__prompt_kernel_g_b3_go
s_cmp_eq_u32 s76, 0
s_cbranch_scc1 L_interleave_layers__linear_kernel_hedgehog__mha_block__prompt_kernel_g_b3_slow
s_andn2_b32 s32, 0xffff, s72
s_lshl_b32 s33, s32, 16
s_or_b32 s33, s33, s32
s_lshr_b32 s33, s33, s66
s_ff1_i32_b32 s33, s33
s_add_u32 s33, s33, s66
s_and_b32 s73, s33, 15
s_bitset1_b32 s72, s73
s_branch L_interleave_layers__linear_kernel_hedgehog__mha_block__prompt_kernel_g_b3_ok
L_interleave_layers__linear_kernel_hedgehog__mha_block__prompt_kernel_g_b3_slow:
s_mov_b32 s34, 2097152
s_cmp_lg_u32 s27, 0
s_cbranch_scc1 L_interleave_layers__linear_kernel_hedgehog__mha_block__prompt_kernel_g_b3_rd
v_mov_b32 v3, 2244
ds_read_b32 v1, v3
s_waitcnt lgkmcnt(0)
v_readfirstlane_b32 s31, v1
s_nop 0
s_lshr_b32 s32, s31, 16
s_cmp_eq_u32 s32, s75
s_cselect_b32 s31, s31, 0
s_and_b32 s31, s31, 0xffff
s_or_b32 s71, s71, s31
L_interleave_layers__linear_kernel_hedgehog__mha_block__prompt_kernel_g_b3_ch:
s_andn2_b32 s32, s71, s72
s_cbranch_scc1 L_interleave_layers__linear_kernel_hedgehog__mha_block__prompt_kernel_g_b3_hv
s_mov_b32 exec_lo, 0xffff
s_mov_b32 exec_hi, 0
v_lshlrev_b32 v2, 2, v0
buffer_load_dword v1, v2, s[52:55], s65 offen sc1
s_waitcnt vmcnt(0)
v_cmp_eq_u32 vcc, s35, v1
s_mov_b64 exec, -1
s_or_b32 s71, s71, vcc_lo
s_andn2_b32 s32, s71, s72
s_cbranch_scc1 L_interleave_layers__linear_kernel_hedgehog__mha_block__prompt_kernel_g_b3_hv
s_sub_u32 s34, s34, 1
s_cmp_lg_u32 s34, 0
s_cbranch_scc1 L_interleave_layers__linear_kernel_hedgehog__mha_block__prompt_kernel_g_b3_ch
s_orn2_b32 s32, 0, s72
s_and_b32 s32, s32, 0xffff
L_interleave_layers__linear_kernel_hedgehog__mha_block__prompt_kernel_g_b3_hv:
s_lshl_b32 s33, s32, 16
s_or_b32 s33, s33, s32
s_lshr_b32 s33, s33, s66
s_ff1_i32_b32 s33, s33
s_add_u32 s33, s33, s66
s_and_b32 s73, s33, 15
s_bitset1_b32 s72, s73
s_cmp_eq_u32 s71, 0xffff
s_cselect_b32 s77, 1, 0
s_lshl_b32 s31, s77, 7
s_or_b32 s31, s31, s73
s_lshl_b32 s33, s75, 8
s_or_b32 s31, s31, s33
v_mov_b32 v1, s31
s_lshl_b32 s31, s74, 2
v_mov_b32 v3, s31
ds_write_b32 v3, v1 offset:2176
L_interleave_layers__linear_kernel_hedgehog__mha_block__prompt_kernel_g_b3_got:
s_mov_b32 s76, s77
s_branch L_interleave_layers__linear_kernel_hedgehog__mha_block__prompt_kernel_g_b3_adv
L_interleave_layers__linear_kernel_hedgehog__mha_block__prompt_kernel_g_b3_rd:
s_lshl_b32 s31, s74, 2
v_mov_b32 v3, s31
L_interleave_layers__linear_kernel_hedgehog__mha_block__prompt_kernel_g_b3_rl:
ds_read_b32 v1, v3 offset:2176
s_waitcnt lgkmcnt(0)
v_readfirstlane_b32 s31, v1
s_nop 0
s_and_b32 s73, s31, 15
s_bfe_u32 s76, s31, 0x10007
s_lshr_b32 s31, s31, 8
s_cmp_eq_u32 s31, s75
s_cbranch_scc1 L_interleave_layers__linear_kernel_hedgehog__mha_block__prompt_kernel_g_b3_rok
s_sub_u32 s34, s34, 1
s_cmp_lg_u32 s34, 0
s_cbranch_scc1 L_interleave_layers__linear_kernel_hedgehog__mha_block__prompt_kernel_g_b3_rl
L_interleave_layers__linear_kernel_hedgehog__mha_block__prompt_kernel_g_b3_rok:
s_bitset1_b32 s72, s73
L_interleave_layers__linear_kernel_hedgehog__mha_block__prompt_kernel_g_b3_adv:
s_add_u32 s74, s74, 1
L_interleave_layers__linear_kernel_hedgehog__mha_block__prompt_kernel_g_b3_ok:
L_interleave_layers__linear_kernel_hedgehog__mha_block__prompt_kernel_g_b3_go:
s_mov_b32 s68, 0
s_lshl_b32 s56, s73, 12
s_add_u32 s56, s56, s63
s_mul_i32 s57, s73, 393216
s_add_u32 s57, s57, s59
s_add_u32 m0, s60, s61
s_nop 0
buffer_load_dwordx4 v239, s[36:39], s56 offen offset:0 sc1 lds
buffer_load_dwordx4 v239, s[36:39], s56 offen offset:1024 sc1 lds
s_add_u32 m0, s60, s62
s_add_u32 s56, s56, 2048
buffer_load_dwordx4 v232, s[40:43], s57 offen lds
s_add_u32 m0, s60, s58
s_nop 0
buffer_load_dwordx4 v233, s[40:43], s57 offen lds
s_add_u32 m0, s60, s78
s_nop 0
buffer_load_dwordx4 v235, s[40:43], s57 offen lds
s_add_u32 s57, s57, 196608
s_add_u32 s60, s60, 20480
s_cmp_eq_u32 s60, 151552
s_cselect_b32 s60, 8192, s60
s_cmp_eq_u32 s76, 0
s_cbranch_scc1 L_interleave_layers__linear_kernel_hedgehog__mha_block__prompt_kernel_g_l3
s_andn2_b32 s32, 0xffff, s72
s_ff1_i32_b32 s73, s32
s_mov_b32 s68, 1
s_bitset1_b32 s72, s73
L_interleave_layers__linear_kernel_hedgehog__mha_block__prompt_kernel_g_l3:
s_waitcnt vmcnt(15)
s_barrier
s_lshr_b32 s31, s29, 1
s_or_b32 s31, s31, s27
s_cmp_eq_u32 s31, 0
s_cselect_b32 s69, 8, 99
s_cselect_b32 s79, 1, 99
s_cbranch_scc0 L_interleave_layers__linear_kernel_hedgehog__mha_block__prompt_kernel_g_nopc
s_mul_i32 s31, s29, 2048
s_lshl_b32 s70, s21, 7
s_add_u32 s70, s70, s31
s_add_u32 s70, s70, 24576
s_lshl_b32 s31, s20, 2
s_add_u32 s67, s70, s31
v_mov_b32 v1, s35
v_mov_b32 v2, 0
s_mov_b64 exec, 1
buffer_store_dword v1, v2, s[52:55], s67 offen sc1
s_mov_b64 exec, -1
L_interleave_layers__linear_kernel_hedgehog__mha_block__prompt_kernel_g_nopc:
s_mov_b32 s64, 11
L_interleave_layers__linear_kernel_hedgehog__mha_block__prompt_kernel_g_ld:
s_add_u32 m0, s60, s61
s_nop 0
buffer_load_dwordx4 v239, s[36:39], s56 offen offset:0 sc1 lds
buffer_load_dwordx4 v239, s[36:39], s56 offen offset:1024 sc1 lds
s_add_u32 m0, s60, s62
s_add_u32 s56, s56, 2048
buffer_load_dwordx4 v232, s[40:43], s57 offen lds
s_add_u32 m0, s60, s58
s_nop 0
buffer_load_dwordx4 v233, s[40:43], s57 offen lds
s_add_u32 m0, s60, s78
s_nop 0
buffer_load_dwordx4 v235, s[40:43], s57 offen lds
s_add_u32 s57, s57, 196608
s_add_u32 s60, s60, 20480
s_cmp_eq_u32 s60, 151552
s_cselect_b32 s60, 8192, s60
s_cmp_lg_u32 s64, s69
s_cbranch_scc1 L_interleave_layers__linear_kernel_hedgehog__mha_block__prompt_kernel_g_nofi
s_mov_b32 exec_lo, 0xffff
s_mov_b32 exec_hi, 0
v_lshlrev_b32 v2, 2, v0
buffer_load_dword v6, v2, s[52:55], s70 offen sc1
s_mov_b64 exec, -1
L_interleave_layers__linear_kernel_hedgehog__mha_block__prompt_kernel_g_nofi:
s_cmp_lg_u32 s68, 0
s_cbranch_scc1 L_interleave_layers__linear_kernel_hedgehog__mha_block__prompt_kernel_g_bl_go
s_cmp_eq_u32 s76, 0
s_cbranch_scc1 L_interleave_layers__linear_kernel_hedgehog__mha_block__prompt_kernel_g_bl_slow
s_andn2_b32 s32, 0xffff, s72
s_lshl_b32 s33, s32, 16
s_or_b32 s33, s33, s32
s_lshr_b32 s33, s33, s66
s_ff1_i32_b32 s33, s33
s_add_u32 s33, s33, s66
s_and_b32 s73, s33, 15
s_bitset1_b32 s72, s73
s_branch L_interleave_layers__linear_kernel_hedgehog__mha_block__prompt_kernel_g_bl_ok
L_interleave_layers__linear_kernel_hedgehog__mha_block__prompt_kernel_g_bl_slow:
s_mov_b32 s34, 2097152
s_cmp_lg_u32 s27, 0
s_cbranch_scc1 L_interleave_layers__linear_kernel_hedgehog__mha_block__prompt_kernel_g_bl_rd
v_mov_b32 v3, 2244
ds_read_b32 v1, v3
s_waitcnt lgkmcnt(0)
v_readfirstlane_b32 s31, v1
s_nop 0
s_lshr_b32 s32, s31, 16
s_cmp_eq_u32 s32, s75
s_cselect_b32 s31, s31, 0
s_and_b32 s31, s31, 0xffff
s_or_b32 s71, s71, s31
L_interleave_layers__linear_kernel_hedgehog__mha_block__prompt_kernel_g_bl_ch:
s_andn2_b32 s32, s71, s72
s_cbranch_scc1 L_interleave_layers__linear_kernel_hedgehog__mha_block__prompt_kernel_g_bl_hv
s_mov_b32 exec_lo, 0xffff
s_mov_b32 exec_hi, 0
v_lshlrev_b32 v2, 2, v0
buffer_load_dword v1, v2, s[52:55], s65 offen sc1
s_waitcnt vmcnt(0)
v_cmp_eq_u32 vcc, s35, v1
s_mov_b64 exec, -1
s_or_b32 s71, s71, vcc_lo
s_andn2_b32 s32, s71, s72
s_cbranch_scc1 L_interleave_layers__linear_kernel_hedgehog__mha_block__prompt_kernel_g_bl_hv
s_sub_u32 s34, s34, 1
s_cmp_lg_u32 s34, 0
s_cbranch_scc1 L_interleave_layers__linear_kernel_hedgehog__mha_block__prompt_kernel_g_bl_ch
s_orn2_b32 s32, 0, s72
s_and_b32 s32, s32, 0xffff
L_interleave_layers__linear_kernel_hedgehog__mha_block__prompt_kernel_g_bl_hv:
s_lshl_b32 s33, s32, 16
s_or_b32 s33, s33, s32
s_lshr_b32 s33, s33, s66
s_ff1_i32_b32 s33, s33
s_add_u32 s33, s33, s66
s_and_b32 s73, s33, 15
s_bitset1_b32 s72, s73
s_cmp_eq_u32 s71, 0xffff
s_cselect_b32 s77, 1, 0
s_lshl_b32 s31, s77, 7
s_or_b32 s31, s31, s73
s_lshl_b32 s33, s75, 8
s_or_b32 s31, s31, s33
v_mov_b32 v1, s31
s_lshl_b32 s31, s74, 2
v_mov_b32 v3, s31
ds_write_b32 v3, v1 offset:2176
L_interleave_layers__linear_kernel_hedgehog__mha_block__prompt_kernel_g_bl_got:
s_mov_b32 s76, s77
s_branch L_interleave_layers__linear_kernel_hedgehog__mha_block__prompt_kernel_g_bl_adv
L_interleave_layers__linear_kernel_hedgehog__mha_block__prompt_kernel_g_bl_rd:
s_lshl_b32 s31, s74, 2
v_mov_b32 v3, s31
L_interleave_layers__linear_kernel_hedgehog__mha_block__prompt_kernel_g_bl_rl:
ds_read_b32 v1, v3 offset:2176
s_waitcnt lgkmcnt(0)
v_readfirstlane_b32 s31, v1
s_nop 0
s_and_b32 s73, s31, 15
s_bfe_u32 s76, s31, 0x10007
s_lshr_b32 s31, s31, 8
s_cmp_eq_u32 s31, s75
s_cbranch_scc1 L_interleave_layers__linear_kernel_hedgehog__mha_block__prompt_kernel_g_bl_rok
s_sub_u32 s34, s34, 1
s_cmp_lg_u32 s34, 0
s_cbranch_scc1 L_interleave_layers__linear_kernel_hedgehog__mha_block__prompt_kernel_g_bl_rl
L_interleave_layers__linear_kernel_hedgehog__mha_block__prompt_kernel_g_bl_rok:
s_bitset1_b32 s72, s73
L_interleave_layers__linear_kernel_hedgehog__mha_block__prompt_kernel_g_bl_adv:
s_add_u32 s74, s74, 1
L_interleave_layers__linear_kernel_hedgehog__mha_block__prompt_kernel_g_bl_ok:
L_interleave_layers__linear_kernel_hedgehog__mha_block__prompt_kernel_g_bl_go:
s_mov_b32 s68, 0
s_lshl_b32 s56, s73, 12
s_add_u32 s56, s56, s63
s_mul_i32 s57, s73, 393216
s_add_u32 s57, s57, s59
s_add_u32 m0, s60, s61
s_nop 0
buffer_load_dwordx4 v239, s[36:39], s56 offen offset:0 sc1 lds
buffer_load_dwordx4 v239, s[36:39], s56 offen offset:1024 sc1 lds
s_add_u32 m0, s60, s62
s_add_u32 s56, s56, 2048
buffer_load_dwordx4 v232, s[40:43], s57 offen lds
s_add_u32 m0, s60, s58
s_nop 0
buffer_load_dwordx4 v233, s[40:43], s57 offen lds
s_add_u32 m0, s60, s78
s_nop 0
buffer_load_dwordx4 v235, s[40:43], s57 offen lds
s_add_u32 s57, s57, 196608
s_add_u32 s60, s60, 20480
s_cmp_eq_u32 s60, 151552
s_cselect_b32 s60, 8192, s60
s_cmp_eq_u32 s76, 0
s_cbranch_scc1 L_interleave_layers__linear_kernel_hedgehog__mha_block__prompt_kernel_g_lx
s_andn2_b32 s32, 0xffff, s72
s_ff1_i32_b32 s73, s32
s_mov_b32 s68, 1
s_bitset1_b32 s72, s73
L_interleave_layers__linear_kernel_hedgehog__mha_block__prompt_kernel_g_lx:
s_cmp_lg_u32 s64, s79
s_cbranch_scc1 L_interleave_layers__linear_kernel_hedgehog__mha_block__prompt_kernel_g_nofc
s_mov_b32 exec_lo, 0xffff
s_mov_b32 exec_hi, 0
v_cmp_eq_u32 vcc, s35, v6
s_mov_b64 exec, -1
s_cmp_eq_u32 vcc_lo, 0xffff
s_cbranch_scc1 L_interleave_layers__linear_kernel_hedgehog__mha_block__prompt_kernel_g_nofc
s_mov_b32 s67, s71
s_mov_b32 s71, 0
s_mov_b32 s34, 2097152
L_interleave_layers__linear_kernel_hedgehog__mha_block__prompt_kernel_g_fc:
s_mov_b32 exec_lo, 0xffff
s_mov_b32 exec_hi, 0
v_lshlrev_b32 v2, 2, v0
buffer_load_dword v1, v2, s[52:55], s70 offen sc1
s_waitcnt vmcnt(0)
v_cmp_eq_u32 vcc, s35, v1
s_mov_b64 exec, -1
s_or_b32 s71, s71, vcc_lo
s_cmp_eq_u32 s71, 0xffff
s_cbranch_scc1 L_interleave_layers__linear_kernel_hedgehog__mha_block__prompt_kernel_g_fc_ok
s_sub_u32 s34, s34, 1
s_cmp_lg_u32 s34, 0
s_cbranch_scc1 L_interleave_layers__linear_kernel_hedgehog__mha_block__prompt_kernel_g_fc
L_interleave_layers__linear_kernel_hedgehog__mha_block__prompt_kernel_g_fc_ok:
s_mov_b32 s71, s67
L_interleave_layers__linear_kernel_hedgehog__mha_block__prompt_kernel_g_nofc:
s_waitcnt vmcnt(15)
s_sub_u32 s64, s64, 1
s_cmp_lg_u32 s64, 0
s_barrier
s_cbranch_scc1 L_interleave_layers__linear_kernel_hedgehog__mha_block__prompt_kernel_g_ld
s_add_u32 m0, s60, s61
s_nop 0
buffer_load_dwordx4 v239, s[36:39], s56 offen offset:0 sc1 lds
buffer_load_dwordx4 v239, s[36:39], s56 offen offset:1024 sc1 lds
s_add_u32 m0, s60, s62
s_add_u32 s56, s56, 2048
buffer_load_dwordx4 v232, s[40:43], s57 offen lds
s_add_u32 m0, s60, s58
s_nop 0
buffer_load_dwordx4 v233, s[40:43], s57 offen lds
s_add_u32 m0, s60, s78
s_nop 0
buffer_load_dwordx4 v235, s[40:43], s57 offen lds
s_add_u32 s57, s57, 196608
s_add_u32 s60, s60, 20480
s_cmp_eq_u32 s60, 151552
s_cselect_b32 s60, 8192, s60
s_cmp_lg_u32 s68, 0
s_cbranch_scc1 L_interleave_layers__linear_kernel_hedgehog__mha_block__prompt_kernel_g_bz_go
s_cmp_eq_u32 s76, 0
s_cbranch_scc1 L_interleave_layers__linear_kernel_hedgehog__mha_block__prompt_kernel_g_bz_slow
s_andn2_b32 s32, 0xffff, s72
s_lshl_b32 s33, s32, 16
s_or_b32 s33, s33, s32
s_lshr_b32 s33, s33, s66
s_ff1_i32_b32 s33, s33
s_add_u32 s33, s33, s66
s_and_b32 s73, s33, 15
s_bitset1_b32 s72, s73
s_branch L_interleave_layers__linear_kernel_hedgehog__mha_block__prompt_kernel_g_bz_ok
L_interleave_layers__linear_kernel_hedgehog__mha_block__prompt_kernel_g_bz_slow:
s_mov_b32 s34, 2097152
s_cmp_lg_u32 s27, 0
s_cbranch_scc1 L_interleave_layers__linear_kernel_hedgehog__mha_block__prompt_kernel_g_bz_rd
v_mov_b32 v3, 2244
ds_read_b32 v1, v3
s_waitcnt lgkmcnt(0)
v_readfirstlane_b32 s31, v1
s_nop 0
s_lshr_b32 s32, s31, 16
s_cmp_eq_u32 s32, s75
s_cselect_b32 s31, s31, 0
s_and_b32 s31, s31, 0xffff
s_or_b32 s71, s71, s31
L_interleave_layers__linear_kernel_hedgehog__mha_block__prompt_kernel_g_bz_ch:
s_andn2_b32 s32, s71, s72
s_cbranch_scc1 L_interleave_layers__linear_kernel_hedgehog__mha_block__prompt_kernel_g_bz_hv
s_mov_b32 exec_lo, 0xffff
s_mov_b32 exec_hi, 0
v_lshlrev_b32 v2, 2, v0
buffer_load_dword v1, v2, s[52:55], s65 offen sc1
s_waitcnt vmcnt(0)
v_cmp_eq_u32 vcc, s35, v1
s_mov_b64 exec, -1
s_or_b32 s71, s71, vcc_lo
s_andn2_b32 s32, s71, s72
s_cbranch_scc1 L_interleave_layers__linear_kernel_hedgehog__mha_block__prompt_kernel_g_bz_hv
s_sub_u32 s34, s34, 1
s_cmp_lg_u32 s34, 0
s_cbranch_scc1 L_interleave_layers__linear_kernel_hedgehog__mha_block__prompt_kernel_g_bz_ch
s_orn2_b32 s32, 0, s72
s_and_b32 s32, s32, 0xffff
L_interleave_layers__linear_kernel_hedgehog__mha_block__prompt_kernel_g_bz_hv:
s_lshl_b32 s33, s32, 16
s_or_b32 s33, s33, s32
s_lshr_b32 s33, s33, s66
s_ff1_i32_b32 s33, s33
s_add_u32 s33, s33, s66
s_and_b32 s73, s33, 15
s_bitset1_b32 s72, s73
s_cmp_eq_u32 s71, 0xffff
s_cselect_b32 s77, 1, 0
s_lshl_b32 s31, s77, 7
s_or_b32 s31, s31, s73
s_lshl_b32 s33, s75, 8
s_or_b32 s31, s31, s33
v_mov_b32 v1, s31
s_lshl_b32 s31, s74, 2
v_mov_b32 v3, s31
ds_write_b32 v3, v1 offset:2176
L_interleave_layers__linear_kernel_hedgehog__mha_block__prompt_kernel_g_bz_got:
s_mov_b32 s76, s77
s_branch L_interleave_layers__linear_kernel_hedgehog__mha_block__prompt_kernel_g_bz_adv
L_interleave_layers__linear_kernel_hedgehog__mha_block__prompt_kernel_g_bz_rd:
s_lshl_b32 s31, s74, 2
v_mov_b32 v3, s31
L_interleave_layers__linear_kernel_hedgehog__mha_block__prompt_kernel_g_bz_rl:
ds_read_b32 v1, v3 offset:2176
s_waitcnt lgkmcnt(0)
v_readfirstlane_b32 s31, v1
s_nop 0
s_and_b32 s73, s31, 15
s_bfe_u32 s76, s31, 0x10007
s_lshr_b32 s31, s31, 8
s_cmp_eq_u32 s31, s75
s_cbranch_scc1 L_interleave_layers__linear_kernel_hedgehog__mha_block__prompt_kernel_g_bz_rok
s_sub_u32 s34, s34, 1
s_cmp_lg_u32 s34, 0
s_cbranch_scc1 L_interleave_layers__linear_kernel_hedgehog__mha_block__prompt_kernel_g_bz_rl
L_interleave_layers__linear_kernel_hedgehog__mha_block__prompt_kernel_g_bz_rok:
s_bitset1_b32 s72, s73
L_interleave_layers__linear_kernel_hedgehog__mha_block__prompt_kernel_g_bz_adv:
s_add_u32 s74, s74, 1
L_interleave_layers__linear_kernel_hedgehog__mha_block__prompt_kernel_g_bz_ok:
L_interleave_layers__linear_kernel_hedgehog__mha_block__prompt_kernel_g_bz_go:
s_mov_b32 s68, 0
s_lshl_b32 s56, s73, 12
s_add_u32 s56, s56, s63
s_mul_i32 s57, s73, 393216
s_add_u32 s57, s57, s59
s_add_u32 m0, s60, s61
s_nop 0
buffer_load_dwordx4 v239, s[36:39], s56 offen offset:0 sc1 lds
buffer_load_dwordx4 v239, s[36:39], s56 offen offset:1024 sc1 lds
s_add_u32 m0, s60, s62
s_add_u32 s56, s56, 2048
buffer_load_dwordx4 v232, s[40:43], s57 offen lds
s_add_u32 m0, s60, s58
s_nop 0
buffer_load_dwordx4 v233, s[40:43], s57 offen lds
s_add_u32 m0, s60, s78
s_nop 0
buffer_load_dwordx4 v235, s[40:43], s57 offen lds
s_add_u32 s57, s57, 196608
s_add_u32 s60, s60, 20480
s_cmp_eq_u32 s60, 151552
s_cselect_b32 s60, 8192, s60
s_cmp_ge_u32 s29, 2
s_cbranch_scc1 L_interleave_layers__linear_kernel_hedgehog__mha_block__prompt_kernel_g_cs2
s_add_u32 s44, s4, 58720256
s_addc_u32 s45, s5, 0
s_mov_b32 s46, 393216
s_mov_b32 s47, 0x20000
s_lshl_b32 s31, s29, 4
s_add_u32 s31, s31, s21
s_lshl_b32 s31, s31, 4
s_mul_i32 s31, s31, 768
s_lshl_b32 s32, s27, 8
s_add_u32 s67, s31, s32
v_lshlrev_b32 v7, 2, v0
buffer_load_dword v32, v7, s[44:47], s67 offen sc1
s_add_u32 s67, s67, 768
buffer_load_dword v33, v7, s[44:47], s67 offen sc1
s_add_u32 s67, s67, 768
buffer_load_dword v34, v7, s[44:47], s67 offen sc1
s_add_u32 s67, s67, 768
buffer_load_dword v35, v7, s[44:47], s67 offen sc1
s_add_u32 s67, s67, 768
buffer_load_dword v36, v7, s[44:47], s67 offen sc1
s_add_u32 s67, s67, 768
buffer_load_dword v37, v7, s[44:47], s67 offen sc1
s_add_u32 s67, s67, 768
buffer_load_dword v38, v7, s[44:47], s67 offen sc1
s_add_u32 s67, s67, 768
buffer_load_dword v39, v7, s[44:47], s67 offen sc1
s_add_u32 s67, s67, 768
buffer_load_dword v40, v7, s[44:47], s67 offen sc1
s_add_u32 s67, s67, 768
buffer_load_dword v41, v7, s[44:47], s67 offen sc1
s_add_u32 s67, s67, 768
buffer_load_dword v42, v7, s[44:47], s67 offen sc1
s_add_u32 s67, s67, 768
buffer_load_dword v43, v7, s[44:47], s67 offen sc1
s_add_u32 s67, s67, 768
buffer_load_dword v44, v7, s[44:47], s67 offen sc1
s_add_u32 s67, s67, 768
buffer_load_dword v45, v7, s[44:47], s67 offen sc1
s_add_u32 s67, s67, 768
buffer_load_dword v46, v7, s[44:47], s67 offen sc1
s_add_u32 s67, s67, 768
buffer_load_dword v47, v7, s[44:47], s67 offen sc1
s_waitcnt vmcnt(31)
s_branch L_interleave_layers__linear_kernel_hedgehog__mha_block__prompt_kernel_g_b13
L_interleave_layers__linear_kernel_hedgehog__mha_block__prompt_kernel_g_cs2:
s_waitcnt vmcnt(15)
L_interleave_layers__linear_kernel_hedgehog__mha_block__prompt_kernel_g_b13:
s_barrier
s_mul_i32 s31, s29, 262144
s_add_u32 s31, s31, 55574528
s_add_u32 s48, s4, s31
s_addc_u32 s49, s5, 0
s_mov_b32 s50, 262144
s_mov_b32 s51, 0x20000
v_and_b32 v4, 31, v0
v_lshlrev_b32 v4, 3, v4
v_lshrrev_b32 v5, 5, v0
v_lshlrev_b32 v5, 17, v5
v_add_u32 v4, v4, v5
s_lshl_b32 s31, s20, 10
s_lshl_b32 s32, s27, 8
s_add_u32 s67, s31, s32
buffer_load_dwordx2 v[8:9], v4, s[48:51], s67 offen sc1
s_add_u32 s67, s67, 16384
buffer_load_dwordx2 v[10:11], v4, s[48:51], s67 offen sc1
s_add_u32 s67, s67, 16384
buffer_load_dwordx2 v[12:13], v4, s[48:51], s67 offen sc1
s_add_u32 s67, s67, 16384
buffer_load_dwordx2 v[14:15], v4, s[48:51], s67 offen sc1
s_add_u32 s67, s67, 16384
buffer_load_dwordx2 v[16:17], v4, s[48:51], s67 offen sc1
s_add_u32 s67, s67, 16384
buffer_load_dwordx2 v[18:19], v4, s[48:51], s67 offen sc1
s_add_u32 s67, s67, 16384
buffer_load_dwordx2 v[20:21], v4, s[48:51], s67 offen sc1
s_add_u32 s67, s67, 16384
buffer_load_dwordx2 v[22:23], v4, s[48:51], s67 offen sc1
s_add_u32 m0, s60, s61
s_nop 0
buffer_load_dwordx4 v239, s[36:39], s56 offen offset:0 sc1 lds
buffer_load_dwordx4 v239, s[36:39], s56 offen offset:1024 sc1 lds
s_add_u32 m0, s60, s62
s_add_u32 s56, s56, 2048
buffer_load_dwordx4 v232, s[40:43], s57 offen lds
s_add_u32 m0, s60, s58
s_nop 0
buffer_load_dwordx4 v233, s[40:43], s57 offen lds
s_add_u32 m0, s60, s78
s_nop 0
buffer_load_dwordx4 v235, s[40:43], s57 offen lds
s_add_u32 s57, s57, 196608
s_add_u32 s60, s60, 20480
s_cmp_eq_u32 s60, 151552
s_cselect_b32 s60, 8192, s60
s_cmp_ge_u32 s29, 2
s_cbranch_scc1 L_interleave_layers__linear_kernel_hedgehog__mha_block__prompt_kernel_g_w14
s_waitcnt vmcnt(34)
s_branch L_interleave_layers__linear_kernel_hedgehog__mha_block__prompt_kernel_g_b14
L_interleave_layers__linear_kernel_hedgehog__mha_block__prompt_kernel_g_w14:
s_waitcnt vmcnt(18)
L_interleave_layers__linear_kernel_hedgehog__mha_block__prompt_kernel_g_b14:
s_barrier
s_waitcnt vmcnt(5)
v_add_f32 v8, v8, v10
v_add_f32 v9, v9, v11
v_add_f32 v8, v8, v12
v_add_f32 v9, v9, v13
v_add_f32 v8, v8, v14
v_add_f32 v9, v9, v15
v_add_f32 v8, v8, v16
v_add_f32 v9, v9, v17
v_add_f32 v8, v8, v18
v_add_f32 v9, v9, v19
v_add_f32 v8, v8, v20
v_add_f32 v9, v9, v21
v_add_f32 v8, v8, v22
v_add_f32 v9, v9, v23
v_mov_b32 v4, v8
s_nop 1
v_permlane32_swap_b32 v4, v8
v_add_f32 v8, v8, v4
v_mov_b32 v5, v9
s_nop 1
v_permlane32_swap_b32 v5, v9
v_add_f32 v9, v9, v5
v_mul_f32 v8, 0x3a800000, v8
v_mul_f32 v9, 0x3a800000, v9
v_fma_f32 v9, -v8, v8, v9
v_max_f32 v9, 0, v9
v_add_f32 v9, 0x3727c5ac, v9
v_rsq_f32 v9, v9
v_sub_f32 v8, 0, v8
v_and_b32 v4, 31, v0
v_lshlrev_b32 v4, 2, v4
s_lshl_b32 s31, s27, 7
v_add_u32 v4, s31, v4
ds_write_b32 v4, v8 offset:0
ds_write_b32 v4, v9 offset:512
s_cmp_ge_u32 s29, 2
s_cbranch_scc1 L_interleave_layers__linear_kernel_hedgehog__mha_block__prompt_kernel_g_nocs
s_cmp_eq_u32 s27, 3
s_cbranch_scc1 L_interleave_layers__linear_kernel_hedgehog__mha_block__prompt_kernel_g_nocs
v_add_f32 v32, v32, v33
v_add_f32 v32, v32, v34
v_add_f32 v32, v32, v35
v_add_f32 v32, v32, v36
v_add_f32 v32, v32, v37
v_add_f32 v32, v32, v38
v_add_f32 v32, v32, v39
v_add_f32 v32, v32, v40
v_add_f32 v32, v32, v41
v_add_f32 v32, v32, v42
v_add_f32 v32, v32, v43
v_add_f32 v32, v32, v44
v_add_f32 v32, v32, v45
v_add_f32 v32, v32, v46
v_add_f32 v32, v32, v47
s_lshl_b32 s31, s27, 8
s_mul_i32 s32, s29, 2048
s_add_u32 s31, s31, s32
v_add_u32 v7, s31, v7
ds_write_b32 v7, v32 offset:1024
L_interleave_layers__linear_kernel_hedgehog__mha_block__prompt_kernel_g_nocs:
s_waitcnt vmcnt(0) lgkmcnt(0)
s_barrier
s_bitcmp1_b32 s29, 0
s_cbranch_scc1 L_interleave_layers__linear_kernel_hedgehog__mha_block__prompt_kernel_lB
s_mul_i32 s31, s27, 6144
s_add_u32 s31, s31, 8192
v_add_u32 v1, s31, v239
s_barrier
ds_read_b128 v[4:7], v1 offset:0
ds_read_b128 v[8:11], v1 offset:1024
ds_read_b128 v[12:15], v1 offset:2048
ds_read_b128 v[16:19], v1 offset:3072
ds_read_b128 v[20:23], v1 offset:4096
ds_read_b128 v[24:27], v1 offset:5120
s_waitcnt lgkmcnt(0)
L_interleave_layers__linear_kernel_hedgehog__mha_block__prompt_kernel_a_mix:
s_mul_i32 s31, s30, 2097152
s_add_u32 s31, s31, 50331648
s_add_u32 s44, s4, s31
s_addc_u32 s45, s5, 0
s_mov_b32 s46, 2097152
s_mov_b32 s47, 0x20000
s_mul_i32 s31, s30, 131072
s_add_u32 s31, s31, 54525952
s_add_u32 s48, s4, s31
s_addc_u32 s49, s5, 0
s_mov_b32 s50, 131072
s_mov_b32 s51, 0x20000
s_mov_b32 s65, 0x3fb8aa3b
v_lshrrev_b32 v28, 5, v0
v_lshlrev_b32 v28, 2, v28
v_bfe_u32 v29, v0, 2, 2
v_add_u32 v28, v28, v29
v_lshlrev_b32 v28, 6, v28
v_bfe_u32 v29, v0, 4, 1
v_lshlrev_b32 v29, 5, v29
v_add_u32 v28, v28, v29
v_and_b32 v29, 3, v0
v_lshlrev_b32 v29, 3, v29
v_add_u32 v28, v28, v29
s_lshl_b32 s31, s23, 11
v_add_u32 v28, s31, v28
ds_read_b64_tr_b16 v[104:105], v28 offset:4096
ds_read_b64_tr_b16 v[106:107], v28 offset:4608
ds_read_b64_tr_b16 v[108:109], v28 offset:5120
ds_read_b64_tr_b16 v[110:111], v28 offset:5632
s_lshl_b32 s31, s23, 13
s_lshl_b32 s32, s24, 11
s_add_u32 s31, s31, s32
v_add_u32 v29, s31, v239
ds_write_b128 v29, v[20:23] offset:32768
ds_write_b128 v29, v[24:27] offset:33792
s_waitcnt lgkmcnt(2)
v_mfma_f32_32x32x16_bf16 v[112:127], v[104:107], v[12:15], 0
v_mfma_f32_32x32x16_bf16 v[112:127], v[108:111], v[16:19], v[112:127]
s_nop 11
v_max3_f32 v92, v112, v113, v114
v_max3_f32 v92, v92, v115, v116
v_max3_f32 v92, v92, v117, v118
v_max3_f32 v92, v92, v119, v120
v_max3_f32 v92, v92, v121, v122
v_max3_f32 v92, v92, v123, v124
v_max3_f32 v92, v92, v125, v126
v_max_f32 v92, v92, v127
v_min3_f32 v93, v112, v113, v114
v_min3_f32 v93, v93, v115, v116
v_min3_f32 v93, v93, v117, v118
v_min3_f32 v93, v93, v119, v120
v_min3_f32 v93, v93, v121, v122
v_min3_f32 v93, v93, v123, v124
v_min3_f32 v93, v93, v125, v126
v_min_f32 v93, v93, v127
v_mov_b32 v28, v92
s_nop 1
v_permlane32_swap_b32 v28, v92
v_max_f32 v92, v92, v28
v_mov_b32 v29, v93
s_nop 1
v_permlane32_swap_b32 v29, v93
v_min_f32 v93, v93, v29
v_mul_f32 v92, s65, v92
v_mul_f32 v93, s65, v93
v_fma_f32 v128, v112, s65, -v92
v_fma_f32 v144, -v112, s65, v93
v_fma_f32 v129, v113, s65, -v92
v_fma_f32 v145, -v113, s65, v93
v_fma_f32 v130, v114, s65, -v92
v_fma_f32 v146, -v114, s65, v93
v_fma_f32 v131, v115, s65, -v92
v_fma_f32 v147, -v115, s65, v93
v_fma_f32 v132, v116, s65, -v92
v_fma_f32 v148, -v116, s65, v93
v_fma_f32 v133, v117, s65, -v92
v_fma_f32 v149, -v117, s65, v93
v_fma_f32 v134, v118, s65, -v92
v_fma_f32 v150, -v118, s65, v93
v_fma_f32 v135, v119, s65, -v92
v_fma_f32 v151, -v119, s65, v93
v_fma_f32 v136, v120, s65, -v92
v_fma_f32 v152, -v120, s65, v93
v_fma_f32 v137, v121, s65, -v92
v_fma_f32 v153, -v121, s65, v93
v_fma_f32 v138, v122, s65, -v92
v_fma_f32 v154, -v122, s65, v93
v_fma_f32 v139, v123, s65, -v92
v_fma_f32 v155, -v123, s65, v93
v_fma_f32 v140, v124, s65, -v92
v_fma_f32 v156, -v124, s65, v93
v_fma_f32 v141, v125, s65, -v92
v_fma_f32 v157, -v125, s65, v93
v_fma_f32 v142, v126, s65, -v92
v_fma_f32 v158, -v126, s65, v93
v_fma_f32 v143, v127, s65, -v92
v_fma_f32 v159, -v127, s65, v93
v_exp_f32 v128, v128
v_exp_f32 v144, v144
v_exp_f32 v129, v129
v_exp_f32 v145, v145
v_exp_f32 v130, v130
v_exp_f32 v146, v146
v_exp_f32 v131, v131
v_exp_f32 v147, v147
v_exp_f32 v132, v132
v_exp_f32 v148, v148
v_exp_f32 v133, v133
v_exp_f32 v149, v149
v_exp_f32 v134, v134
v_exp_f32 v150, v150
v_exp_f32 v135, v135
v_exp_f32 v151, v151
v_exp_f32 v136, v136
v_exp_f32 v152, v152
v_exp_f32 v137, v137
v_exp_f32 v153, v153
v_exp_f32 v138, v138
v_exp_f32 v154, v154
v_exp_f32 v139, v139
v_exp_f32 v155, v155
v_exp_f32 v140, v140
v_exp_f32 v156, v156
v_exp_f32 v141, v141
v_exp_f32 v157, v157
v_exp_f32 v142, v142
v_exp_f32 v158, v158
v_exp_f32 v143, v143
v_exp_f32 v159, v159
v_add_f32 v94, v128, v129
v_add_f32 v95, v144, v145
v_add_f32 v94, v94, v130
v_add_f32 v95, v95, v146
v_add_f32 v94, v94, v131
v_add_f32 v95, v95, v147
v_add_f32 v94, v94, v132
v_add_f32 v95, v95, v148
v_add_f32 v94, v94, v133
v_add_f32 v95, v95, v149
v_add_f32 v94, v94, v134
v_add_f32 v95, v95, v150
v_add_f32 v94, v94, v135
v_add_f32 v95, v95, v151
v_add_f32 v94, v94, v136
v_add_f32 v95, v95, v152
v_add_f32 v94, v94, v137
v_add_f32 v95, v95, v153
v_add_f32 v94, v94, v138
v_add_f32 v95, v95, v154
v_add_f32 v94, v94, v139
v_add_f32 v95, v95, v155
v_add_f32 v94, v94, v140
v_add_f32 v95, v95, v156
v_add_f32 v94, v94, v141
v_add_f32 v95, v95, v157
v_add_f32 v94, v94, v142
v_add_f32 v95, v95, v158
v_add_f32 v94, v94, v143
v_add_f32 v95, v95, v159
v_mov_b32 v28, v94
s_nop 1
v_permlane32_swap_b32 v28, v94
v_add_f32 v94, v94, v28
v_mov_b32 v29, v95
s_nop 1
v_permlane32_swap_b32 v29, v95
v_add_f32 v95, v95, v29
v_rcp_f32 v94, v94
v_rcp_f32 v95, v95
s_nop 0
v_pk_mul_f32 v[128:129], v[128:129], v[94:95] op_sel_hi:[1,0]
v_pk_mul_f32 v[130:131], v[130:131], v[94:95] op_sel_hi:[1,0]
v_pk_mul_f32 v[132:133], v[132:133], v[94:95] op_sel_hi:[1,0]
v_pk_mul_f32 v[134:135], v[134:135], v[94:95] op_sel_hi:[1,0]
v_pk_mul_f32 v[136:137], v[136:137], v[94:95] op_sel_hi:[1,0]
v_pk_mul_f32 v[138:139], v[138:139], v[94:95] op_sel_hi:[1,0]
v_pk_mul_f32 v[140:141], v[140:141], v[94:95] op_sel_hi:[1,0]
v_pk_mul_f32 v[142:143], v[142:143], v[94:95] op_sel_hi:[1,0]
v_pk_mul_f32 v[144:145], v[144:145], v[94:95] op_sel:[0,1] op_sel_hi:[1,1]
v_pk_mul_f32 v[146:147], v[146:147], v[94:95] op_sel:[0,1] op_sel_hi:[1,1]
v_pk_mul_f32 v[148:149], v[148:149], v[94:95] op_sel:[0,1] op_sel_hi:[1,1]
v_pk_mul_f32 v[150:151], v[150:151], v[94:95] op_sel:[0,1] op_sel_hi:[1,1]
v_pk_mul_f32 v[152:153], v[152:153], v[94:95] op_sel:[0,1] op_sel_hi:[1,1]
v_pk_mul_f32 v[154:155], v[154:155], v[94:95] op_sel:[0,1] op_sel_hi:[1,1]
v_pk_mul_f32 v[156:157], v[156:157], v[94:95] op_sel:[0,1] op_sel_hi:[1,1]
v_pk_mul_f32 v[158:159], v[158:159], v[94:95] op_sel:[0,1] op_sel_hi:[1,1]
v_cvt_pk_bf16_f32 v160, v128, v129
v_cvt_pk_bf16_f32 v168, v144, v145
v_cvt_pk_bf16_f32 v161, v130, v131
v_cvt_pk_bf16_f32 v169, v146, v147
v_cvt_pk_bf16_f32 v162, v132, v133
v_cvt_pk_bf16_f32 v170, v148, v149
v_cvt_pk_bf16_f32 v163, v134, v135
v_cvt_pk_bf16_f32 v171, v150, v151
v_cvt_pk_bf16_f32 v164, v136, v137
v_cvt_pk_bf16_f32 v172, v152, v153
v_cvt_pk_bf16_f32 v165, v138, v139
v_cvt_pk_bf16_f32 v173, v154, v155
v_cvt_pk_bf16_f32 v166, v140, v141
v_cvt_pk_bf16_f32 v174, v156, v157
v_cvt_pk_bf16_f32 v167, v142, v143
v_cvt_pk_bf16_f32 v175, v158, v159
s_lshl_b32 s31, s23, 14
s_lshl_b32 s32, s24, 12
s_add_u32 s31, s31, s32
s_add_u32 s31, s31, 90112
v_and_b32 v28, 31, v0
v_lshlrev_b32 v29, 6, v28
v_add_u32 v29, s31, v29
v_bfe_u32 v28, v0, 1, 3
v_lshrrev_b32 v30, 5, v0
v_xor_b32 v28, v28, v30
v_xor_b32 v96, 0, v28
v_lshlrev_b32 v96, 3, v96
v_add_u32 v96, v96, v29
v_xor_b32 v97, 2, v28
v_lshlrev_b32 v97, 3, v97
v_add_u32 v97, v97, v29
v_xor_b32 v98, 4, v28
v_lshlrev_b32 v98, 3, v98
v_add_u32 v98, v98, v29
v_xor_b32 v99, 6, v28
v_lshlrev_b32 v99, 3, v99
v_add_u32 v99, v99, v29
ds_write_b64 v96, v[160:161] offset:0
ds_write_b64 v97, v[162:163] offset:0
ds_write_b64 v98, v[164:165] offset:0
ds_write_b64 v99, v[166:167] offset:0
ds_write_b64 v96, v[168:169] offset:2048
ds_write_b64 v97, v[170:171] offset:2048
ds_write_b64 v98, v[172:173] offset:2048
ds_write_b64 v99, v[174:175] offset:2048
v_lshrrev_b32 v28, 5, v0
v_lshlrev_b32 v28, 2, v28
v_bfe_u32 v29, v0, 2, 2
v_add_u32 v28, v28, v29
v_add_u32 v28, 0, v28
v_bfe_u32 v29, v28, 1, 3
v_bfe_u32 v30, v0, 4, 1
v_lshlrev_b32 v30, 2, v30
v_xor_b32 v29, v29, v30
v_and_b32 v30, 3, v0
v_xor_b32 v29, v29, v30
v_lshlrev_b32 v29, 3, v29
v_lshlrev_b32 v28, 6, v28
v_add_u32 v28, v28, v29
s_lshl_b32 s31, s23, 14
s_lshl_b32 s32, s26, 11
s_add_u32 s31, s31, s32
s_add_u32 s31, s31, 90112
v_add_u32 v100, s31, v28
v_lshrrev_b32 v28, 5, v0
v_lshlrev_b32 v28, 2, v28
v_bfe_u32 v29, v0, 2, 2
v_add_u32 v28, v28, v29
v_add_u32 v28, 8, v28
v_bfe_u32 v29, v28, 1, 3
v_bfe_u32 v30, v0, 4, 1
v_lshlrev_b32 v30, 2, v30
v_xor_b32 v29, v29, v30
v_and_b32 v30, 3, v0
v_xor_b32 v29, v29, v30
v_lshlrev_b32 v29, 3, v29
v_lshlrev_b32 v28, 6, v28
v_add_u32 v28, v28, v29
s_lshl_b32 s31, s23, 14
s_lshl_b32 s32, s26, 11
s_add_u32 s31, s31, s32
s_add_u32 s31, s31, 90112
v_add_u32 v101, s31, v28
s_lshl_b32 s31, s23, 13
v_add_u32 v102, s31, v239
s_waitcnt lgkmcnt(0)
s_barrier
ds_read_b64_tr_b16 v[176:177], v100 offset:0
ds_read_b64_tr_b16 v[178:179], v101 offset:0
ds_read_b64_tr_b16 v[180:181], v100 offset:1024
ds_read_b64_tr_b16 v[182:183], v101 offset:1024
ds_read_b64_tr_b16 v[184:185], v100 offset:4096
ds_read_b64_tr_b16 v[186:187], v101 offset:4096
ds_read_b64_tr_b16 v[188:189], v100 offset:5120
ds_read_b64_tr_b16 v[190:191], v101 offset:5120
s_waitcnt lgkmcnt(4)
ds_read_b64_tr_b16 v[192:193], v100 offset:8192
ds_read_b64_tr_b16 v[194:195], v101 offset:8192
ds_read_b64_tr_b16 v[196:197], v100 offset:9216
ds_read_b64_tr_b16 v[198:199], v101 offset:9216
ds_read_b64_tr_b16 v[200:201], v100 offset:12288
ds_read_b64_tr_b16 v[202:203], v101 offset:12288
ds_read_b64_tr_b16 v[204:205], v100 offset:13312
ds_read_b64_tr_b16 v[206:207], v101 offset:13312
s_cmp_lg_u32 s28, 0
s_cbranch_scc1 L_interleave_layers__linear_kernel_hedgehog__mha_block__prompt_kernel_a_zpart
s_waitcnt lgkmcnt(4)
ds_read_b128 v[112:115], v102 offset:32768
ds_read_b128 v[116:119], v102 offset:33792
ds_read_b128 v[120:123], v102 offset:34816
ds_read_b128 v[124:127], v102 offset:35840
ds_read_b128 v[128:131], v102 offset:36864
ds_read_b128 v[132:135], v102 offset:37888
ds_read_b128 v[136:139], v102 offset:38912
ds_read_b128 v[140:143], v102 offset:39936
s_waitcnt lgkmcnt(0)
v_mfma_f32_32x32x16_bf16 v[48:63], v[176:179], v[112:115], 0
v_mfma_f32_32x32x16_bf16 v[48:63], v[180:183], v[116:119], v[48:63]
v_mfma_f32_32x32x16_bf16 v[48:63], v[184:187], v[120:123], v[48:63]
v_mfma_f32_32x32x16_bf16 v[48:63], v[188:191], v[124:127], v[48:63]
v_mfma_f32_32x32x16_bf16 v[48:63], v[192:195], v[128:131], v[48:63]
v_mfma_f32_32x32x16_bf16 v[48:63], v[196:199], v[132:135], v[48:63]
v_mfma_f32_32x32x16_bf16 v[48:63], v[200:203], v[136:139], v[48:63]
v_mfma_f32_32x32x16_bf16 v[48:63], v[204:207], v[140:143], v[48:63]
s_nop 11
v_cvt_pk_bf16_f32 v112, v48, v49
v_cvt_pk_bf16_f32 v113, v50, v51
v_cvt_pk_bf16_f32 v114, v52, v53
v_cvt_pk_bf16_f32 v115, v54, v55
v_cvt_pk_bf16_f32 v116, v56, v57
v_cvt_pk_bf16_f32 v117, v58, v59
v_cvt_pk_bf16_f32 v118, v60, v61
v_cvt_pk_bf16_f32 v119, v62, v63
s_lshl_b32 s31, s25, 16
s_lshl_b32 s32, s20, 12
s_add_u32 s31, s31, s32
s_lshl_b32 s32, s26, 11
s_add_u32 s31, s31, s32
buffer_store_dwordx4 v[112:115], v239, s[44:47], s31 offen sc1
buffer_store_dwordx4 v[116:119], v239, s[44:47], s31 offen offset:1024 sc1
s_branch L_interleave_layers__linear_kernel_hedgehog__mha_block__prompt_kernel_a_parted
L_interleave_layers__linear_kernel_hedgehog__mha_block__prompt_kernel_a_zpart:
v_mov_b32 v144, 0x3f803f80
v_mov_b32 v145, 0x3f803f80
v_mov_b32 v146, 0x3f803f80
v_mov_b32 v147, 0x3f803f80
s_waitcnt lgkmcnt(0)
s_nop 0
v_mfma_f32_32x32x16_bf16 v[48:63], v[144:147], v[176:179], 0
v_mfma_f32_32x32x16_bf16 v[48:63], v[144:147], v[180:183], v[48:63]
v_mfma_f32_32x32x16_bf16 v[48:63], v[144:147], v[184:187], v[48:63]
v_mfma_f32_32x32x16_bf16 v[48:63], v[144:147], v[188:191], v[48:63]
v_mfma_f32_32x32x16_bf16 v[48:63], v[144:147], v[192:195], v[48:63]
v_mfma_f32_32x32x16_bf16 v[48:63], v[144:147], v[196:199], v[48:63]
v_mfma_f32_32x32x16_bf16 v[48:63], v[144:147], v[200:203], v[48:63]
v_mfma_f32_32x32x16_bf16 v[48:63], v[144:147], v[204:207], v[48:63]
s_lshl_b32 s31, s25, 12
s_lshl_b32 s32, s26, 11
s_add_u32 s31, s31, s32
s_lshl_b32 s32, s20, 7
s_add_u32 s31, s31, s32
v_lshlrev_b32 v28, 2, v0
s_mov_b64 exec, 0xffffffff
s_nop 4
buffer_store_dword v48, v28, s[48:51], s31 offen sc1
s_mov_b64 exec, -1
L_interleave_layers__linear_kernel_hedgehog__mha_block__prompt_kernel_a_parted:
s_waitcnt vmcnt(0)
s_barrier
s_cmp_lg_u32 s22, 0
s_cbranch_scc1 L_interleave_layers__linear_kernel_hedgehog__mha_block__prompt_kernel_a_m_npub
s_mul_i32 s31, s29, 2048
s_lshl_b32 s70, s21, 7
s_add_u32 s70, s70, s31
s_add_u32 s70, s70, 8192
s_lshl_b32 s31, s20, 2
s_add_u32 s32, s70, s31
v_mov_b32 v1, s35
v_mov_b32 v2, 0
s_mov_b64 exec, 1
buffer_store_dword v1, v2, s[52:55], s32 offen sc1
s_mov_b64 exec, -1
L_interleave_layers__linear_kernel_hedgehog__mha_block__prompt_kernel_a_m_npub:
v_mfma_f32_32x32x16_bf16 v[112:127], v[104:107], v[4:7], 0
v_mfma_f32_32x32x16_bf16 v[112:127], v[108:111], v[8:11], v[112:127]
s_nop 11
v_max3_f32 v92, v112, v113, v114
v_max3_f32 v92, v92, v115, v116
v_max3_f32 v92, v92, v117, v118
v_max3_f32 v92, v92, v119, v120
v_max3_f32 v92, v92, v121, v122
v_max3_f32 v92, v92, v123, v124
v_max3_f32 v92, v92, v125, v126
v_max_f32 v92, v92, v127
v_min3_f32 v93, v112, v113, v114
v_min3_f32 v93, v93, v115, v116
v_min3_f32 v93, v93, v117, v118
v_min3_f32 v93, v93, v119, v120
v_min3_f32 v93, v93, v121, v122
v_min3_f32 v93, v93, v123, v124
v_min3_f32 v93, v93, v125, v126
v_min_f32 v93, v93, v127
v_mov_b32 v28, v92
s_nop 1
v_permlane32_swap_b32 v28, v92
v_max_f32 v92, v92, v28
v_mov_b32 v29, v93
s_nop 1
v_permlane32_swap_b32 v29, v93
v_min_f32 v93, v93, v29
v_mul_f32 v92, s65, v92
v_mul_f32 v93, s65, v93
v_fma_f32 v128, v112, s65, -v92
v_fma_f32 v144, -v112, s65, v93
v_fma_f32 v129, v113, s65, -v92
v_fma_f32 v145, -v113, s65, v93
v_fma_f32 v130, v114, s65, -v92
v_fma_f32 v146, -v114, s65, v93
v_fma_f32 v131, v115, s65, -v92
v_fma_f32 v147, -v115, s65, v93
v_fma_f32 v132, v116, s65, -v92
v_fma_f32 v148, -v116, s65, v93
v_fma_f32 v133, v117, s65, -v92
v_fma_f32 v149, -v117, s65, v93
v_fma_f32 v134, v118, s65, -v92
v_fma_f32 v150, -v118, s65, v93
v_fma_f32 v135, v119, s65, -v92
v_fma_f32 v151, -v119, s65, v93
v_fma_f32 v136, v120, s65, -v92
v_fma_f32 v152, -v120, s65, v93
v_fma_f32 v137, v121, s65, -v92
v_fma_f32 v153, -v121, s65, v93
v_fma_f32 v138, v122, s65, -v92
v_fma_f32 v154, -v122, s65, v93
v_fma_f32 v139, v123, s65, -v92
v_fma_f32 v155, -v123, s65, v93
v_fma_f32 v140, v124, s65, -v92
v_fma_f32 v156, -v124, s65, v93
v_fma_f32 v141, v125, s65, -v92
v_fma_f32 v157, -v125, s65, v93
v_fma_f32 v142, v126, s65, -v92
v_fma_f32 v158, -v126, s65, v93
v_fma_f32 v143, v127, s65, -v92
v_fma_f32 v159, -v127, s65, v93
v_exp_f32 v128, v128
v_exp_f32 v144, v144
v_exp_f32 v129, v129
v_exp_f32 v145, v145
v_exp_f32 v130, v130
v_exp_f32 v146, v146
v_exp_f32 v131, v131
v_exp_f32 v147, v147
v_exp_f32 v132, v132
v_exp_f32 v148, v148
v_exp_f32 v133, v133
v_exp_f32 v149, v149
v_exp_f32 v134, v134
v_exp_f32 v150, v150
v_exp_f32 v135, v135
v_exp_f32 v151, v151
v_exp_f32 v136, v136
v_exp_f32 v152, v152
v_exp_f32 v137, v137
v_exp_f32 v153, v153
v_exp_f32 v138, v138
v_exp_f32 v154, v154
v_exp_f32 v139, v139
v_exp_f32 v155, v155
v_exp_f32 v140, v140
v_exp_f32 v156, v156
v_exp_f32 v141, v141
v_exp_f32 v157, v157
v_exp_f32 v142, v142
v_exp_f32 v158, v158
v_exp_f32 v143, v143
v_exp_f32 v159, v159
v_add_f32 v94, v128, v129
v_add_f32 v95, v144, v145
v_add_f32 v94, v94, v130
v_add_f32 v95, v95, v146
v_add_f32 v94, v94, v131
v_add_f32 v95, v95, v147
v_add_f32 v94, v94, v132
v_add_f32 v95, v95, v148
v_add_f32 v94, v94, v133
v_add_f32 v95, v95, v149
v_add_f32 v94, v94, v134
v_add_f32 v95, v95, v150
v_add_f32 v94, v94, v135
v_add_f32 v95, v95, v151
v_add_f32 v94, v94, v136
v_add_f32 v95, v95, v152
v_add_f32 v94, v94, v137
v_add_f32 v95, v95, v153
v_add_f32 v94, v94, v138
v_add_f32 v95, v95, v154
v_add_f32 v94, v94, v139
v_add_f32 v95, v95, v155
v_add_f32 v94, v94, v140
v_add_f32 v95, v95, v156
v_add_f32 v94, v94, v141
v_add_f32 v95, v95, v157
v_add_f32 v94, v94, v142
v_add_f32 v95, v95, v158
v_add_f32 v94, v94, v143
v_add_f32 v95, v95, v159
v_mov_b32 v28, v94
s_nop 1
v_permlane32_swap_b32 v28, v94
v_add_f32 v94, v94, v28
v_mov_b32 v29, v95
s_nop 1
v_permlane32_swap_b32 v29, v95
v_add_f32 v95, v95, v29
v_rcp_f32 v94, v94
v_rcp_f32 v95, v95
s_nop 0
v_pk_mul_f32 v[128:129], v[128:129], v[94:95] op_sel_hi:[1,0]
v_pk_mul_f32 v[130:131], v[130:131], v[94:95] op_sel_hi:[1,0]
v_pk_mul_f32 v[132:133], v[132:133], v[94:95] op_sel_hi:[1,0]
v_pk_mul_f32 v[134:135], v[134:135], v[94:95] op_sel_hi:[1,0]
v_pk_mul_f32 v[136:137], v[136:137], v[94:95] op_sel_hi:[1,0]
v_pk_mul_f32 v[138:139], v[138:139], v[94:95] op_sel_hi:[1,0]
v_pk_mul_f32 v[140:141], v[140:141], v[94:95] op_sel_hi:[1,0]
v_pk_mul_f32 v[142:143], v[142:143], v[94:95] op_sel_hi:[1,0]
v_pk_mul_f32 v[144:145], v[144:145], v[94:95] op_sel:[0,1] op_sel_hi:[1,1]
v_pk_mul_f32 v[146:147], v[146:147], v[94:95] op_sel:[0,1] op_sel_hi:[1,1]
v_pk_mul_f32 v[148:149], v[148:149], v[94:95] op_sel:[0,1] op_sel_hi:[1,1]
v_pk_mul_f32 v[150:151], v[150:151], v[94:95] op_sel:[0,1] op_sel_hi:[1,1]
v_pk_mul_f32 v[152:153], v[152:153], v[94:95] op_sel:[0,1] op_sel_hi:[1,1]
v_pk_mul_f32 v[154:155], v[154:155], v[94:95] op_sel:[0,1] op_sel_hi:[1,1]
v_pk_mul_f32 v[156:157], v[156:157], v[94:95] op_sel:[0,1] op_sel_hi:[1,1]
v_pk_mul_f32 v[158:159], v[158:159], v[94:95] op_sel:[0,1] op_sel_hi:[1,1]
v_cvt_pk_bf16_f32 v32, v128, v129
v_cvt_pk_bf16_f32 v40, v144, v145
v_cvt_pk_bf16_f32 v33, v130, v131
v_cvt_pk_bf16_f32 v41, v146, v147
v_cvt_pk_bf16_f32 v34, v132, v133
v_cvt_pk_bf16_f32 v42, v148, v149
v_cvt_pk_bf16_f32 v35, v134, v135
v_cvt_pk_bf16_f32 v43, v150, v151
v_cvt_pk_bf16_f32 v36, v136, v137
v_cvt_pk_bf16_f32 v44, v152, v153
v_cvt_pk_bf16_f32 v37, v138, v139
v_cvt_pk_bf16_f32 v45, v154, v155
v_cvt_pk_bf16_f32 v38, v140, v141
v_cvt_pk_bf16_f32 v46, v156, v157
v_cvt_pk_bf16_f32 v39, v142, v143
v_cvt_pk_bf16_f32 v47, v158, v159
s_cmp_eq_u32 s28, 0
s_cbranch_scc1 L_interleave_layers__linear_kernel_hedgehog__mha_block__prompt_kernel_a_redC
s_cmp_lg_u32 s27, 0
s_cbranch_scc1 L_interleave_layers__linear_kernel_hedgehog__mha_block__prompt_kernel_a_m_kd
s_mul_i32 s31, s29, 2048
s_lshl_b32 s65, s21, 7
s_add_u32 s65, s65, s31
s_add_u32 s65, s65, 8192
s_lshl_b32 s31, s20, 2
s_add_u32 s66, s65, s31
s_mov_b32 s71, 0
s_mov_b32 s34, 2097152
s_add_u32 s75, s29, 9
s_lshl_b32 s75, s75, 16
v_mov_b32 v3, 2240
L_interleave_layers__linear_kernel_hedgehog__mha_block__prompt_kernel_a_m_kp:
s_mov_b32 exec_lo, 0xffff
s_mov_b32 exec_hi, 0
v_lshlrev_b32 v2, 2, v0
buffer_load_dword v1, v2, s[52:55], s65 offen sc1
s_waitcnt vmcnt(0)
v_cmp_eq_u32 vcc, s35, v1
s_mov_b64 exec, -1
s_or_b32 s71, s71, vcc_lo
s_or_b32 s31, s71, s75
v_mov_b32 v1, s31
ds_write_b32 v3, v1
s_cmp_eq_u32 s71, 0xffff
s_cbranch_scc1 L_interleave_layers__linear_kernel_hedgehog__mha_block__prompt_kernel_a_m_kd
s_sub_u32 s34, s34, 1
s_cmp_lg_u32 s34, 0
s_cbranch_scc1 L_interleave_layers__linear_kernel_hedgehog__mha_block__prompt_kernel_a_m_kp
L_interleave_layers__linear_kernel_hedgehog__mha_block__prompt_kernel_a_m_kd:
s_mov_b32 s40, s12
s_mov_b32 s41, s13
s_mov_b32 s42, 2097152
s_mov_b32 s43, 0x20000
s_lshl_b32 s67, s27, 10
s_add_u32 s67, s67, 8192
s_lshl_b32 s68, s21, 7
s_add_u32 s68, s68, 0
s_add_u32 m0, s67, 0
s_nop 0
buffer_load_dwordx4 v234, s[40:43], s68 offen lds
s_add_u32 s68, s68, 65536
s_add_u32 m0, s67, 4096
s_nop 0
buffer_load_dwordx4 v234, s[40:43], s68 offen lds
s_add_u32 s68, s68, 65536
s_add_u32 m0, s67, 8192
s_nop 0
buffer_load_dwordx4 v234, s[40:43], s68 offen lds
s_add_u32 s68, s68, 65536
s_add_u32 m0, s67, 12288
s_nop 0
buffer_load_dwordx4 v234, s[40:43], s68 offen lds
s_add_u32 s68, s68, 65536
s_add_u32 m0, s67, 16384
s_nop 0
buffer_load_dwordx4 v234, s[40:43], s68 offen lds
s_add_u32 s68, s68, 65536
s_add_u32 m0, s67, 20480
s_nop 0
buffer_load_dwordx4 v234, s[40:43], s68 offen lds
s_add_u32 s68, s68, 65536
s_add_u32 m0, s67, 24576
s_nop 0
buffer_load_dwordx4 v234, s[40:43], s68 offen lds
s_add_u32 s68, s68, 65536
s_add_u32 m0, s67, 28672
s_nop 0
buffer_load_dwordx4 v234, s[40:43], s68 offen lds
s_lshl_b32 s67, s27, 10
s_add_u32 s67, s67, 40960
s_lshl_b32 s68, s21, 7
s_add_u32 s68, s68, 524288
s_add_u32 m0, s67, 0
s_nop 0
buffer_load_dwordx4 v234, s[40:43], s68 offen lds
s_add_u32 s68, s68, 65536
s_add_u32 m0, s67, 4096
s_nop 0
buffer_load_dwordx4 v234, s[40:43], s68 offen lds
s_add_u32 s68, s68, 65536
s_add_u32 m0, s67, 8192
s_nop 0
buffer_load_dwordx4 v234, s[40:43], s68 offen lds
s_add_u32 s68, s68, 65536
s_add_u32 m0, s67, 12288
s_nop 0
buffer_load_dwordx4 v234, s[40:43], s68 offen lds
s_add_u32 s68, s68, 65536
s_add_u32 m0, s67, 16384
s_nop 0
buffer_load_dwordx4 v234, s[40:43], s68 offen lds
s_add_u32 s68, s68, 65536
s_add_u32 m0, s67, 20480
s_nop 0
buffer_load_dwordx4 v234, s[40:43], s68 offen lds
s_add_u32 s68, s68, 65536
s_add_u32 m0, s67, 24576
s_nop 0
buffer_load_dwordx4 v234, s[40:43], s68 offen lds
s_add_u32 s68, s68, 65536
s_add_u32 m0, s67, 28672
s_nop 0
buffer_load_dwordx4 v234, s[40:43], s68 offen lds
s_lshl_b32 s67, s27, 10
s_add_u32 s67, s67, 73728
s_lshl_b32 s68, s21, 7
s_add_u32 s68, s68, 1048576
s_add_u32 m0, s67, 0
s_nop 0
buffer_load_dwordx4 v234, s[40:43], s68 offen lds
s_add_u32 s68, s68, 65536
s_add_u32 m0, s67, 4096
s_nop 0
buffer_load_dwordx4 v234, s[40:43], s68 offen lds
s_add_u32 s68, s68, 65536
s_add_u32 m0, s67, 8192
s_nop 0
buffer_load_dwordx4 v234, s[40:43], s68 offen lds
s_add_u32 s68, s68, 65536
s_add_u32 m0, s67, 12288
s_nop 0
buffer_load_dwordx4 v234, s[40:43], s68 offen lds
s_add_u32 s68, s68, 65536
s_add_u32 m0, s67, 16384
s_nop 0
buffer_load_dwordx4 v234, s[40:43], s68 offen lds
s_add_u32 s68, s68, 65536
s_add_u32 m0, s67, 20480
s_nop 0
buffer_load_dwordx4 v234, s[40:43], s68 offen lds
s_add_u32 s68, s68, 65536
s_add_u32 m0, s67, 24576
s_nop 0
buffer_load_dwordx4 v234, s[40:43], s68 offen lds
s_add_u32 s68, s68, 65536
s_add_u32 m0, s67, 28672
s_nop 0
buffer_load_dwordx4 v234, s[40:43], s68 offen lds
s_lshl_b32 s67, s27, 10
s_add_u32 s67, s67, 106496
s_lshl_b32 s68, s21, 7
s_add_u32 s68, s68, 1572864
s_add_u32 m0, s67, 0
s_nop 0
buffer_load_dwordx4 v234, s[40:43], s68 offen lds
s_add_u32 s68, s68, 65536
s_add_u32 m0, s67, 4096
s_nop 0
buffer_load_dwordx4 v234, s[40:43], s68 offen lds
s_add_u32 s68, s68, 65536
s_add_u32 m0, s67, 8192
s_nop 0
buffer_load_dwordx4 v234, s[40:43], s68 offen lds
s_add_u32 s68, s68, 65536
s_add_u32 m0, s67, 12288
s_nop 0
buffer_load_dwordx4 v234, s[40:43], s68 offen lds
s_add_u32 s68, s68, 65536
s_add_u32 m0, s67, 16384
s_nop 0
buffer_load_dwordx4 v234, s[40:43], s68 offen lds
s_add_u32 s68, s68, 65536
s_add_u32 m0, s67, 20480
s_nop 0
buffer_load_dwordx4 v234, s[40:43], s68 offen lds
s_add_u32 s68, s68, 65536
s_add_u32 m0, s67, 24576
s_nop 0
buffer_load_dwordx4 v234, s[40:43], s68 offen lds
s_add_u32 s68, s68, 65536
s_add_u32 m0, s67, 28672
s_nop 0
buffer_load_dwordx4 v234, s[40:43], s68 offen lds
s_branch L_interleave_layers__linear_kernel_hedgehog__mha_block__prompt_kernel_a_zdone
L_interleave_layers__linear_kernel_hedgehog__mha_block__prompt_kernel_a_redC:
s_lshl_b32 s31, s25, 16
s_lshl_b32 s32, s26, 11
s_add_u32 s67, s31, s32
s_lshl_b32 s31, s25, 12
s_add_u32 s68, s31, s32
v_and_b32 v30, 31, v0
v_lshlrev_b32 v30, 2, v30
s_mov_b32 s72, 0
s_bitset1_b32 s72, s20
s_mov_b32 s71, s72
s_mov_b32 s66, 0
s_add_u32 s75, s29, 9
s_mov_b32 s73, s20
s_lshl_b32 s31, s73, 12
s_add_u32 s31, s31, s67
s_lshl_b32 s32, s73, 7
s_add_u32 s32, s32, s68
buffer_load_dwordx4 v[104:107], v239, s[44:47], s31 offen offset:0 sc1
buffer_load_dwordx4 v[108:111], v239, s[44:47], s31 offen offset:1024 sc1
buffer_load_dword v84, v30, s[48:51], s32 offen sc1
v_and_b32 v28, 31, v0
v_lshrrev_b32 v29, 5, v0
v_lshlrev_b32 v29, 2, v29
v_sub_u32 v28, v28, v29
v_mov_b32 v80, 0
v_mov_b32 v29, 0x3f80
v_cmp_eq_u32 vcc, 0, v28
s_nop 1
v_cndmask_b32 v80, v80, v29, vcc
v_mov_b32 v29, 0x3f800000
v_cmp_eq_u32 vcc, 1, v28
s_nop 1
v_cndmask_b32 v80, v80, v29, vcc
v_mov_b32 v81, 0
v_mov_b32 v29, 0x3f80
v_cmp_eq_u32 vcc, 2, v28
s_nop 1
v_cndmask_b32 v81, v81, v29, vcc
v_mov_b32 v29, 0x3f800000
v_cmp_eq_u32 vcc, 3, v28
s_nop 1
v_cndmask_b32 v81, v81, v29, vcc
v_mov_b32 v82, 0
v_mov_b32 v29, 0x3f80
v_cmp_eq_u32 vcc, 8, v28
s_nop 1
v_cndmask_b32 v82, v82, v29, vcc
v_mov_b32 v29, 0x3f800000
v_cmp_eq_u32 vcc, 9, v28
s_nop 1
v_cndmask_b32 v82, v82, v29, vcc
v_mov_b32 v83, 0
v_mov_b32 v29, 0x3f80
v_cmp_eq_u32 vcc, 10, v28
s_nop 1
v_cndmask_b32 v83, v83, v29, vcc
v_mov_b32 v29, 0x3f800000
v_cmp_eq_u32 vcc, 11, v28
s_nop 1
v_cndmask_b32 v83, v83, v29, vcc
s_andn2_b32 s32, s71, s72
s_cbranch_scc0 L_interleave_layers__linear_kernel_hedgehog__mha_block__prompt_kernel_a_r1_sl
L_interleave_layers__linear_kernel_hedgehog__mha_block__prompt_kernel_a_r1_hv:
s_ff1_i32_b32 s73, s32
s_bitset1_b32 s72, s73
s_lshl_b32 s31, s73, 12
s_add_u32 s31, s31, s67
s_lshl_b32 s32, s73, 7
s_add_u32 s32, s32, s68
buffer_load_dwordx4 v[112:115], v239, s[44:47], s31 offen offset:0 sc1
buffer_load_dwordx4 v[116:119], v239, s[44:47], s31 offen offset:1024 sc1
buffer_load_dword v85, v30, s[48:51], s32 offen sc1
s_waitcnt vmcnt(5)
v_mfma_f32_32x32x16_bf16 v[48:63], v[80:83], v[104:107], 0
s_waitcnt vmcnt(4)
v_mfma_f32_32x32x16_bf16 v[64:79], v[80:83], v[108:111], 0
s_waitcnt vmcnt(3)
v_mov_b32 v103, v84
s_andn2_b32 s32, s71, s72
s_cbranch_scc0 L_interleave_layers__linear_kernel_hedgehog__mha_block__prompt_kernel_a_r2_sl
L_interleave_layers__linear_kernel_hedgehog__mha_block__prompt_kernel_a_r2_hv:
s_ff1_i32_b32 s73, s32
s_bitset1_b32 s72, s73
s_lshl_b32 s31, s73, 12
s_add_u32 s31, s31, s67
s_lshl_b32 s32, s73, 7
s_add_u32 s32, s32, s68
buffer_load_dwordx4 v[120:123], v239, s[44:47], s31 offen offset:0 sc1
buffer_load_dwordx4 v[124:127], v239, s[44:47], s31 offen offset:1024 sc1
buffer_load_dword v86, v30, s[48:51], s32 offen sc1
s_andn2_b32 s32, s71, s72
s_cbranch_scc0 L_interleave_layers__linear_kernel_hedgehog__mha_block__prompt_kernel_a_r3_sl
L_interleave_layers__linear_kernel_hedgehog__mha_block__prompt_kernel_a_r3_hv:
s_ff1_i32_b32 s73, s32
s_bitset1_b32 s72, s73
s_lshl_b32 s31, s73, 12
s_add_u32 s31, s31, s67
s_lshl_b32 s32, s73, 7
s_add_u32 s32, s32, s68
buffer_load_dwordx4 v[128:131], v239, s[44:47], s31 offen offset:0 sc1
buffer_load_dwordx4 v[132:135], v239, s[44:47], s31 offen offset:1024 sc1
buffer_load_dword v87, v30, s[48:51], s32 offen sc1
s_waitcnt vmcnt(8)
v_mfma_f32_32x32x16_bf16 v[48:63], v[80:83], v[112:115], v[48:63]
s_waitcnt vmcnt(7)
v_mfma_f32_32x32x16_bf16 v[64:79], v[80:83], v[116:119], v[64:79]
s_waitcnt vmcnt(6)
v_add_f32 v103, v103, v85
s_andn2_b32 s32, s71, s72
s_cbranch_scc0 L_interleave_layers__linear_kernel_hedgehog__mha_block__prompt_kernel_a_r4_sl
L_interleave_layers__linear_kernel_hedgehog__mha_block__prompt_kernel_a_r4_hv:
s_ff1_i32_b32 s73, s32
s_bitset1_b32 s72, s73
s_lshl_b32 s31, s73, 12
s_add_u32 s31, s31, s67
s_lshl_b32 s32, s73, 7
s_add_u32 s32, s32, s68
buffer_load_dwordx4 v[136:139], v239, s[44:47], s31 offen offset:0 sc1
buffer_load_dwordx4 v[140:143], v239, s[44:47], s31 offen offset:1024 sc1
buffer_load_dword v88, v30, s[48:51], s32 offen sc1
s_andn2_b32 s32, s71, s72
s_cbranch_scc0 L_interleave_layers__linear_kernel_hedgehog__mha_block__prompt_kernel_a_r5_sl
L_interleave_layers__linear_kernel_hedgehog__mha_block__prompt_kernel_a_r5_hv:
s_ff1_i32_b32 s73, s32
s_bitset1_b32 s72, s73
s_lshl_b32 s31, s73, 12
s_add_u32 s31, s31, s67
s_lshl_b32 s32, s73, 7
s_add_u32 s32, s32, s68
buffer_load_dwordx4 v[144:147], v239, s[44:47], s31 offen offset:0 sc1
buffer_load_dwordx4 v[148:151], v239, s[44:47], s31 offen offset:1024 sc1
buffer_load_dword v89, v30, s[48:51], s32 offen sc1
s_waitcnt vmcnt(11)
v_mfma_f32_32x32x16_bf16 v[48:63], v[80:83], v[120:123], v[48:63]
s_waitcnt vmcnt(10)
v_mfma_f32_32x32x16_bf16 v[64:79], v[80:83], v[124:127], v[64:79]
s_waitcnt vmcnt(9)
v_add_f32 v103, v103, v86
s_andn2_b32 s32, s71, s72
s_cbranch_scc0 L_interleave_layers__linear_kernel_hedgehog__mha_block__prompt_kernel_a_r6_sl
L_interleave_layers__linear_kernel_hedgehog__mha_block__prompt_kernel_a_r6_hv:
s_ff1_i32_b32 s73, s32
s_bitset1_b32 s72, s73
s_lshl_b32 s31, s73, 12
s_add_u32 s31, s31, s67
s_lshl_b32 s32, s73, 7
s_add_u32 s32, s32, s68
buffer_load_dwordx4 v[152:155], v239, s[44:47], s31 offen offset:0 sc1
buffer_load_dwordx4 v[156:159], v239, s[44:47], s31 offen offset:1024 sc1
buffer_load_dword v90, v30, s[48:51], s32 offen sc1
s_andn2_b32 s32, s71, s72
s_cbranch_scc0 L_interleave_layers__linear_kernel_hedgehog__mha_block__prompt_kernel_a_r7_sl
L_interleave_layers__linear_kernel_hedgehog__mha_block__prompt_kernel_a_r7_hv:
s_ff1_i32_b32 s73, s32
s_bitset1_b32 s72, s73
s_lshl_b32 s31, s73, 12
s_add_u32 s31, s31, s67
s_lshl_b32 s32, s73, 7
s_add_u32 s32, s32, s68
buffer_load_dwordx4 v[160:163], v239, s[44:47], s31 offen offset:0 sc1
buffer_load_dwordx4 v[164:167], v239, s[44:47], s31 offen offset:1024 sc1
buffer_load_dword v91, v30, s[48:51], s32 offen sc1
s_waitcnt vmcnt(14)
v_mfma_f32_32x32x16_bf16 v[48:63], v[80:83], v[128:131], v[48:63]
s_waitcnt vmcnt(13)
v_mfma_f32_32x32x16_bf16 v[64:79], v[80:83], v[132:135], v[64:79]
s_waitcnt vmcnt(12)
v_add_f32 v103, v103, v87
s_andn2_b32 s32, s71, s72
s_cbranch_scc0 L_interleave_layers__linear_kernel_hedgehog__mha_block__prompt_kernel_a_r8_sl
L_interleave_layers__linear_kernel_hedgehog__mha_block__prompt_kernel_a_r8_hv:
s_ff1_i32_b32 s73, s32
s_bitset1_b32 s72, s73
s_lshl_b32 s31, s73, 12
s_add_u32 s31, s31, s67
s_lshl_b32 s32, s73, 7
s_add_u32 s32, s32, s68
buffer_load_dwordx4 v[168:171], v239, s[44:47], s31 offen offset:0 sc1
buffer_load_dwordx4 v[172:175], v239, s[44:47], s31 offen offset:1024 sc1
buffer_load_dword v92, v30, s[48:51], s32 offen sc1
s_andn2_b32 s32, s71, s72
s_cbranch_scc0 L_interleave_layers__linear_kernel_hedgehog__mha_block__prompt_kernel_a_r9_sl
L_interleave_layers__linear_kernel_hedgehog__mha_block__prompt_kernel_a_r9_hv:
s_ff1_i32_b32 s73, s32
s_bitset1_b32 s72, s73
s_lshl_b32 s31, s73, 12
s_add_u32 s31, s31, s67
s_lshl_b32 s32, s73, 7
s_add_u32 s32, s32, s68
buffer_load_dwordx4 v[176:179], v239, s[44:47], s31 offen offset:0 sc1
buffer_load_dwordx4 v[180:183], v239, s[44:47], s31 offen offset:1024 sc1
buffer_load_dword v93, v30, s[48:51], s32 offen sc1
s_waitcnt vmcnt(17)
v_mfma_f32_32x32x16_bf16 v[48:63], v[80:83], v[136:139], v[48:63]
s_waitcnt vmcnt(16)
v_mfma_f32_32x32x16_bf16 v[64:79], v[80:83], v[140:143], v[64:79]
s_waitcnt vmcnt(15)
v_add_f32 v103, v103, v88
s_andn2_b32 s32, s71, s72
s_cbranch_scc0 L_interleave_layers__linear_kernel_hedgehog__mha_block__prompt_kernel_a_r10_sl
L_interleave_layers__linear_kernel_hedgehog__mha_block__prompt_kernel_a_r10_hv:
s_ff1_i32_b32 s73, s32
s_bitset1_b32 s72, s73
s_lshl_b32 s31, s73, 12
s_add_u32 s31, s31, s67
s_lshl_b32 s32, s73, 7
s_add_u32 s32, s32, s68
buffer_load_dwordx4 v[184:187], v239, s[44:47], s31 offen offset:0 sc1
buffer_load_dwordx4 v[188:191], v239, s[44:47], s31 offen offset:1024 sc1
buffer_load_dword v94, v30, s[48:51], s32 offen sc1
s_waitcnt vmcnt(17)
v_mfma_f32_32x32x16_bf16 v[48:63], v[80:83], v[144:147], v[48:63]
s_waitcnt vmcnt(16)
v_mfma_f32_32x32x16_bf16 v[64:79], v[80:83], v[148:151], v[64:79]
s_waitcnt vmcnt(15)
v_add_f32 v103, v103, v89
s_andn2_b32 s32, s71, s72
s_cbranch_scc0 L_interleave_layers__linear_kernel_hedgehog__mha_block__prompt_kernel_a_r11_sl
L_interleave_layers__linear_kernel_hedgehog__mha_block__prompt_kernel_a_r11_hv:
s_ff1_i32_b32 s73, s32
s_bitset1_b32 s72, s73
s_lshl_b32 s31, s73, 12
s_add_u32 s31, s31, s67
s_lshl_b32 s32, s73, 7
s_add_u32 s32, s32, s68
buffer_load_dwordx4 v[192:195], v239, s[44:47], s31 offen offset:0 sc1
buffer_load_dwordx4 v[196:199], v239, s[44:47], s31 offen offset:1024 sc1
buffer_load_dword v95, v30, s[48:51], s32 offen sc1
s_waitcnt vmcnt(17)
v_mfma_f32_32x32x16_bf16 v[48:63], v[80:83], v[152:155], v[48:63]
s_waitcnt vmcnt(16)
v_mfma_f32_32x32x16_bf16 v[64:79], v[80:83], v[156:159], v[64:79]
s_waitcnt vmcnt(15)
v_add_f32 v103, v103, v90
s_andn2_b32 s32, s71, s72
s_cbranch_scc0 L_interleave_layers__linear_kernel_hedgehog__mha_block__prompt_kernel_a_r12_sl
L_interleave_layers__linear_kernel_hedgehog__mha_block__prompt_kernel_a_r12_hv:
s_ff1_i32_b32 s73, s32
s_bitset1_b32 s72, s73
s_lshl_b32 s31, s73, 12
s_add_u32 s31, s31, s67
s_lshl_b32 s32, s73, 7
s_add_u32 s32, s32, s68
buffer_load_dwordx4 v[200:203], v239, s[44:47], s31 offen offset:0 sc1
buffer_load_dwordx4 v[204:207], v239, s[44:47], s31 offen offset:1024 sc1
buffer_load_dword v96, v30, s[48:51], s32 offen sc1
s_waitcnt vmcnt(17)
v_mfma_f32_32x32x16_bf16 v[48:63], v[80:83], v[160:163], v[48:63]
s_waitcnt vmcnt(16)
v_mfma_f32_32x32x16_bf16 v[64:79], v[80:83], v[164:167], v[64:79]
s_waitcnt vmcnt(15)
v_add_f32 v103, v103, v91
s_andn2_b32 s32, s71, s72
s_cbranch_scc0 L_interleave_layers__linear_kernel_hedgehog__mha_block__prompt_kernel_a_r13_sl
L_interleave_layers__linear_kernel_hedgehog__mha_block__prompt_kernel_a_r13_hv:
s_ff1_i32_b32 s73, s32
s_bitset1_b32 s72, s73
s_lshl_b32 s31, s73, 12
s_add_u32 s31, s31, s67
s_lshl_b32 s32, s73, 7
s_add_u32 s32, s32, s68
buffer_load_dwordx4 v[208:211], v239, s[44:47], s31 offen offset:0 sc1
buffer_load_dwordx4 v[212:215], v239, s[44:47], s31 offen offset:1024 sc1
buffer_load_dword v97, v30, s[48:51], s32 offen sc1
s_waitcnt vmcnt(17)
v_mfma_f32_32x32x16_bf16 v[48:63], v[80:83], v[168:171], v[48:63]
s_waitcnt vmcnt(16)
v_mfma_f32_32x32x16_bf16 v[64:79], v[80:83], v[172:175], v[64:79]
s_waitcnt vmcnt(15)
v_add_f32 v103, v103, v92
s_andn2_b32 s32, s71, s72
s_cbranch_scc0 L_interleave_layers__linear_kernel_hedgehog__mha_block__prompt_kernel_a_r14_sl
L_interleave_layers__linear_kernel_hedgehog__mha_block__prompt_kernel_a_r14_hv:
s_ff1_i32_b32 s73, s32
s_bitset1_b32 s72, s73
s_lshl_b32 s31, s73, 12
s_add_u32 s31, s31, s67
s_lshl_b32 s32, s73, 7
s_add_u32 s32, s32, s68
buffer_load_dwordx4 v[216:219], v239, s[44:47], s31 offen offset:0 sc1
buffer_load_dwordx4 v[220:223], v239, s[44:47], s31 offen offset:1024 sc1
buffer_load_dword v98, v30, s[48:51], s32 offen sc1
s_waitcnt vmcnt(17)
v_mfma_f32_32x32x16_bf16 v[48:63], v[80:83], v[176:179], v[48:63]
s_waitcnt vmcnt(16)
v_mfma_f32_32x32x16_bf16 v[64:79], v[80:83], v[180:183], v[64:79]
s_waitcnt vmcnt(15)
v_add_f32 v103, v103, v93
s_andn2_b32 s32, s71, s72
s_cbranch_scc0 L_interleave_layers__linear_kernel_hedgehog__mha_block__prompt_kernel_a_r15_sl
L_interleave_layers__linear_kernel_hedgehog__mha_block__prompt_kernel_a_r15_hv:
s_ff1_i32_b32 s73, s32
s_bitset1_b32 s72, s73
s_lshl_b32 s31, s73, 12
s_add_u32 s31, s31, s67
s_lshl_b32 s32, s73, 7
s_add_u32 s32, s32, s68
buffer_load_dwordx4 v[224:227], v239, s[44:47], s31 offen offset:0 sc1
buffer_load_dwordx4 v[228:231], v239, s[44:47], s31 offen offset:1024 sc1
buffer_load_dword v99, v30, s[48:51], s32 offen sc1
s_waitcnt vmcnt(17)
v_mfma_f32_32x32x16_bf16 v[48:63], v[80:83], v[184:187], v[48:63]
s_waitcnt vmcnt(16)
v_mfma_f32_32x32x16_bf16 v[64:79], v[80:83], v[188:191], v[64:79]
s_waitcnt vmcnt(15)
v_add_f32 v103, v103, v94
s_waitcnt vmcnt(14)
v_mfma_f32_32x32x16_bf16 v[48:63], v[80:83], v[192:195], v[48:63]
s_waitcnt vmcnt(13)
v_mfma_f32_32x32x16_bf16 v[64:79], v[80:83], v[196:199], v[64:79]
s_waitcnt vmcnt(12)
v_add_f32 v103, v103, v95
s_waitcnt vmcnt(11)
v_mfma_f32_32x32x16_bf16 v[48:63], v[80:83], v[200:203], v[48:63]
s_waitcnt vmcnt(10)
v_mfma_f32_32x32x16_bf16 v[64:79], v[80:83], v[204:207], v[64:79]
s_waitcnt vmcnt(9)
v_add_f32 v103, v103, v96
s_waitcnt vmcnt(8)
v_mfma_f32_32x32x16_bf16 v[48:63], v[80:83], v[208:211], v[48:63]
s_waitcnt vmcnt(7)
v_mfma_f32_32x32x16_bf16 v[64:79], v[80:83], v[212:215], v[64:79]
s_waitcnt vmcnt(6)
v_add_f32 v103, v103, v97
s_waitcnt vmcnt(5)
v_mfma_f32_32x32x16_bf16 v[48:63], v[80:83], v[216:219], v[48:63]
s_waitcnt vmcnt(4)
v_mfma_f32_32x32x16_bf16 v[64:79], v[80:83], v[220:223], v[64:79]
s_waitcnt vmcnt(3)
v_add_f32 v103, v103, v98
s_waitcnt vmcnt(2)
v_mfma_f32_32x32x16_bf16 v[48:63], v[80:83], v[224:227], v[48:63]
s_waitcnt vmcnt(1)
v_mfma_f32_32x32x16_bf16 v[64:79], v[80:83], v[228:231], v[64:79]
s_waitcnt vmcnt(0)
v_add_f32 v103, v103, v99
s_nop 7
v_cvt_pk_bf16_f32 v104, v48, v49
v_cvt_pk_bf16_f32 v105, v50, v51
v_cvt_pk_bf16_f32 v106, v52, v53
v_cvt_pk_bf16_f32 v107, v54, v55
v_cvt_pk_bf16_f32 v108, v64, v65
v_cvt_pk_bf16_f32 v109, v66, v67
v_cvt_pk_bf16_f32 v110, v68, v69
v_cvt_pk_bf16_f32 v111, v70, v71
s_lshl_b32 s31, s23, 12
s_lshl_b32 s32, s26, 11
s_add_u32 s31, s31, s32
s_add_u32 s31, s31, 139264
v_add_u32 v29, s31, v239
ds_write_b128 v29, v[104:107]
ds_write_b128 v29, v[108:111] offset:1024
v_cvt_pk_bf16_f32 v28, v103, v103
v_lshlrev_b32 v30, 16, v28
v_sub_f32 v30, v103, v30
v_cvt_pk_bf16_f32 v112, v103, v30
v_mov_b32 v113, 0
v_mov_b32 v114, 0
v_mov_b32 v115, 0
v_mov_b32 v28, 0
v_cmp_gt_u32 vcc, 32, v0
s_nop 1
v_cndmask_b32 v112, v28, v112, vcc
v_mov_b32 v116, 0x3f803f80
v_mov_b32 v117, 0
v_mov_b32 v118, 0
v_mov_b32 v119, 0
s_nop 1
v_mfma_f32_32x32x16_bf16 v[48:63], v[112:115], v[116:119], 0
s_nop 11
v_cvt_pk_bf16_f32 v120, v48, v49
v_cvt_pk_bf16_f32 v121, v50, v51
v_cvt_pk_bf16_f32 v122, v52, v53
v_cvt_pk_bf16_f32 v123, v54, v55
v_cvt_pk_bf16_f32 v124, v56, v57
v_cvt_pk_bf16_f32 v125, v58, v59
v_cvt_pk_bf16_f32 v126, v60, v61
v_cvt_pk_bf16_f32 v127, v62, v63
ds_write_b128 v29, v[120:123] offset:8192
ds_write_b128 v29, v[124:127] offset:9216
L_interleave_layers__linear_kernel_hedgehog__mha_block__prompt_kernel_a_zdone:
s_waitcnt lgkmcnt(0)
s_barrier
s_lshl_b32 s31, s23, 12
s_add_u32 s31, s31, 139264
v_add_u32 v29, s31, v239
ds_read_b128 v[104:107], v29 offset:0
ds_read_b128 v[108:111], v29 offset:1024
ds_read_b128 v[112:115], v29 offset:2048
ds_read_b128 v[116:119], v29 offset:3072
ds_read_b128 v[120:123], v29 offset:8192
ds_read_b128 v[124:127], v29 offset:9216
ds_read_b128 v[128:131], v29 offset:10240
ds_read_b128 v[132:135], v29 offset:11264
s_waitcnt lgkmcnt(4)
v_mfma_f32_32x32x16_bf16 v[136:151], v[104:107], v[32:35], 0
v_mfma_f32_32x32x16_bf16 v[136:151], v[108:111], v[36:39], v[136:151]
v_mfma_f32_32x32x16_bf16 v[136:151], v[112:115], v[40:43], v[136:151]
v_mfma_f32_32x32x16_bf16 v[136:151], v[116:119], v[44:47], v[136:151]
s_waitcnt lgkmcnt(0)
v_mfma_f32_32x32x16_bf16 v[152:167], v[120:123], v[32:35], 0
v_mfma_f32_32x32x16_bf16 v[152:167], v[124:127], v[36:39], v[152:167]
v_mfma_f32_32x32x16_bf16 v[152:167], v[128:131], v[40:43], v[152:167]
v_mfma_f32_32x32x16_bf16 v[152:167], v[132:135], v[44:47], v[152:167]
s_nop 11
v_add_f32 v28, 0x358637bd, v152
v_rcp_f32 v28, v28
s_nop 0
v_pk_mul_f32 v[136:137], v[136:137], v[28:29] op_sel_hi:[1,0]
v_pk_mul_f32 v[138:139], v[138:139], v[28:29] op_sel_hi:[1,0]
v_pk_mul_f32 v[140:141], v[140:141], v[28:29] op_sel_hi:[1,0]
v_pk_mul_f32 v[142:143], v[142:143], v[28:29] op_sel_hi:[1,0]
v_pk_mul_f32 v[144:145], v[144:145], v[28:29] op_sel_hi:[1,0]
v_pk_mul_f32 v[146:147], v[146:147], v[28:29] op_sel_hi:[1,0]
v_pk_mul_f32 v[148:149], v[148:149], v[28:29] op_sel_hi:[1,0]
v_pk_mul_f32 v[150:151], v[150:151], v[28:29] op_sel_hi:[1,0]
v_cvt_pk_bf16_f32 v104, v136, v137
v_cvt_pk_bf16_f32 v105, v138, v139
v_cvt_pk_bf16_f32 v106, v140, v141
v_cvt_pk_bf16_f32 v107, v142, v143
v_cvt_pk_bf16_f32 v108, v144, v145
v_cvt_pk_bf16_f32 v109, v146, v147
v_cvt_pk_bf16_f32 v110, v148, v149
v_cvt_pk_bf16_f32 v111, v150, v151
s_mul_i32 s31, s29, 4194304
s_add_u32 s31, s31, 16777216
s_add_u32 s36, s4, s31
s_addc_u32 s37, s5, 0
s_mov_b32 s38, 4194304
s_mov_b32 s39, 0x20000
s_lshl_b32 s31, s20, 2
s_add_u32 s31, s31, s24
s_lshl_b32 s31, s31, 16
s_lshl_b32 s32, s25, 11
s_add_u32 s31, s31, s32
buffer_store_dwordx4 v[104:107], v239, s[36:39], s31 offen sc1
buffer_store_dwordx4 v[108:111], v239, s[36:39], s31 offen offset:1024 sc1
s_waitcnt vmcnt(0)
s_barrier
s_branch L_interleave_layers__linear_kernel_hedgehog__mha_block__prompt_kernel_p
L_interleave_layers__linear_kernel_hedgehog__mha_block__prompt_kernel_lB:
s_mul_i32 s31, s30, 8388608
s_add_u32 s31, s31, 33554432
s_add_u32 s36, s4, s31
s_addc_u32 s37, s5, 0
s_mov_b32 s38, 8388608
s_mov_b32 s39, 0x20000
s_lshr_b32 s31, s27, 1
s_and_b32 s32, s27, 1
s_lshl_b32 s32, s32, 13
s_lshl_b32 s58, s21, 1
s_add_u32 s58, s58, s31
s_lshl_b32 s58, s58, 18
s_add_u32 s58, s58, s32
s_lshl_b32 s31, s31, 14
s_add_u32 s59, s31, s32
s_add_u32 s59, s59, 8192
s_barrier
s_mul_i32 s31, s29, 2048
s_lshl_b32 s65, s21, 7
s_add_u32 s65, s65, s31
s_add_u32 s65, s65, 8192
s_lshl_b32 s31, s20, 2
s_add_u32 s67, s65, s31
s_cmp_lg_u32 s27, 0
s_cbranch_scc1 L_interleave_layers__linear_kernel_hedgehog__mha_block__prompt_kernel_b_notlast
s_add_u32 s68, s30, 1
s_lshl_b32 s68, s68, 2
v_mov_b32 v2, 2112
s_mov_b32 s34, 2097152
L_interleave_layers__linear_kernel_hedgehog__mha_block__prompt_kernel_b_cnt:
ds_read_b32 v1, v2
s_waitcnt lgkmcnt(0)
v_readfirstlane_b32 s31, v1
s_nop 0
s_cmp_ge_u32 s31, s68
s_cbranch_scc1 L_interleave_layers__linear_kernel_hedgehog__mha_block__prompt_kernel_b_cntok
s_sub_u32 s34, s34, 1
s_cmp_lg_u32 s34, 0
s_cbranch_scc1 L_interleave_layers__linear_kernel_hedgehog__mha_block__prompt_kernel_b_cnt
L_interleave_layers__linear_kernel_hedgehog__mha_block__prompt_kernel_b_cntok:
v_mov_b32 v1, s35
v_mov_b32 v2, 0
s_mov_b64 exec, 1
buffer_store_dword v1, v2, s[52:55], s67 offen sc1
s_mov_b64 exec, -1
L_interleave_layers__linear_kernel_hedgehog__mha_block__prompt_kernel_b_notlast:
s_mov_b32 s72, 0
s_bitset1_b32 s72, s20
s_mov_b32 s71, s72
s_add_u32 s66, s20, 1
s_lshl_b32 s75, s29, 1
s_add_u32 s75, s75, 2
s_mov_b32 s74, 0
s_mov_b32 s57, 1
L_interleave_layers__linear_kernel_hedgehog__mha_block__prompt_kernel_b_lgo:
s_lshl_b32 s31, s74, 2
v_mov_b32 v3, s31
s_add_u32 s74, s74, 1
s_mov_b32 s34, 2097152
s_cmp_lg_u32 s27, 0
s_cbranch_scc1 L_interleave_layers__linear_kernel_hedgehog__mha_block__prompt_kernel_b_k1_rd
L_interleave_layers__linear_kernel_hedgehog__mha_block__prompt_kernel_b_k1_ch:
s_andn2_b32 s32, s71, s72
s_cbranch_scc1 L_interleave_layers__linear_kernel_hedgehog__mha_block__prompt_kernel_b_k1_hv
s_mov_b32 exec_lo, 0xffff
s_mov_b32 exec_hi, 0
v_lshlrev_b32 v2, 2, v0
buffer_load_dword v1, v2, s[52:55], s65 offen sc1
s_waitcnt vmcnt(0)
v_cmp_eq_u32 vcc, s35, v1
s_mov_b64 exec, -1
s_or_b32 s71, s71, vcc_lo
s_andn2_b32 s32, s71, s72
s_cbranch_scc1 L_interleave_layers__linear_kernel_hedgehog__mha_block__prompt_kernel_b_k1_hv
s_sub_u32 s34, s34, 1
s_cmp_lg_u32 s34, 0
s_cbranch_scc1 L_interleave_layers__linear_kernel_hedgehog__mha_block__prompt_kernel_b_k1_ch
s_orn2_b32 s32, 0, s72
s_and_b32 s32, s32, 0xffff
L_interleave_layers__linear_kernel_hedgehog__mha_block__prompt_kernel_b_k1_hv:
s_lshl_b32 s33, s32, 16
s_or_b32 s33, s33, s32
s_lshr_b32 s33, s33, s66
s_ff1_i32_b32 s33, s33
s_add_u32 s33, s33, s66
s_and_b32 s73, s33, 15
s_bitset1_b32 s72, s73
s_lshl_b32 s31, s75, 8
s_or_b32 s31, s31, s73
v_mov_b32 v1, s31
ds_write_b32 v3, v1 offset:2176
s_branch L_interleave_layers__linear_kernel_hedgehog__mha_block__prompt_kernel_b_k1_ok
L_interleave_layers__linear_kernel_hedgehog__mha_block__prompt_kernel_b_k1_rd:
ds_read_b32 v1, v3 offset:2176
s_waitcnt lgkmcnt(0)
v_readfirstlane_b32 s31, v1
s_nop 0
s_and_b32 s73, s31, 15
s_lshr_b32 s31, s31, 8
s_cmp_eq_u32 s31, s75
s_cbranch_scc1 L_interleave_layers__linear_kernel_hedgehog__mha_block__prompt_kernel_b_k1_ok
s_sub_u32 s34, s34, 1
s_cmp_lg_u32 s34, 0
s_cbranch_scc1 L_interleave_layers__linear_kernel_hedgehog__mha_block__prompt_kernel_b_k1_rd
L_interleave_layers__linear_kernel_hedgehog__mha_block__prompt_kernel_b_k1_ok:
s_lshl_b32 s31, s73, 14
s_add_u32 s56, s58, s31
s_lshl_b32 s31, s57, 15
s_add_u32 m0, s59, s31
s_add_u32 s57, s57, 1
s_and_b32 s57, s57, 3
buffer_load_dwordx4 v239, s[36:39], s56 offen offset:0 sc1 lds
buffer_load_dwordx4 v239, s[36:39], s56 offen offset:1024 sc1 lds
buffer_load_dwordx4 v239, s[36:39], s56 offen offset:2048 sc1 lds
buffer_load_dwordx4 v239, s[36:39], s56 offen offset:3072 sc1 lds
s_add_u32 m0, m0, 4096
s_add_u32 s56, s56, 4096
buffer_load_dwordx4 v239, s[36:39], s56 offen offset:0 sc1 lds
buffer_load_dwordx4 v239, s[36:39], s56 offen offset:1024 sc1 lds
buffer_load_dwordx4 v239, s[36:39], s56 offen offset:2048 sc1 lds
buffer_load_dwordx4 v239, s[36:39], s56 offen offset:3072 sc1 lds
s_waitcnt vmcnt(0)
s_barrier
s_lshl_b32 s31, s74, 2
v_mov_b32 v3, s31
s_add_u32 s74, s74, 1
s_mov_b32 s34, 2097152
s_cmp_lg_u32 s27, 0
s_cbranch_scc1 L_interleave_layers__linear_kernel_hedgehog__mha_block__prompt_kernel_b_k2_rd
L_interleave_layers__linear_kernel_hedgehog__mha_block__prompt_kernel_b_k2_ch:
s_andn2_b32 s32, s71, s72
s_cbranch_scc1 L_interleave_layers__linear_kernel_hedgehog__mha_block__prompt_kernel_b_k2_hv
s_mov_b32 exec_lo, 0xffff
s_mov_b32 exec_hi, 0
v_lshlrev_b32 v2, 2, v0
buffer_load_dword v1, v2, s[52:55], s65 offen sc1
s_waitcnt vmcnt(0)
v_cmp_eq_u32 vcc, s35, v1
s_mov_b64 exec, -1
s_or_b32 s71, s71, vcc_lo
s_andn2_b32 s32, s71, s72
s_cbranch_scc1 L_interleave_layers__linear_kernel_hedgehog__mha_block__prompt_kernel_b_k2_hv
s_sub_u32 s34, s34, 1
s_cmp_lg_u32 s34, 0
s_cbranch_scc1 L_interleave_layers__linear_kernel_hedgehog__mha_block__prompt_kernel_b_k2_ch
s_orn2_b32 s32, 0, s72
s_and_b32 s32, s32, 0xffff
L_interleave_layers__linear_kernel_hedgehog__mha_block__prompt_kernel_b_k2_hv:
s_lshl_b32 s33, s32, 16
s_or_b32 s33, s33, s32
s_lshr_b32 s33, s33, s66
s_ff1_i32_b32 s33, s33
s_add_u32 s33, s33, s66
s_and_b32 s73, s33, 15
s_bitset1_b32 s72, s73
s_lshl_b32 s31, s75, 8
s_or_b32 s31, s31, s73
v_mov_b32 v1, s31
ds_write_b32 v3, v1 offset:2176
s_branch L_interleave_layers__linear_kernel_hedgehog__mha_block__prompt_kernel_b_k2_ok
L_interleave_layers__linear_kernel_hedgehog__mha_block__prompt_kernel_b_k2_rd:
ds_read_b32 v1, v3 offset:2176
s_waitcnt lgkmcnt(0)
v_readfirstlane_b32 s31, v1
s_nop 0
s_and_b32 s73, s31, 15
s_lshr_b32 s31, s31, 8
s_cmp_eq_u32 s31, s75
s_cbranch_scc1 L_interleave_layers__linear_kernel_hedgehog__mha_block__prompt_kernel_b_k2_ok
s_sub_u32 s34, s34, 1
s_cmp_lg_u32 s34, 0
s_cbranch_scc1 L_interleave_layers__linear_kernel_hedgehog__mha_block__prompt_kernel_b_k2_rd
L_interleave_layers__linear_kernel_hedgehog__mha_block__prompt_kernel_b_k2_ok:
s_lshl_b32 s31, s73, 14
s_add_u32 s56, s58, s31
s_lshl_b32 s31, s57, 15
s_add_u32 m0, s59, s31
s_add_u32 s57, s57, 1
s_and_b32 s57, s57, 3
buffer_load_dwordx4 v239, s[36:39], s56 offen offset:0 sc1 lds
buffer_load_dwordx4 v239, s[36:39], s56 offen offset:1024 sc1 lds
buffer_load_dwordx4 v239, s[36:39], s56 offen offset:2048 sc1 lds
buffer_load_dwordx4 v239, s[36:39], s56 offen offset:3072 sc1 lds
s_add_u32 m0, m0, 4096
s_add_u32 s56, s56, 4096
buffer_load_dwordx4 v239, s[36:39], s56 offen offset:0 sc1 lds
buffer_load_dwordx4 v239, s[36:39], s56 offen offset:1024 sc1 lds
buffer_load_dwordx4 v239, s[36:39], s56 offen offset:2048 sc1 lds
buffer_load_dwordx4 v239, s[36:39], s56 offen offset:3072 sc1 lds
s_lshl_b32 s31, s74, 2
v_mov_b32 v3, s31
s_add_u32 s74, s74, 1
s_mov_b32 s34, 2097152
s_cmp_lg_u32 s27, 0
s_cbranch_scc1 L_interleave_layers__linear_kernel_hedgehog__mha_block__prompt_kernel_b_k3_rd
L_interleave_layers__linear_kernel_hedgehog__mha_block__prompt_kernel_b_k3_ch:
s_andn2_b32 s32, s71, s72
s_cbranch_scc1 L_interleave_layers__linear_kernel_hedgehog__mha_block__prompt_kernel_b_k3_hv
s_mov_b32 exec_lo, 0xffff
s_mov_b32 exec_hi, 0
v_lshlrev_b32 v2, 2, v0
buffer_load_dword v1, v2, s[52:55], s65 offen sc1
s_waitcnt vmcnt(0)
v_cmp_eq_u32 vcc, s35, v1
s_mov_b64 exec, -1
s_or_b32 s71, s71, vcc_lo
s_andn2_b32 s32, s71, s72
s_cbranch_scc1 L_interleave_layers__linear_kernel_hedgehog__mha_block__prompt_kernel_b_k3_hv
s_sub_u32 s34, s34, 1
s_cmp_lg_u32 s34, 0
s_cbranch_scc1 L_interleave_layers__linear_kernel_hedgehog__mha_block__prompt_kernel_b_k3_ch
s_orn2_b32 s32, 0, s72
s_and_b32 s32, s32, 0xffff
L_interleave_layers__linear_kernel_hedgehog__mha_block__prompt_kernel_b_k3_hv:
s_lshl_b32 s33, s32, 16
s_or_b32 s33, s33, s32
s_lshr_b32 s33, s33, s66
s_ff1_i32_b32 s33, s33
s_add_u32 s33, s33, s66
s_and_b32 s73, s33, 15
s_bitset1_b32 s72, s73
s_lshl_b32 s31, s75, 8
s_or_b32 s31, s31, s73
v_mov_b32 v1, s31
ds_write_b32 v3, v1 offset:2176
s_branch L_interleave_layers__linear_kernel_hedgehog__mha_block__prompt_kernel_b_k3_ok
L_interleave_layers__linear_kernel_hedgehog__mha_block__prompt_kernel_b_k3_rd:
ds_read_b32 v1, v3 offset:2176
s_waitcnt lgkmcnt(0)
v_readfirstlane_b32 s31, v1
s_nop 0
s_and_b32 s73, s31, 15
s_lshr_b32 s31, s31, 8
s_cmp_eq_u32 s31, s75
s_cbranch_scc1 L_interleave_layers__linear_kernel_hedgehog__mha_block__prompt_kernel_b_k3_ok
s_sub_u32 s34, s34, 1
s_cmp_lg_u32 s34, 0
s_cbranch_scc1 L_interleave_layers__linear_kernel_hedgehog__mha_block__prompt_kernel_b_k3_rd
L_interleave_layers__linear_kernel_hedgehog__mha_block__prompt_kernel_b_k3_ok:
s_lshl_b32 s31, s73, 14
s_add_u32 s56, s58, s31
s_lshl_b32 s31, s57, 15
s_add_u32 m0, s59, s31
s_add_u32 s57, s57, 1
s_and_b32 s57, s57, 3
buffer_load_dwordx4 v239, s[36:39], s56 offen offset:0 sc1 lds
buffer_load_dwordx4 v239, s[36:39], s56 offen offset:1024 sc1 lds
buffer_load_dwordx4 v239, s[36:39], s56 offen offset:2048 sc1 lds
buffer_load_dwordx4 v239, s[36:39], s56 offen offset:3072 sc1 lds
s_add_u32 m0, m0, 4096
s_add_u32 s56, s56, 4096
buffer_load_dwordx4 v239, s[36:39], s56 offen offset:0 sc1 lds
buffer_load_dwordx4 v239, s[36:39], s56 offen offset:1024 sc1 lds
buffer_load_dwordx4 v239, s[36:39], s56 offen offset:2048 sc1 lds
buffer_load_dwordx4 v239, s[36:39], s56 offen offset:3072 sc1 lds
s_waitcnt vmcnt(8)
s_barrier
s_lshl_b32 s31, s74, 2
v_mov_b32 v3, s31
s_add_u32 s74, s74, 1
s_mov_b32 s34, 2097152
s_cmp_lg_u32 s27, 0
s_cbranch_scc1 L_interleave_layers__linear_kernel_hedgehog__mha_block__prompt_kernel_b_k4_rd
L_interleave_layers__linear_kernel_hedgehog__mha_block__prompt_kernel_b_k4_ch:
s_andn2_b32 s32, s71, s72
s_cbranch_scc1 L_interleave_layers__linear_kernel_hedgehog__mha_block__prompt_kernel_b_k4_hv
s_mov_b32 exec_lo, 0xffff
s_mov_b32 exec_hi, 0
v_lshlrev_b32 v2, 2, v0
buffer_load_dword v1, v2, s[52:55], s65 offen sc1
s_waitcnt vmcnt(0)
v_cmp_eq_u32 vcc, s35, v1
s_mov_b64 exec, -1
s_or_b32 s71, s71, vcc_lo
s_andn2_b32 s32, s71, s72
s_cbranch_scc1 L_interleave_layers__linear_kernel_hedgehog__mha_block__prompt_kernel_b_k4_hv
s_sub_u32 s34, s34, 1
s_cmp_lg_u32 s34, 0
s_cbranch_scc1 L_interleave_layers__linear_kernel_hedgehog__mha_block__prompt_kernel_b_k4_ch
s_orn2_b32 s32, 0, s72
s_and_b32 s32, s32, 0xffff
L_interleave_layers__linear_kernel_hedgehog__mha_block__prompt_kernel_b_k4_hv:
s_lshl_b32 s33, s32, 16
s_or_b32 s33, s33, s32
s_lshr_b32 s33, s33, s66
s_ff1_i32_b32 s33, s33
s_add_u32 s33, s33, s66
s_and_b32 s73, s33, 15
s_bitset1_b32 s72, s73
s_lshl_b32 s31, s75, 8
s_or_b32 s31, s31, s73
v_mov_b32 v1, s31
ds_write_b32 v3, v1 offset:2176
s_branch L_interleave_layers__linear_kernel_hedgehog__mha_block__prompt_kernel_b_k4_ok
L_interleave_layers__linear_kernel_hedgehog__mha_block__prompt_kernel_b_k4_rd:
ds_read_b32 v1, v3 offset:2176
s_waitcnt lgkmcnt(0)
v_readfirstlane_b32 s31, v1
s_nop 0
s_and_b32 s73, s31, 15
s_lshr_b32 s31, s31, 8
s_cmp_eq_u32 s31, s75
s_cbranch_scc1 L_interleave_layers__linear_kernel_hedgehog__mha_block__prompt_kernel_b_k4_ok
s_sub_u32 s34, s34, 1
s_cmp_lg_u32 s34, 0
s_cbranch_scc1 L_interleave_layers__linear_kernel_hedgehog__mha_block__prompt_kernel_b_k4_rd
L_interleave_layers__linear_kernel_hedgehog__mha_block__prompt_kernel_b_k4_ok:
s_lshl_b32 s31, s73, 14
s_add_u32 s56, s58, s31
s_lshl_b32 s31, s57, 15
s_add_u32 m0, s59, s31
s_add_u32 s57, s57, 1
s_and_b32 s57, s57, 3
buffer_load_dwordx4 v239, s[36:39], s56 offen offset:0 sc1 lds
buffer_load_dwordx4 v239, s[36:39], s56 offen offset:1024 sc1 lds
buffer_load_dwordx4 v239, s[36:39], s56 offen offset:2048 sc1 lds
buffer_load_dwordx4 v239, s[36:39], s56 offen offset:3072 sc1 lds
s_add_u32 m0, m0, 4096
s_add_u32 s56, s56, 4096
buffer_load_dwordx4 v239, s[36:39], s56 offen offset:0 sc1 lds
buffer_load_dwordx4 v239, s[36:39], s56 offen offset:1024 sc1 lds
buffer_load_dwordx4 v239, s[36:39], s56 offen offset:2048 sc1 lds
buffer_load_dwordx4 v239, s[36:39], s56 offen offset:3072 sc1 lds
s_mov_b32 s64, 11
L_interleave_layers__linear_kernel_hedgehog__mha_block__prompt_kernel_b_ll:
s_waitcnt vmcnt(8)
s_barrier
s_lshl_b32 s31, s74, 2
v_mov_b32 v3, s31
s_add_u32 s74, s74, 1
s_mov_b32 s34, 2097152
s_cmp_lg_u32 s27, 0
s_cbranch_scc1 L_interleave_layers__linear_kernel_hedgehog__mha_block__prompt_kernel_b_kl_rd
L_interleave_layers__linear_kernel_hedgehog__mha_block__prompt_kernel_b_kl_ch:
s_andn2_b32 s32, s71, s72
s_cbranch_scc1 L_interleave_layers__linear_kernel_hedgehog__mha_block__prompt_kernel_b_kl_hv
s_mov_b32 exec_lo, 0xffff
s_mov_b32 exec_hi, 0
v_lshlrev_b32 v2, 2, v0
buffer_load_dword v1, v2, s[52:55], s65 offen sc1
s_waitcnt vmcnt(0)
v_cmp_eq_u32 vcc, s35, v1
s_mov_b64 exec, -1
s_or_b32 s71, s71, vcc_lo
s_andn2_b32 s32, s71, s72
s_cbranch_scc1 L_interleave_layers__linear_kernel_hedgehog__mha_block__prompt_kernel_b_kl_hv
s_sub_u32 s34, s34, 1
s_cmp_lg_u32 s34, 0
s_cbranch_scc1 L_interleave_layers__linear_kernel_hedgehog__mha_block__prompt_kernel_b_kl_ch
s_orn2_b32 s32, 0, s72
s_and_b32 s32, s32, 0xffff
L_interleave_layers__linear_kernel_hedgehog__mha_block__prompt_kernel_b_kl_hv:
s_lshl_b32 s33, s32, 16
s_or_b32 s33, s33, s32
s_lshr_b32 s33, s33, s66
s_ff1_i32_b32 s33, s33
s_add_u32 s33, s33, s66
s_and_b32 s73, s33, 15
s_bitset1_b32 s72, s73
s_lshl_b32 s31, s75, 8
s_or_b32 s31, s31, s73
v_mov_b32 v1, s31
ds_write_b32 v3, v1 offset:2176
s_branch L_interleave_layers__linear_kernel_hedgehog__mha_block__prompt_kernel_b_kl_ok
L_interleave_layers__linear_kernel_hedgehog__mha_block__prompt_kernel_b_kl_rd:
ds_read_b32 v1, v3 offset:2176
s_waitcnt lgkmcnt(0)
v_readfirstlane_b32 s31, v1
s_nop 0
s_and_b32 s73, s31, 15
s_lshr_b32 s31, s31, 8
s_cmp_eq_u32 s31, s75
s_cbranch_scc1 L_interleave_layers__linear_kernel_hedgehog__mha_block__prompt_kernel_b_kl_ok
s_sub_u32 s34, s34, 1
s_cmp_lg_u32 s34, 0
s_cbranch_scc1 L_interleave_layers__linear_kernel_hedgehog__mha_block__prompt_kernel_b_kl_rd
L_interleave_layers__linear_kernel_hedgehog__mha_block__prompt_kernel_b_kl_ok:
s_lshl_b32 s31, s73, 14
s_add_u32 s56, s58, s31
s_lshl_b32 s31, s57, 15
s_add_u32 m0, s59, s31
s_add_u32 s57, s57, 1
s_and_b32 s57, s57, 3
buffer_load_dwordx4 v239, s[36:39], s56 offen offset:0 sc1 lds
buffer_load_dwordx4 v239, s[36:39], s56 offen offset:1024 sc1 lds
buffer_load_dwordx4 v239, s[36:39], s56 offen offset:2048 sc1 lds
buffer_load_dwordx4 v239, s[36:39], s56 offen offset:3072 sc1 lds
s_add_u32 m0, m0, 4096
s_add_u32 s56, s56, 4096
buffer_load_dwordx4 v239, s[36:39], s56 offen offset:0 sc1 lds
buffer_load_dwordx4 v239, s[36:39], s56 offen offset:1024 sc1 lds
buffer_load_dwordx4 v239, s[36:39], s56 offen offset:2048 sc1 lds
buffer_load_dwordx4 v239, s[36:39], s56 offen offset:3072 sc1 lds
s_sub_u32 s64, s64, 1
s_cmp_lg_u32 s64, 0
s_cbranch_scc1 L_interleave_layers__linear_kernel_hedgehog__mha_block__prompt_kernel_b_ll
s_mov_b32 s40, s14
s_mov_b32 s41, s15
s_mov_b32 s42, 2097152
s_mov_b32 s43, 0x20000
s_waitcnt vmcnt(8)
s_barrier
s_lshl_b32 s67, s27, 10
s_add_u32 s67, s67, 8192
s_lshl_b32 s68, s21, 7
s_add_u32 s68, s68, 0
s_add_u32 m0, s67, 0
s_nop 0
buffer_load_dwordx4 v234, s[40:43], s68 offen lds
s_add_u32 s68, s68, 65536
s_add_u32 m0, s67, 4096
s_nop 0
buffer_load_dwordx4 v234, s[40:43], s68 offen lds
s_add_u32 s68, s68, 65536
s_add_u32 m0, s67, 8192
s_nop 0
buffer_load_dwordx4 v234, s[40:43], s68 offen lds
s_add_u32 s68, s68, 65536
s_add_u32 m0, s67, 12288
s_nop 0
buffer_load_dwordx4 v234, s[40:43], s68 offen lds
s_add_u32 s68, s68, 65536
s_add_u32 m0, s67, 16384
s_nop 0
buffer_load_dwordx4 v234, s[40:43], s68 offen lds
s_add_u32 s68, s68, 65536
s_add_u32 m0, s67, 20480
s_nop 0
buffer_load_dwordx4 v234, s[40:43], s68 offen lds
s_add_u32 s68, s68, 65536
s_add_u32 m0, s67, 24576
s_nop 0
buffer_load_dwordx4 v234, s[40:43], s68 offen lds
s_add_u32 s68, s68, 65536
s_add_u32 m0, s67, 28672
s_nop 0
buffer_load_dwordx4 v234, s[40:43], s68 offen lds
s_waitcnt vmcnt(8)
s_barrier
s_lshl_b32 s67, s27, 10
s_add_u32 s67, s67, 40960
s_lshl_b32 s68, s21, 7
s_add_u32 s68, s68, 524288
s_add_u32 m0, s67, 0
s_nop 0
buffer_load_dwordx4 v234, s[40:43], s68 offen lds
s_add_u32 s68, s68, 65536
s_add_u32 m0, s67, 4096
s_nop 0
buffer_load_dwordx4 v234, s[40:43], s68 offen lds
s_add_u32 s68, s68, 65536
s_add_u32 m0, s67, 8192
s_nop 0
buffer_load_dwordx4 v234, s[40:43], s68 offen lds
s_add_u32 s68, s68, 65536
s_add_u32 m0, s67, 12288
s_nop 0
buffer_load_dwordx4 v234, s[40:43], s68 offen lds
s_add_u32 s68, s68, 65536
s_add_u32 m0, s67, 16384
s_nop 0
buffer_load_dwordx4 v234, s[40:43], s68 offen lds
s_add_u32 s68, s68, 65536
s_add_u32 m0, s67, 20480
s_nop 0
buffer_load_dwordx4 v234, s[40:43], s68 offen lds
s_add_u32 s68, s68, 65536
s_add_u32 m0, s67, 24576
s_nop 0
buffer_load_dwordx4 v234, s[40:43], s68 offen lds
s_add_u32 s68, s68, 65536
s_add_u32 m0, s67, 28672
s_nop 0
buffer_load_dwordx4 v234, s[40:43], s68 offen lds
s_barrier
s_lshl_b32 s67, s27, 10
s_add_u32 s67, s67, 73728
s_lshl_b32 s68, s21, 7
s_add_u32 s68, s68, 1048576
s_add_u32 m0, s67, 0
s_nop 0
buffer_load_dwordx4 v234, s[40:43], s68 offen lds
s_add_u32 s68, s68, 65536
s_add_u32 m0, s67, 4096
s_nop 0
buffer_load_dwordx4 v234, s[40:43], s68 offen lds
s_add_u32 s68, s68, 65536
s_add_u32 m0, s67, 8192
s_nop 0
buffer_load_dwordx4 v234, s[40:43], s68 offen lds
s_add_u32 s68, s68, 65536
s_add_u32 m0, s67, 12288
s_nop 0
buffer_load_dwordx4 v234, s[40:43], s68 offen lds
s_add_u32 s68, s68, 65536
s_add_u32 m0, s67, 16384
s_nop 0
buffer_load_dwordx4 v234, s[40:43], s68 offen lds
s_add_u32 s68, s68, 65536
s_add_u32 m0, s67, 20480
s_nop 0
buffer_load_dwordx4 v234, s[40:43], s68 offen lds
s_add_u32 s68, s68, 65536
s_add_u32 m0, s67, 24576
s_nop 0
buffer_load_dwordx4 v234, s[40:43], s68 offen lds
s_add_u32 s68, s68, 65536
s_add_u32 m0, s67, 28672
s_nop 0
buffer_load_dwordx4 v234, s[40:43], s68 offen lds
s_barrier
s_lshl_b32 s67, s27, 10
s_add_u32 s67, s67, 106496
s_lshl_b32 s68, s21, 7
s_add_u32 s68, s68, 1572864
s_add_u32 m0, s67, 0
s_nop 0
buffer_load_dwordx4 v234, s[40:43], s68 offen lds
s_add_u32 s68, s68, 65536
s_add_u32 m0, s67, 4096
s_nop 0
buffer_load_dwordx4 v234, s[40:43], s68 offen lds
s_add_u32 s68, s68, 65536
s_add_u32 m0, s67, 8192
s_nop 0
buffer_load_dwordx4 v234, s[40:43], s68 offen lds
s_add_u32 s68, s68, 65536
s_add_u32 m0, s67, 12288
s_nop 0
buffer_load_dwordx4 v234, s[40:43], s68 offen lds
s_add_u32 s68, s68, 65536
s_add_u32 m0, s67, 16384
s_nop 0
buffer_load_dwordx4 v234, s[40:43], s68 offen lds
s_add_u32 s68, s68, 65536
s_add_u32 m0, s67, 20480
s_nop 0
buffer_load_dwordx4 v234, s[40:43], s68 offen lds
s_add_u32 s68, s68, 65536
s_add_u32 m0, s67, 24576
s_nop 0
buffer_load_dwordx4 v234, s[40:43], s68 offen lds
s_add_u32 s68, s68, 65536
s_add_u32 m0, s67, 28672
s_nop 0
buffer_load_dwordx4 v234, s[40:43], s68 offen lds
s_barrier
v_and_b32 v1, 3, v0
v_lshlrev_b32 v1, 2, v1
ds_read_b32 v2, v1 offset:2048
s_waitcnt lgkmcnt(0)
v_cmp_ne_u32 vcc, 0, v2
s_nop 0
s_cmp_eq_u64 vcc, 0
s_cbranch_scc1 L_interleave_layers__linear_kernel_hedgehog__mha_block__prompt_kernel_b_lfin
s_waitcnt vmcnt(0)
s_barrier
s_mov_b32 s57, 0
s_lshl_b32 s31, s20, 14
s_add_u32 s56, s58, s31
s_lshl_b32 s31, s57, 15
s_add_u32 m0, s59, s31
s_add_u32 s57, s57, 1
s_and_b32 s57, s57, 3
buffer_load_dwordx4 v239, s[36:39], s56 offen offset:0 sc1 lds
buffer_load_dwordx4 v239, s[36:39], s56 offen offset:1024 sc1 lds
buffer_load_dwordx4 v239, s[36:39], s56 offen offset:2048 sc1 lds
buffer_load_dwordx4 v239, s[36:39], s56 offen offset:3072 sc1 lds
s_add_u32 m0, m0, 4096
s_add_u32 s56, s56, 4096
buffer_load_dwordx4 v239, s[36:39], s56 offen offset:0 sc1 lds
buffer_load_dwordx4 v239, s[36:39], s56 offen offset:1024 sc1 lds
buffer_load_dwordx4 v239, s[36:39], s56 offen offset:2048 sc1 lds
buffer_load_dwordx4 v239, s[36:39], s56 offen offset:3072 sc1 lds
s_mov_b32 s72, 0
s_bitset1_b32 s72, s20
s_add_u32 s75, s75, 16
s_mov_b32 s74, 0
s_waitcnt vmcnt(0)
s_barrier
s_branch L_interleave_layers__linear_kernel_hedgehog__mha_block__prompt_kernel_b_lgo
L_interleave_layers__linear_kernel_hedgehog__mha_block__prompt_kernel_b_lfin:
L_interleave_layers__linear_kernel_hedgehog__mha_block__prompt_kernel_p:
s_cmp_lg_u32 s22, 0
s_cbranch_scc1 L_interleave_layers__linear_kernel_hedgehog__mha_block__prompt_kernel_p_o_npub
s_mul_i32 s31, s29, 2048
s_lshl_b32 s70, s20, 7
s_add_u32 s70, s70, s31
s_add_u32 s70, s70, 16384
s_lshl_b32 s31, s21, 2
s_add_u32 s32, s70, s31
v_mov_b32 v1, s35
v_mov_b32 v2, 0
s_mov_b64 exec, 1
buffer_store_dword v1, v2, s[52:55], s32 offen sc1
s_mov_b64 exec, -1
L_interleave_layers__linear_kernel_hedgehog__mha_block__prompt_kernel_p_o_npub:
s_cmp_lg_u32 s28, 0
s_cbranch_scc1 L_interleave_layers__linear_kernel_hedgehog__mha_block__prompt_kernel_pL
s_mul_i32 s31, s29, 4194304
s_add_u32 s31, s31, 16777216
s_add_u32 s36, s4, s31
s_addc_u32 s37, s5, 0
s_mov_b32 s38, 4194304
s_mov_b32 s39, 0x20000
s_lshl_b32 s31, s20, 2
s_add_u32 s31, s31, s27
s_lshl_b32 s65, s31, 16
s_mov_b32 s72, 0
s_bitset1_b32 s72, s21
s_mov_b32 s71, s72
s_mov_b32 s66, 0
s_add_u32 s75, s29, 1
s_mov_b32 s73, s21
s_mov_b32 s56, s73
s_lshl_b32 s31, s73, 12
s_add_u32 s31, s31, s65
buffer_load_dwordx4 v[4:7], v239, s[36:39], s31 offen offset:0 sc1
buffer_load_dwordx4 v[8:11], v239, s[36:39], s31 offen offset:1024 sc1
buffer_load_dwordx4 v[12:15], v239, s[36:39], s31 offen offset:2048 sc1
buffer_load_dwordx4 v[16:19], v239, s[36:39], s31 offen offset:3072 sc1
s_barrier
s_andn2_b32 s32, s71, s72
s_cbranch_scc0 L_interleave_layers__linear_kernel_hedgehog__mha_block__prompt_kernel_p_q1_sl
L_interleave_layers__linear_kernel_hedgehog__mha_block__prompt_kernel_p_q1_hv:
s_ff1_i32_b32 s73, s32
s_bitset1_b32 s72, s73
s_mov_b32 s57, s73
s_lshl_b32 s31, s73, 12
s_add_u32 s31, s31, s65
buffer_load_dwordx4 v[20:23], v239, s[36:39], s31 offen offset:0 sc1
buffer_load_dwordx4 v[24:27], v239, s[36:39], s31 offen offset:1024 sc1
buffer_load_dwordx4 v[28:31], v239, s[36:39], s31 offen offset:2048 sc1
buffer_load_dwordx4 v[32:35], v239, s[36:39], s31 offen offset:3072 sc1
s_lshl_b32 s31, s56, 13
v_add_u32 v180, s31, v237
v_add_u32 v181, s31, v238
ds_read_b64_tr_b16 v[164:165], v180 offset:0
ds_read_b64_tr_b16 v[166:167], v180 offset:1024
ds_read_b64_tr_b16 v[168:169], v181 offset:0
ds_read_b64_tr_b16 v[170:171], v181 offset:1024
ds_read_b64_tr_b16 v[172:173], v180 offset:2048
ds_read_b64_tr_b16 v[174:175], v180 offset:3072
ds_read_b64_tr_b16 v[176:177], v181 offset:2048
ds_read_b64_tr_b16 v[178:179], v181 offset:3072
s_lshl_b32 s31, s57, 13
v_add_u32 v182, s31, v237
v_add_u32 v183, s31, v238
s_waitcnt vmcnt(7) lgkmcnt(4)
v_mfma_f32_32x32x16_bf16 v[132:147], v[164:167], v[4:7], 0
ds_read_b64_tr_b16 v[192:193], v180 offset:4096
ds_read_b64_tr_b16 v[194:195], v180 offset:5120
v_mfma_f32_32x32x16_bf16 v[148:163], v[168:171], v[4:7], 0
ds_read_b64_tr_b16 v[196:197], v181 offset:4096
ds_read_b64_tr_b16 v[198:199], v181 offset:5120
s_waitcnt vmcnt(6) lgkmcnt(4)
v_mfma_f32_32x32x16_bf16 v[132:147], v[172:175], v[8:11], v[132:147]
ds_read_b64_tr_b16 v[164:165], v180 offset:6144
ds_read_b64_tr_b16 v[166:167], v180 offset:7168
v_mfma_f32_32x32x16_bf16 v[148:163], v[176:179], v[8:11], v[148:163]
ds_read_b64_tr_b16 v[168:169], v181 offset:6144
ds_read_b64_tr_b16 v[170:171], v181 offset:7168
s_waitcnt vmcnt(5) lgkmcnt(4)
v_mfma_f32_32x32x16_bf16 v[132:147], v[192:195], v[12:15], v[132:147]
ds_read_b64_tr_b16 v[172:173], v182 offset:0
ds_read_b64_tr_b16 v[174:175], v182 offset:1024
v_mfma_f32_32x32x16_bf16 v[148:163], v[196:199], v[12:15], v[148:163]
ds_read_b64_tr_b16 v[176:177], v183 offset:0
ds_read_b64_tr_b16 v[178:179], v183 offset:1024
s_waitcnt vmcnt(4) lgkmcnt(4)
v_mfma_f32_32x32x16_bf16 v[132:147], v[164:167], v[16:19], v[132:147]
ds_read_b64_tr_b16 v[192:193], v182 offset:2048
ds_read_b64_tr_b16 v[194:195], v182 offset:3072
v_mfma_f32_32x32x16_bf16 v[148:163], v[168:171], v[16:19], v[148:163]
ds_read_b64_tr_b16 v[196:197], v183 offset:2048
ds_read_b64_tr_b16 v[198:199], v183 offset:3072
s_andn2_b32 s32, s71, s72
s_cbranch_scc0 L_interleave_layers__linear_kernel_hedgehog__mha_block__prompt_kernel_p_q2_sl
L_interleave_layers__linear_kernel_hedgehog__mha_block__prompt_kernel_p_q2_hv:
s_ff1_i32_b32 s73, s32
s_bitset1_b32 s72, s73
s_mov_b32 s58, s73
s_lshl_b32 s31, s73, 12
s_add_u32 s31, s31, s65
buffer_load_dwordx4 v[36:39], v239, s[36:39], s31 offen offset:0 sc1
buffer_load_dwordx4 v[40:43], v239, s[36:39], s31 offen offset:1024 sc1
buffer_load_dwordx4 v[44:47], v239, s[36:39], s31 offen offset:2048 sc1
buffer_load_dwordx4 v[48:51], v239, s[36:39], s31 offen offset:3072 sc1
s_andn2_b32 s32, s71, s72
s_cbranch_scc0 L_interleave_layers__linear_kernel_hedgehog__mha_block__prompt_kernel_p_q3_sl
L_interleave_layers__linear_kernel_hedgehog__mha_block__prompt_kernel_p_q3_hv:
s_ff1_i32_b32 s73, s32
s_bitset1_b32 s72, s73
s_mov_b32 s59, s73
s_lshl_b32 s31, s73, 12
s_add_u32 s31, s31, s65
buffer_load_dwordx4 v[52:55], v239, s[36:39], s31 offen offset:0 sc1
buffer_load_dwordx4 v[56:59], v239, s[36:39], s31 offen offset:1024 sc1
buffer_load_dwordx4 v[60:63], v239, s[36:39], s31 offen offset:2048 sc1
buffer_load_dwordx4 v[64:67], v239, s[36:39], s31 offen offset:3072 sc1
s_lshl_b32 s31, s58, 13
v_add_u32 v180, s31, v237
v_add_u32 v181, s31, v238
s_waitcnt vmcnt(11) lgkmcnt(4)
v_mfma_f32_32x32x16_bf16 v[132:147], v[172:175], v[20:23], v[132:147]
ds_read_b64_tr_b16 v[164:165], v182 offset:4096
ds_read_b64_tr_b16 v[166:167], v182 offset:5120
v_mfma_f32_32x32x16_bf16 v[148:163], v[176:179], v[20:23], v[148:163]
ds_read_b64_tr_b16 v[168:169], v183 offset:4096
ds_read_b64_tr_b16 v[170:171], v183 offset:5120
s_waitcnt vmcnt(10) lgkmcnt(4)
v_mfma_f32_32x32x16_bf16 v[132:147], v[192:195], v[24:27], v[132:147]
ds_read_b64_tr_b16 v[172:173], v182 offset:6144
ds_read_b64_tr_b16 v[174:175], v182 offset:7168
v_mfma_f32_32x32x16_bf16 v[148:163], v[196:199], v[24:27], v[148:163]
ds_read_b64_tr_b16 v[176:177], v183 offset:6144
ds_read_b64_tr_b16 v[178:179], v183 offset:7168
s_waitcnt vmcnt(9) lgkmcnt(4)
v_mfma_f32_32x32x16_bf16 v[132:147], v[164:167], v[28:31], v[132:147]
ds_read_b64_tr_b16 v[192:193], v180 offset:0
ds_read_b64_tr_b16 v[194:195], v180 offset:1024
v_mfma_f32_32x32x16_bf16 v[148:163], v[168:171], v[28:31], v[148:163]
ds_read_b64_tr_b16 v[196:197], v181 offset:0
ds_read_b64_tr_b16 v[198:199], v181 offset:1024
s_waitcnt vmcnt(8) lgkmcnt(4)
v_mfma_f32_32x32x16_bf16 v[132:147], v[172:175], v[32:35], v[132:147]
ds_read_b64_tr_b16 v[164:165], v180 offset:2048
ds_read_b64_tr_b16 v[166:167], v180 offset:3072
v_mfma_f32_32x32x16_bf16 v[148:163], v[176:179], v[32:35], v[148:163]
ds_read_b64_tr_b16 v[168:169], v181 offset:2048
ds_read_b64_tr_b16 v[170:171], v181 offset:3072
s_andn2_b32 s32, s71, s72
s_cbranch_scc0 L_interleave_layers__linear_kernel_hedgehog__mha_block__prompt_kernel_p_q4_sl
L_interleave_layers__linear_kernel_hedgehog__mha_block__prompt_kernel_p_q4_hv:
s_ff1_i32_b32 s73, s32
s_bitset1_b32 s72, s73
s_mov_b32 s60, s73
s_lshl_b32 s31, s73, 12
s_add_u32 s31, s31, s65
buffer_load_dwordx4 v[68:71], v239, s[36:39], s31 offen offset:0 sc1
buffer_load_dwordx4 v[72:75], v239, s[36:39], s31 offen offset:1024 sc1
buffer_load_dwordx4 v[76:79], v239, s[36:39], s31 offen offset:2048 sc1
buffer_load_dwordx4 v[80:83], v239, s[36:39], s31 offen offset:3072 sc1
s_andn2_b32 s32, s71, s72
s_cbranch_scc0 L_interleave_layers__linear_kernel_hedgehog__mha_block__prompt_kernel_p_q5_sl
L_interleave_layers__linear_kernel_hedgehog__mha_block__prompt_kernel_p_q5_hv:
s_ff1_i32_b32 s73, s32
s_bitset1_b32 s72, s73
s_mov_b32 s61, s73
s_lshl_b32 s31, s73, 12
s_add_u32 s31, s31, s65
buffer_load_dwordx4 v[84:87], v239, s[36:39], s31 offen offset:0 sc1
buffer_load_dwordx4 v[88:91], v239, s[36:39], s31 offen offset:1024 sc1
buffer_load_dwordx4 v[92:95], v239, s[36:39], s31 offen offset:2048 sc1
buffer_load_dwordx4 v[96:99], v239, s[36:39], s31 offen offset:3072 sc1
s_lshl_b32 s31, s59, 13
v_add_u32 v182, s31, v237
v_add_u32 v183, s31, v238
s_waitcnt vmcnt(15) lgkmcnt(4)
v_mfma_f32_32x32x16_bf16 v[132:147], v[192:195], v[36:39], v[132:147]
ds_read_b64_tr_b16 v[172:173], v180 offset:4096
ds_read_b64_tr_b16 v[174:175], v180 offset:5120
v_mfma_f32_32x32x16_bf16 v[148:163], v[196:199], v[36:39], v[148:163]
ds_read_b64_tr_b16 v[176:177], v181 offset:4096
ds_read_b64_tr_b16 v[178:179], v181 offset:5120
s_waitcnt vmcnt(14) lgkmcnt(4)
v_mfma_f32_32x32x16_bf16 v[132:147], v[164:167], v[40:43], v[132:147]
ds_read_b64_tr_b16 v[192:193], v180 offset:6144
ds_read_b64_tr_b16 v[194:195], v180 offset:7168
v_mfma_f32_32x32x16_bf16 v[148:163], v[168:171], v[40:43], v[148:163]
ds_read_b64_tr_b16 v[196:197], v181 offset:6144
ds_read_b64_tr_b16 v[198:199], v181 offset:7168
s_waitcnt vmcnt(13) lgkmcnt(4)
v_mfma_f32_32x32x16_bf16 v[132:147], v[172:175], v[44:47], v[132:147]
ds_read_b64_tr_b16 v[164:165], v182 offset:0
ds_read_b64_tr_b16 v[166:167], v182 offset:1024
v_mfma_f32_32x32x16_bf16 v[148:163], v[176:179], v[44:47], v[148:163]
ds_read_b64_tr_b16 v[168:169], v183 offset:0
ds_read_b64_tr_b16 v[170:171], v183 offset:1024
s_waitcnt vmcnt(12) lgkmcnt(4)
v_mfma_f32_32x32x16_bf16 v[132:147], v[192:195], v[48:51], v[132:147]
ds_read_b64_tr_b16 v[172:173], v182 offset:2048
ds_read_b64_tr_b16 v[174:175], v182 offset:3072
v_mfma_f32_32x32x16_bf16 v[148:163], v[196:199], v[48:51], v[148:163]
ds_read_b64_tr_b16 v[176:177], v183 offset:2048
ds_read_b64_tr_b16 v[178:179], v183 offset:3072
s_andn2_b32 s32, s71, s72
s_cbranch_scc0 L_interleave_layers__linear_kernel_hedgehog__mha_block__prompt_kernel_p_q6_sl
L_interleave_layers__linear_kernel_hedgehog__mha_block__prompt_kernel_p_q6_hv:
s_ff1_i32_b32 s73, s32
s_bitset1_b32 s72, s73
s_mov_b32 s62, s73
s_lshl_b32 s31, s73, 12
s_add_u32 s31, s31, s65
buffer_load_dwordx4 v[100:103], v239, s[36:39], s31 offen offset:0 sc1
buffer_load_dwordx4 v[104:107], v239, s[36:39], s31 offen offset:1024 sc1
buffer_load_dwordx4 v[108:111], v239, s[36:39], s31 offen offset:2048 sc1
buffer_load_dwordx4 v[112:115], v239, s[36:39], s31 offen offset:3072 sc1
s_andn2_b32 s32, s71, s72
s_cbranch_scc0 L_interleave_layers__linear_kernel_hedgehog__mha_block__prompt_kernel_p_q7_sl
L_interleave_layers__linear_kernel_hedgehog__mha_block__prompt_kernel_p_q7_hv:
s_ff1_i32_b32 s73, s32
s_bitset1_b32 s72, s73
s_mov_b32 s63, s73
s_lshl_b32 s31, s73, 12
s_add_u32 s31, s31, s65
buffer_load_dwordx4 v[116:119], v239, s[36:39], s31 offen offset:0 sc1
buffer_load_dwordx4 v[120:123], v239, s[36:39], s31 offen offset:1024 sc1
buffer_load_dwordx4 v[124:127], v239, s[36:39], s31 offen offset:2048 sc1
buffer_load_dwordx4 v[128:131], v239, s[36:39], s31 offen offset:3072 sc1
s_lshl_b32 s31, s60, 13
v_add_u32 v180, s31, v237
v_add_u32 v181, s31, v238
s_waitcnt vmcnt(19) lgkmcnt(4)
v_mfma_f32_32x32x16_bf16 v[132:147], v[164:167], v[52:55], v[132:147]
ds_read_b64_tr_b16 v[192:193], v182 offset:4096
ds_read_b64_tr_b16 v[194:195], v182 offset:5120
v_mfma_f32_32x32x16_bf16 v[148:163], v[168:171], v[52:55], v[148:163]
ds_read_b64_tr_b16 v[196:197], v183 offset:4096
ds_read_b64_tr_b16 v[198:199], v183 offset:5120
s_waitcnt vmcnt(18) lgkmcnt(4)
v_mfma_f32_32x32x16_bf16 v[132:147], v[172:175], v[56:59], v[132:147]
ds_read_b64_tr_b16 v[164:165], v182 offset:6144
ds_read_b64_tr_b16 v[166:167], v182 offset:7168
v_mfma_f32_32x32x16_bf16 v[148:163], v[176:179], v[56:59], v[148:163]
ds_read_b64_tr_b16 v[168:169], v183 offset:6144
ds_read_b64_tr_b16 v[170:171], v183 offset:7168
s_waitcnt vmcnt(17) lgkmcnt(4)
v_mfma_f32_32x32x16_bf16 v[132:147], v[192:195], v[60:63], v[132:147]
ds_read_b64_tr_b16 v[172:173], v180 offset:0
ds_read_b64_tr_b16 v[174:175], v180 offset:1024
v_mfma_f32_32x32x16_bf16 v[148:163], v[196:199], v[60:63], v[148:163]
ds_read_b64_tr_b16 v[176:177], v181 offset:0
ds_read_b64_tr_b16 v[178:179], v181 offset:1024
s_waitcnt vmcnt(16) lgkmcnt(4)
v_mfma_f32_32x32x16_bf16 v[132:147], v[164:167], v[64:67], v[132:147]
ds_read_b64_tr_b16 v[192:193], v180 offset:2048
ds_read_b64_tr_b16 v[194:195], v180 offset:3072
v_mfma_f32_32x32x16_bf16 v[148:163], v[168:171], v[64:67], v[148:163]
ds_read_b64_tr_b16 v[196:197], v181 offset:2048
ds_read_b64_tr_b16 v[198:199], v181 offset:3072
s_andn2_b32 s32, s71, s72
s_cbranch_scc0 L_interleave_layers__linear_kernel_hedgehog__mha_block__prompt_kernel_p_q8_sl
L_interleave_layers__linear_kernel_hedgehog__mha_block__prompt_kernel_p_q8_hv:
s_ff1_i32_b32 s73, s32
s_bitset1_b32 s72, s73
s_mov_b32 s56, s73
s_lshl_b32 s31, s73, 12
s_add_u32 s31, s31, s65
buffer_load_dwordx4 v[4:7], v239, s[36:39], s31 offen offset:0 sc1
buffer_load_dwordx4 v[8:11], v239, s[36:39], s31 offen offset:1024 sc1
buffer_load_dwordx4 v[12:15], v239, s[36:39], s31 offen offset:2048 sc1
buffer_load_dwordx4 v[16:19], v239, s[36:39], s31 offen offset:3072 sc1
s_lshl_b32 s31, s61, 13
v_add_u32 v182, s31, v237
v_add_u32 v183, s31, v238
s_waitcnt vmcnt(19) lgkmcnt(4)
v_mfma_f32_32x32x16_bf16 v[132:147], v[172:175], v[68:71], v[132:147]
ds_read_b64_tr_b16 v[164:165], v180 offset:4096
ds_read_b64_tr_b16 v[166:167], v180 offset:5120
v_mfma_f32_32x32x16_bf16 v[148:163], v[176:179], v[68:71], v[148:163]
ds_read_b64_tr_b16 v[168:169], v181 offset:4096
ds_read_b64_tr_b16 v[170:171], v181 offset:5120
s_waitcnt vmcnt(18) lgkmcnt(4)
v_mfma_f32_32x32x16_bf16 v[132:147], v[192:195], v[72:75], v[132:147]
ds_read_b64_tr_b16 v[172:173], v180 offset:6144
ds_read_b64_tr_b16 v[174:175], v180 offset:7168
v_mfma_f32_32x32x16_bf16 v[148:163], v[196:199], v[72:75], v[148:163]
ds_read_b64_tr_b16 v[176:177], v181 offset:6144
ds_read_b64_tr_b16 v[178:179], v181 offset:7168
s_waitcnt vmcnt(17) lgkmcnt(4)
v_mfma_f32_32x32x16_bf16 v[132:147], v[164:167], v[76:79], v[132:147]
ds_read_b64_tr_b16 v[192:193], v182 offset:0
ds_read_b64_tr_b16 v[194:195], v182 offset:1024
v_mfma_f32_32x32x16_bf16 v[148:163], v[168:171], v[76:79], v[148:163]
ds_read_b64_tr_b16 v[196:197], v183 offset:0
ds_read_b64_tr_b16 v[198:199], v183 offset:1024
s_waitcnt vmcnt(16) lgkmcnt(4)
v_mfma_f32_32x32x16_bf16 v[132:147], v[172:175], v[80:83], v[132:147]
ds_read_b64_tr_b16 v[164:165], v182 offset:2048
ds_read_b64_tr_b16 v[166:167], v182 offset:3072
v_mfma_f32_32x32x16_bf16 v[148:163], v[176:179], v[80:83], v[148:163]
ds_read_b64_tr_b16 v[168:169], v183 offset:2048
ds_read_b64_tr_b16 v[170:171], v183 offset:3072
s_andn2_b32 s32, s71, s72
s_cbranch_scc0 L_interleave_layers__linear_kernel_hedgehog__mha_block__prompt_kernel_p_q9_sl
L_interleave_layers__linear_kernel_hedgehog__mha_block__prompt_kernel_p_q9_hv:
s_ff1_i32_b32 s73, s32
s_bitset1_b32 s72, s73
s_mov_b32 s57, s73
s_lshl_b32 s31, s73, 12
s_add_u32 s31, s31, s65
buffer_load_dwordx4 v[20:23], v239, s[36:39], s31 offen offset:0 sc1
buffer_load_dwordx4 v[24:27], v239, s[36:39], s31 offen offset:1024 sc1
buffer_load_dwordx4 v[28:31], v239, s[36:39], s31 offen offset:2048 sc1
buffer_load_dwordx4 v[32:35], v239, s[36:39], s31 offen offset:3072 sc1
s_lshl_b32 s31, s62, 13
v_add_u32 v180, s31, v237
v_add_u32 v181, s31, v238
s_waitcnt vmcnt(19) lgkmcnt(4)
v_mfma_f32_32x32x16_bf16 v[132:147], v[192:195], v[84:87], v[132:147]
ds_read_b64_tr_b16 v[172:173], v182 offset:4096
ds_read_b64_tr_b16 v[174:175], v182 offset:5120
v_mfma_f32_32x32x16_bf16 v[148:163], v[196:199], v[84:87], v[148:163]
ds_read_b64_tr_b16 v[176:177], v183 offset:4096
ds_read_b64_tr_b16 v[178:179], v183 offset:5120
s_waitcnt vmcnt(18) lgkmcnt(4)
v_mfma_f32_32x32x16_bf16 v[132:147], v[164:167], v[88:91], v[132:147]
ds_read_b64_tr_b16 v[192:193], v182 offset:6144
ds_read_b64_tr_b16 v[194:195], v182 offset:7168
v_mfma_f32_32x32x16_bf16 v[148:163], v[168:171], v[88:91], v[148:163]
ds_read_b64_tr_b16 v[196:197], v183 offset:6144
ds_read_b64_tr_b16 v[198:199], v183 offset:7168
s_waitcnt vmcnt(17) lgkmcnt(4)
v_mfma_f32_32x32x16_bf16 v[132:147], v[172:175], v[92:95], v[132:147]
ds_read_b64_tr_b16 v[164:165], v180 offset:0
ds_read_b64_tr_b16 v[166:167], v180 offset:1024
v_mfma_f32_32x32x16_bf16 v[148:163], v[176:179], v[92:95], v[148:163]
ds_read_b64_tr_b16 v[168:169], v181 offset:0
ds_read_b64_tr_b16 v[170:171], v181 offset:1024
s_waitcnt vmcnt(16) lgkmcnt(4)
v_mfma_f32_32x32x16_bf16 v[132:147], v[192:195], v[96:99], v[132:147]
ds_read_b64_tr_b16 v[172:173], v180 offset:2048
ds_read_b64_tr_b16 v[174:175], v180 offset:3072
v_mfma_f32_32x32x16_bf16 v[148:163], v[196:199], v[96:99], v[148:163]
ds_read_b64_tr_b16 v[176:177], v181 offset:2048
ds_read_b64_tr_b16 v[178:179], v181 offset:3072
s_andn2_b32 s32, s71, s72
s_cbranch_scc0 L_interleave_layers__linear_kernel_hedgehog__mha_block__prompt_kernel_p_q10_sl
L_interleave_layers__linear_kernel_hedgehog__mha_block__prompt_kernel_p_q10_hv:
s_ff1_i32_b32 s73, s32
s_bitset1_b32 s72, s73
s_mov_b32 s58, s73
s_lshl_b32 s31, s73, 12
s_add_u32 s31, s31, s65
buffer_load_dwordx4 v[36:39], v239, s[36:39], s31 offen offset:0 sc1
buffer_load_dwordx4 v[40:43], v239, s[36:39], s31 offen offset:1024 sc1
buffer_load_dwordx4 v[44:47], v239, s[36:39], s31 offen offset:2048 sc1
buffer_load_dwordx4 v[48:51], v239, s[36:39], s31 offen offset:3072 sc1
s_lshl_b32 s31, s63, 13
v_add_u32 v182, s31, v237
v_add_u32 v183, s31, v238
s_waitcnt vmcnt(19) lgkmcnt(4)
v_mfma_f32_32x32x16_bf16 v[132:147], v[164:167], v[100:103], v[132:147]
ds_read_b64_tr_b16 v[192:193], v180 offset:4096
ds_read_b64_tr_b16 v[194:195], v180 offset:5120
v_mfma_f32_32x32x16_bf16 v[148:163], v[168:171], v[100:103], v[148:163]
ds_read_b64_tr_b16 v[196:197], v181 offset:4096
ds_read_b64_tr_b16 v[198:199], v181 offset:5120
s_waitcnt vmcnt(18) lgkmcnt(4)
v_mfma_f32_32x32x16_bf16 v[132:147], v[172:175], v[104:107], v[132:147]
ds_read_b64_tr_b16 v[164:165], v180 offset:6144
ds_read_b64_tr_b16 v[166:167], v180 offset:7168
v_mfma_f32_32x32x16_bf16 v[148:163], v[176:179], v[104:107], v[148:163]
ds_read_b64_tr_b16 v[168:169], v181 offset:6144
ds_read_b64_tr_b16 v[170:171], v181 offset:7168
s_waitcnt vmcnt(17) lgkmcnt(4)
v_mfma_f32_32x32x16_bf16 v[132:147], v[192:195], v[108:111], v[132:147]
ds_read_b64_tr_b16 v[172:173], v182 offset:0
ds_read_b64_tr_b16 v[174:175], v182 offset:1024
v_mfma_f32_32x32x16_bf16 v[148:163], v[196:199], v[108:111], v[148:163]
ds_read_b64_tr_b16 v[176:177], v183 offset:0
ds_read_b64_tr_b16 v[178:179], v183 offset:1024
s_waitcnt vmcnt(16) lgkmcnt(4)
v_mfma_f32_32x32x16_bf16 v[132:147], v[164:167], v[112:115], v[132:147]
ds_read_b64_tr_b16 v[192:193], v182 offset:2048
ds_read_b64_tr_b16 v[194:195], v182 offset:3072
v_mfma_f32_32x32x16_bf16 v[148:163], v[168:171], v[112:115], v[148:163]
ds_read_b64_tr_b16 v[196:197], v183 offset:2048
ds_read_b64_tr_b16 v[198:199], v183 offset:3072
s_andn2_b32 s32, s71, s72
s_cbranch_scc0 L_interleave_layers__linear_kernel_hedgehog__mha_block__prompt_kernel_p_q11_sl
L_interleave_layers__linear_kernel_hedgehog__mha_block__prompt_kernel_p_q11_hv:
s_ff1_i32_b32 s73, s32
s_bitset1_b32 s72, s73
s_mov_b32 s59, s73
s_lshl_b32 s31, s73, 12
s_add_u32 s31, s31, s65
buffer_load_dwordx4 v[52:55], v239, s[36:39], s31 offen offset:0 sc1
buffer_load_dwordx4 v[56:59], v239, s[36:39], s31 offen offset:1024 sc1
buffer_load_dwordx4 v[60:63], v239, s[36:39], s31 offen offset:2048 sc1
buffer_load_dwordx4 v[64:67], v239, s[36:39], s31 offen offset:3072 sc1
s_lshl_b32 s31, s56, 13
v_add_u32 v180, s31, v237
v_add_u32 v181, s31, v238
s_waitcnt vmcnt(19) lgkmcnt(4)
v_mfma_f32_32x32x16_bf16 v[132:147], v[172:175], v[116:119], v[132:147]
ds_read_b64_tr_b16 v[164:165], v182 offset:4096
ds_read_b64_tr_b16 v[166:167], v182 offset:5120
v_mfma_f32_32x32x16_bf16 v[148:163], v[176:179], v[116:119], v[148:163]
ds_read_b64_tr_b16 v[168:169], v183 offset:4096
ds_read_b64_tr_b16 v[170:171], v183 offset:5120
s_waitcnt vmcnt(18) lgkmcnt(4)
v_mfma_f32_32x32x16_bf16 v[132:147], v[192:195], v[120:123], v[132:147]
ds_read_b64_tr_b16 v[172:173], v182 offset:6144
ds_read_b64_tr_b16 v[174:175], v182 offset:7168
v_mfma_f32_32x32x16_bf16 v[148:163], v[196:199], v[120:123], v[148:163]
ds_read_b64_tr_b16 v[176:177], v183 offset:6144
ds_read_b64_tr_b16 v[178:179], v183 offset:7168
s_waitcnt vmcnt(17) lgkmcnt(4)
v_mfma_f32_32x32x16_bf16 v[132:147], v[164:167], v[124:127], v[132:147]
ds_read_b64_tr_b16 v[192:193], v180 offset:0
ds_read_b64_tr_b16 v[194:195], v180 offset:1024
v_mfma_f32_32x32x16_bf16 v[148:163], v[168:171], v[124:127], v[148:163]
ds_read_b64_tr_b16 v[196:197], v181 offset:0
ds_read_b64_tr_b16 v[198:199], v181 offset:1024
s_waitcnt vmcnt(16) lgkmcnt(4)
v_mfma_f32_32x32x16_bf16 v[132:147], v[172:175], v[128:131], v[132:147]
ds_read_b64_tr_b16 v[164:165], v180 offset:2048
ds_read_b64_tr_b16 v[166:167], v180 offset:3072
v_mfma_f32_32x32x16_bf16 v[148:163], v[176:179], v[128:131], v[148:163]
ds_read_b64_tr_b16 v[168:169], v181 offset:2048
ds_read_b64_tr_b16 v[170:171], v181 offset:3072
s_andn2_b32 s32, s71, s72
s_cbranch_scc0 L_interleave_layers__linear_kernel_hedgehog__mha_block__prompt_kernel_p_q12_sl
L_interleave_layers__linear_kernel_hedgehog__mha_block__prompt_kernel_p_q12_hv:
s_ff1_i32_b32 s73, s32
s_bitset1_b32 s72, s73
s_mov_b32 s60, s73
s_lshl_b32 s31, s73, 12
s_add_u32 s31, s31, s65
buffer_load_dwordx4 v[68:71], v239, s[36:39], s31 offen offset:0 sc1
buffer_load_dwordx4 v[72:75], v239, s[36:39], s31 offen offset:1024 sc1
buffer_load_dwordx4 v[76:79], v239, s[36:39], s31 offen offset:2048 sc1
buffer_load_dwordx4 v[80:83], v239, s[36:39], s31 offen offset:3072 sc1
s_lshl_b32 s31, s57, 13
v_add_u32 v182, s31, v237
v_add_u32 v183, s31, v238
s_waitcnt vmcnt(19) lgkmcnt(4)
v_mfma_f32_32x32x16_bf16 v[132:147], v[192:195], v[4:7], v[132:147]
ds_read_b64_tr_b16 v[172:173], v180 offset:4096
ds_read_b64_tr_b16 v[174:175], v180 offset:5120
v_mfma_f32_32x32x16_bf16 v[148:163], v[196:199], v[4:7], v[148:163]
ds_read_b64_tr_b16 v[176:177], v181 offset:4096
ds_read_b64_tr_b16 v[178:179], v181 offset:5120
s_waitcnt vmcnt(18) lgkmcnt(4)
v_mfma_f32_32x32x16_bf16 v[132:147], v[164:167], v[8:11], v[132:147]
ds_read_b64_tr_b16 v[192:193], v180 offset:6144
ds_read_b64_tr_b16 v[194:195], v180 offset:7168
v_mfma_f32_32x32x16_bf16 v[148:163], v[168:171], v[8:11], v[148:163]
ds_read_b64_tr_b16 v[196:197], v181 offset:6144
ds_read_b64_tr_b16 v[198:199], v181 offset:7168
s_waitcnt vmcnt(17) lgkmcnt(4)
v_mfma_f32_32x32x16_bf16 v[132:147], v[172:175], v[12:15], v[132:147]
ds_read_b64_tr_b16 v[164:165], v182 offset:0
ds_read_b64_tr_b16 v[166:167], v182 offset:1024
v_mfma_f32_32x32x16_bf16 v[148:163], v[176:179], v[12:15], v[148:163]
ds_read_b64_tr_b16 v[168:169], v183 offset:0
ds_read_b64_tr_b16 v[170:171], v183 offset:1024
s_waitcnt vmcnt(16) lgkmcnt(4)
v_mfma_f32_32x32x16_bf16 v[132:147], v[192:195], v[16:19], v[132:147]
ds_read_b64_tr_b16 v[172:173], v182 offset:2048
ds_read_b64_tr_b16 v[174:175], v182 offset:3072
v_mfma_f32_32x32x16_bf16 v[148:163], v[196:199], v[16:19], v[148:163]
ds_read_b64_tr_b16 v[176:177], v183 offset:2048
ds_read_b64_tr_b16 v[178:179], v183 offset:3072
s_andn2_b32 s32, s71, s72
s_cbranch_scc0 L_interleave_layers__linear_kernel_hedgehog__mha_block__prompt_kernel_p_q13_sl
L_interleave_layers__linear_kernel_hedgehog__mha_block__prompt_kernel_p_q13_hv:
s_ff1_i32_b32 s73, s32
s_bitset1_b32 s72, s73
s_mov_b32 s61, s73
s_lshl_b32 s31, s73, 12
s_add_u32 s31, s31, s65
buffer_load_dwordx4 v[84:87], v239, s[36:39], s31 offen offset:0 sc1
buffer_load_dwordx4 v[88:91], v239, s[36:39], s31 offen offset:1024 sc1
buffer_load_dwordx4 v[92:95], v239, s[36:39], s31 offen offset:2048 sc1
buffer_load_dwordx4 v[96:99], v239, s[36:39], s31 offen offset:3072 sc1
s_lshl_b32 s31, s58, 13
v_add_u32 v180, s31, v237
v_add_u32 v181, s31, v238
s_waitcnt vmcnt(19) lgkmcnt(4)
v_mfma_f32_32x32x16_bf16 v[132:147], v[164:167], v[20:23], v[132:147]
ds_read_b64_tr_b16 v[192:193], v182 offset:4096
ds_read_b64_tr_b16 v[194:195], v182 offset:5120
v_mfma_f32_32x32x16_bf16 v[148:163], v[168:171], v[20:23], v[148:163]
ds_read_b64_tr_b16 v[196:197], v183 offset:4096
ds_read_b64_tr_b16 v[198:199], v183 offset:5120
s_waitcnt vmcnt(18) lgkmcnt(4)
v_mfma_f32_32x32x16_bf16 v[132:147], v[172:175], v[24:27], v[132:147]
ds_read_b64_tr_b16 v[164:165], v182 offset:6144
ds_read_b64_tr_b16 v[166:167], v182 offset:7168
v_mfma_f32_32x32x16_bf16 v[148:163], v[176:179], v[24:27], v[148:163]
ds_read_b64_tr_b16 v[168:169], v183 offset:6144
ds_read_b64_tr_b16 v[170:171], v183 offset:7168
s_waitcnt vmcnt(17) lgkmcnt(4)
v_mfma_f32_32x32x16_bf16 v[132:147], v[192:195], v[28:31], v[132:147]
ds_read_b64_tr_b16 v[172:173], v180 offset:0
ds_read_b64_tr_b16 v[174:175], v180 offset:1024
v_mfma_f32_32x32x16_bf16 v[148:163], v[196:199], v[28:31], v[148:163]
ds_read_b64_tr_b16 v[176:177], v181 offset:0
ds_read_b64_tr_b16 v[178:179], v181 offset:1024
s_waitcnt vmcnt(16) lgkmcnt(4)
v_mfma_f32_32x32x16_bf16 v[132:147], v[164:167], v[32:35], v[132:147]
ds_read_b64_tr_b16 v[192:193], v180 offset:2048
ds_read_b64_tr_b16 v[194:195], v180 offset:3072
v_mfma_f32_32x32x16_bf16 v[148:163], v[168:171], v[32:35], v[148:163]
ds_read_b64_tr_b16 v[196:197], v181 offset:2048
ds_read_b64_tr_b16 v[198:199], v181 offset:3072
s_andn2_b32 s32, s71, s72
s_cbranch_scc0 L_interleave_layers__linear_kernel_hedgehog__mha_block__prompt_kernel_p_q14_sl
L_interleave_layers__linear_kernel_hedgehog__mha_block__prompt_kernel_p_q14_hv:
s_ff1_i32_b32 s73, s32
s_bitset1_b32 s72, s73
s_mov_b32 s62, s73
s_lshl_b32 s31, s73, 12
s_add_u32 s31, s31, s65
buffer_load_dwordx4 v[100:103], v239, s[36:39], s31 offen offset:0 sc1
buffer_load_dwordx4 v[104:107], v239, s[36:39], s31 offen offset:1024 sc1
buffer_load_dwordx4 v[108:111], v239, s[36:39], s31 offen offset:2048 sc1
buffer_load_dwordx4 v[112:115], v239, s[36:39], s31 offen offset:3072 sc1
s_lshl_b32 s31, s59, 13
v_add_u32 v182, s31, v237
v_add_u32 v183, s31, v238
s_waitcnt vmcnt(19) lgkmcnt(4)
v_mfma_f32_32x32x16_bf16 v[132:147], v[172:175], v[36:39], v[132:147]
ds_read_b64_tr_b16 v[164:165], v180 offset:4096
ds_read_b64_tr_b16 v[166:167], v180 offset:5120
v_mfma_f32_32x32x16_bf16 v[148:163], v[176:179], v[36:39], v[148:163]
ds_read_b64_tr_b16 v[168:169], v181 offset:4096
ds_read_b64_tr_b16 v[170:171], v181 offset:5120
s_waitcnt vmcnt(18) lgkmcnt(4)
v_mfma_f32_32x32x16_bf16 v[132:147], v[192:195], v[40:43], v[132:147]
ds_read_b64_tr_b16 v[172:173], v180 offset:6144
ds_read_b64_tr_b16 v[174:175], v180 offset:7168
v_mfma_f32_32x32x16_bf16 v[148:163], v[196:199], v[40:43], v[148:163]
ds_read_b64_tr_b16 v[176:177], v181 offset:6144
ds_read_b64_tr_b16 v[178:179], v181 offset:7168
s_waitcnt vmcnt(17) lgkmcnt(4)
v_mfma_f32_32x32x16_bf16 v[132:147], v[164:167], v[44:47], v[132:147]
ds_read_b64_tr_b16 v[192:193], v182 offset:0
ds_read_b64_tr_b16 v[194:195], v182 offset:1024
v_mfma_f32_32x32x16_bf16 v[148:163], v[168:171], v[44:47], v[148:163]
ds_read_b64_tr_b16 v[196:197], v183 offset:0
ds_read_b64_tr_b16 v[198:199], v183 offset:1024
s_waitcnt vmcnt(16) lgkmcnt(4)
v_mfma_f32_32x32x16_bf16 v[132:147], v[172:175], v[48:51], v[132:147]
ds_read_b64_tr_b16 v[164:165], v182 offset:2048
ds_read_b64_tr_b16 v[166:167], v182 offset:3072
v_mfma_f32_32x32x16_bf16 v[148:163], v[176:179], v[48:51], v[148:163]
ds_read_b64_tr_b16 v[168:169], v183 offset:2048
ds_read_b64_tr_b16 v[170:171], v183 offset:3072
s_andn2_b32 s32, s71, s72
s_cbranch_scc0 L_interleave_layers__linear_kernel_hedgehog__mha_block__prompt_kernel_p_q15_sl
L_interleave_layers__linear_kernel_hedgehog__mha_block__prompt_kernel_p_q15_hv:
s_ff1_i32_b32 s73, s32
s_bitset1_b32 s72, s73
s_mov_b32 s63, s73
s_lshl_b32 s31, s73, 12
s_add_u32 s31, s31, s65
buffer_load_dwordx4 v[116:119], v239, s[36:39], s31 offen offset:0 sc1
buffer_load_dwordx4 v[120:123], v239, s[36:39], s31 offen offset:1024 sc1
buffer_load_dwordx4 v[124:127], v239, s[36:39], s31 offen offset:2048 sc1
buffer_load_dwordx4 v[128:131], v239, s[36:39], s31 offen offset:3072 sc1
s_lshl_b32 s31, s60, 13
v_add_u32 v180, s31, v237
v_add_u32 v181, s31, v238
s_waitcnt vmcnt(19) lgkmcnt(4)
v_mfma_f32_32x32x16_bf16 v[132:147], v[192:195], v[52:55], v[132:147]
ds_read_b64_tr_b16 v[172:173], v182 offset:4096
ds_read_b64_tr_b16 v[174:175], v182 offset:5120
v_mfma_f32_32x32x16_bf16 v[148:163], v[196:199], v[52:55], v[148:163]
ds_read_b64_tr_b16 v[176:177], v183 offset:4096
ds_read_b64_tr_b16 v[178:179], v183 offset:5120
s_waitcnt vmcnt(18) lgkmcnt(4)
v_mfma_f32_32x32x16_bf16 v[132:147], v[164:167], v[56:59], v[132:147]
ds_read_b64_tr_b16 v[192:193], v182 offset:6144
ds_read_b64_tr_b16 v[194:195], v182 offset:7168
v_mfma_f32_32x32x16_bf16 v[148:163], v[168:171], v[56:59], v[148:163]
ds_read_b64_tr_b16 v[196:197], v183 offset:6144
ds_read_b64_tr_b16 v[198:199], v183 offset:7168
s_waitcnt vmcnt(17) lgkmcnt(4)
v_mfma_f32_32x32x16_bf16 v[132:147], v[172:175], v[60:63], v[132:147]
ds_read_b64_tr_b16 v[164:165], v180 offset:0
ds_read_b64_tr_b16 v[166:167], v180 offset:1024
v_mfma_f32_32x32x16_bf16 v[148:163], v[176:179], v[60:63], v[148:163]
ds_read_b64_tr_b16 v[168:169], v181 offset:0
ds_read_b64_tr_b16 v[170:171], v181 offset:1024
s_waitcnt vmcnt(16) lgkmcnt(4)
v_mfma_f32_32x32x16_bf16 v[132:147], v[192:195], v[64:67], v[132:147]
ds_read_b64_tr_b16 v[172:173], v180 offset:2048
ds_read_b64_tr_b16 v[174:175], v180 offset:3072
v_mfma_f32_32x32x16_bf16 v[148:163], v[196:199], v[64:67], v[148:163]
ds_read_b64_tr_b16 v[176:177], v181 offset:2048
ds_read_b64_tr_b16 v[178:179], v181 offset:3072
s_lshl_b32 s31, s61, 13
v_add_u32 v182, s31, v237
v_add_u32 v183, s31, v238
s_waitcnt vmcnt(15) lgkmcnt(4)
v_mfma_f32_32x32x16_bf16 v[132:147], v[164:167], v[68:71], v[132:147]
ds_read_b64_tr_b16 v[192:193], v180 offset:4096
ds_read_b64_tr_b16 v[194:195], v180 offset:5120
v_mfma_f32_32x32x16_bf16 v[148:163], v[168:171], v[68:71], v[148:163]
ds_read_b64_tr_b16 v[196:197], v181 offset:4096
ds_read_b64_tr_b16 v[198:199], v181 offset:5120
s_waitcnt vmcnt(14) lgkmcnt(4)
v_mfma_f32_32x32x16_bf16 v[132:147], v[172:175], v[72:75], v[132:147]
ds_read_b64_tr_b16 v[164:165], v180 offset:6144
ds_read_b64_tr_b16 v[166:167], v180 offset:7168
v_mfma_f32_32x32x16_bf16 v[148:163], v[176:179], v[72:75], v[148:163]
ds_read_b64_tr_b16 v[168:169], v181 offset:6144
ds_read_b64_tr_b16 v[170:171], v181 offset:7168
s_waitcnt vmcnt(13) lgkmcnt(4)
v_mfma_f32_32x32x16_bf16 v[132:147], v[192:195], v[76:79], v[132:147]
ds_read_b64_tr_b16 v[172:173], v182 offset:0
ds_read_b64_tr_b16 v[174:175], v182 offset:1024
v_mfma_f32_32x32x16_bf16 v[148:163], v[196:199], v[76:79], v[148:163]
ds_read_b64_tr_b16 v[176:177], v183 offset:0
ds_read_b64_tr_b16 v[178:179], v183 offset:1024
s_waitcnt vmcnt(12) lgkmcnt(4)
v_mfma_f32_32x32x16_bf16 v[132:147], v[164:167], v[80:83], v[132:147]
ds_read_b64_tr_b16 v[192:193], v182 offset:2048
ds_read_b64_tr_b16 v[194:195], v182 offset:3072
v_mfma_f32_32x32x16_bf16 v[148:163], v[168:171], v[80:83], v[148:163]
ds_read_b64_tr_b16 v[196:197], v183 offset:2048
ds_read_b64_tr_b16 v[198:199], v183 offset:3072
s_lshl_b32 s31, s62, 13
v_add_u32 v180, s31, v237
v_add_u32 v181, s31, v238
s_waitcnt vmcnt(11) lgkmcnt(4)
v_mfma_f32_32x32x16_bf16 v[132:147], v[172:175], v[84:87], v[132:147]
ds_read_b64_tr_b16 v[164:165], v182 offset:4096
ds_read_b64_tr_b16 v[166:167], v182 offset:5120
v_mfma_f32_32x32x16_bf16 v[148:163], v[176:179], v[84:87], v[148:163]
ds_read_b64_tr_b16 v[168:169], v183 offset:4096
ds_read_b64_tr_b16 v[170:171], v183 offset:5120
s_waitcnt vmcnt(10) lgkmcnt(4)
v_mfma_f32_32x32x16_bf16 v[132:147], v[192:195], v[88:91], v[132:147]
ds_read_b64_tr_b16 v[172:173], v182 offset:6144
ds_read_b64_tr_b16 v[174:175], v182 offset:7168
v_mfma_f32_32x32x16_bf16 v[148:163], v[196:199], v[88:91], v[148:163]
ds_read_b64_tr_b16 v[176:177], v183 offset:6144
ds_read_b64_tr_b16 v[178:179], v183 offset:7168
s_waitcnt vmcnt(9) lgkmcnt(4)
v_mfma_f32_32x32x16_bf16 v[132:147], v[164:167], v[92:95], v[132:147]
ds_read_b64_tr_b16 v[192:193], v180 offset:0
ds_read_b64_tr_b16 v[194:195], v180 offset:1024
v_mfma_f32_32x32x16_bf16 v[148:163], v[168:171], v[92:95], v[148:163]
ds_read_b64_tr_b16 v[196:197], v181 offset:0
ds_read_b64_tr_b16 v[198:199], v181 offset:1024
s_waitcnt vmcnt(8) lgkmcnt(4)
v_mfma_f32_32x32x16_bf16 v[132:147], v[172:175], v[96:99], v[132:147]
ds_read_b64_tr_b16 v[164:165], v180 offset:2048
ds_read_b64_tr_b16 v[166:167], v180 offset:3072
v_mfma_f32_32x32x16_bf16 v[148:163], v[176:179], v[96:99], v[148:163]
ds_read_b64_tr_b16 v[168:169], v181 offset:2048
ds_read_b64_tr_b16 v[170:171], v181 offset:3072
s_lshl_b32 s31, s63, 13
v_add_u32 v182, s31, v237
v_add_u32 v183, s31, v238
s_waitcnt vmcnt(7) lgkmcnt(4)
v_mfma_f32_32x32x16_bf16 v[132:147], v[192:195], v[100:103], v[132:147]
ds_read_b64_tr_b16 v[172:173], v180 offset:4096
ds_read_b64_tr_b16 v[174:175], v180 offset:5120
v_mfma_f32_32x32x16_bf16 v[148:163], v[196:199], v[100:103], v[148:163]
ds_read_b64_tr_b16 v[176:177], v181 offset:4096
ds_read_b64_tr_b16 v[178:179], v181 offset:5120
s_waitcnt vmcnt(6) lgkmcnt(4)
v_mfma_f32_32x32x16_bf16 v[132:147], v[164:167], v[104:107], v[132:147]
ds_read_b64_tr_b16 v[192:193], v180 offset:6144
ds_read_b64_tr_b16 v[194:195], v180 offset:7168
v_mfma_f32_32x32x16_bf16 v[148:163], v[168:171], v[104:107], v[148:163]
ds_read_b64_tr_b16 v[196:197], v181 offset:6144
ds_read_b64_tr_b16 v[198:199], v181 offset:7168
s_waitcnt vmcnt(5) lgkmcnt(4)
v_mfma_f32_32x32x16_bf16 v[132:147], v[172:175], v[108:111], v[132:147]
ds_read_b64_tr_b16 v[164:165], v182 offset:0
ds_read_b64_tr_b16 v[166:167], v182 offset:1024
v_mfma_f32_32x32x16_bf16 v[148:163], v[176:179], v[108:111], v[148:163]
ds_read_b64_tr_b16 v[168:169], v183 offset:0
ds_read_b64_tr_b16 v[170:171], v183 offset:1024
s_waitcnt vmcnt(4) lgkmcnt(4)
v_mfma_f32_32x32x16_bf16 v[132:147], v[192:195], v[112:115], v[132:147]
ds_read_b64_tr_b16 v[172:173], v182 offset:2048
ds_read_b64_tr_b16 v[174:175], v182 offset:3072
v_mfma_f32_32x32x16_bf16 v[148:163], v[196:199], v[112:115], v[148:163]
ds_read_b64_tr_b16 v[176:177], v183 offset:2048
ds_read_b64_tr_b16 v[178:179], v183 offset:3072
s_waitcnt vmcnt(3) lgkmcnt(4)
v_mfma_f32_32x32x16_bf16 v[132:147], v[164:167], v[116:119], v[132:147]
ds_read_b64_tr_b16 v[192:193], v182 offset:4096
ds_read_b64_tr_b16 v[194:195], v182 offset:5120
v_mfma_f32_32x32x16_bf16 v[148:163], v[168:171], v[116:119], v[148:163]
ds_read_b64_tr_b16 v[196:197], v183 offset:4096
ds_read_b64_tr_b16 v[198:199], v183 offset:5120
s_waitcnt vmcnt(2) lgkmcnt(4)
v_mfma_f32_32x32x16_bf16 v[132:147], v[172:175], v[120:123], v[132:147]
ds_read_b64_tr_b16 v[164:165], v182 offset:6144
ds_read_b64_tr_b16 v[166:167], v182 offset:7168
v_mfma_f32_32x32x16_bf16 v[148:163], v[176:179], v[120:123], v[148:163]
ds_read_b64_tr_b16 v[168:169], v183 offset:6144
ds_read_b64_tr_b16 v[170:171], v183 offset:7168
s_waitcnt vmcnt(1) lgkmcnt(4)
v_mfma_f32_32x32x16_bf16 v[132:147], v[192:195], v[124:127], v[132:147]
v_mfma_f32_32x32x16_bf16 v[148:163], v[196:199], v[124:127], v[148:163]
s_waitcnt vmcnt(0) lgkmcnt(0)
v_mfma_f32_32x32x16_bf16 v[132:147], v[164:167], v[128:131], v[132:147]
v_mfma_f32_32x32x16_bf16 v[148:163], v[168:171], v[128:131], v[148:163]
v_lshlrev_b32 v4, 16, v240
v_and_b32 v5, 0xffff0000, v240
v_lshlrev_b32 v6, 16, v241
v_and_b32 v7, 0xffff0000, v241
v_lshlrev_b32 v8, 16, v242
v_and_b32 v9, 0xffff0000, v242
v_lshlrev_b32 v10, 16, v243
v_and_b32 v11, 0xffff0000, v243
v_lshlrev_b32 v12, 16, v244
v_and_b32 v13, 0xffff0000, v244
v_lshlrev_b32 v14, 16, v245
v_and_b32 v15, 0xffff0000, v245
v_lshlrev_b32 v16, 16, v246
v_and_b32 v17, 0xffff0000, v246
v_lshlrev_b32 v18, 16, v247
v_and_b32 v19, 0xffff0000, v247
v_lshlrev_b32 v20, 16, v248
v_and_b32 v21, 0xffff0000, v248
v_lshlrev_b32 v22, 16, v249
v_and_b32 v23, 0xffff0000, v249
v_lshlrev_b32 v24, 16, v250
v_and_b32 v25, 0xffff0000, v250
v_lshlrev_b32 v26, 16, v251
v_and_b32 v27, 0xffff0000, v251
v_lshlrev_b32 v28, 16, v252
v_and_b32 v29, 0xffff0000, v252
v_lshlrev_b32 v30, 16, v253
v_and_b32 v31, 0xffff0000, v253
v_lshlrev_b32 v32, 16, v254
v_and_b32 v33, 0xffff0000, v254
v_lshlrev_b32 v34, 16, v255
v_and_b32 v35, 0xffff0000, v255
v_pk_add_f32 v[4:5], v[4:5], v[132:133]
v_pk_add_f32 v[6:7], v[6:7], v[134:135]
v_pk_add_f32 v[8:9], v[8:9], v[136:137]
v_pk_add_f32 v[10:11], v[10:11], v[138:139]
v_pk_add_f32 v[12:13], v[12:13], v[140:141]
v_pk_add_f32 v[14:15], v[14:15], v[142:143]
v_pk_add_f32 v[16:17], v[16:17], v[144:145]
v_pk_add_f32 v[18:19], v[18:19], v[146:147]
v_pk_add_f32 v[20:21], v[20:21], v[148:149]
v_pk_add_f32 v[22:23], v[22:23], v[150:151]
v_pk_add_f32 v[24:25], v[24:25], v[152:153]
v_pk_add_f32 v[26:27], v[26:27], v[154:155]
v_pk_add_f32 v[28:29], v[28:29], v[156:157]
v_pk_add_f32 v[30:31], v[30:31], v[158:159]
v_pk_add_f32 v[32:33], v[32:33], v[160:161]
v_pk_add_f32 v[34:35], v[34:35], v[162:163]
v_cvt_pk_bf16_f32 v240, v4, v5
v_cvt_pk_bf16_f32 v241, v6, v7
v_cvt_pk_bf16_f32 v242, v8, v9
v_cvt_pk_bf16_f32 v243, v10, v11
v_cvt_pk_bf16_f32 v244, v12, v13
v_cvt_pk_bf16_f32 v245, v14, v15
v_cvt_pk_bf16_f32 v246, v16, v17
v_cvt_pk_bf16_f32 v247, v18, v19
v_cvt_pk_bf16_f32 v248, v20, v21
v_cvt_pk_bf16_f32 v249, v22, v23
v_cvt_pk_bf16_f32 v250, v24, v25
v_cvt_pk_bf16_f32 v251, v26, v27
v_cvt_pk_bf16_f32 v252, v28, v29
v_cvt_pk_bf16_f32 v253, v30, v31
v_cvt_pk_bf16_f32 v254, v32, v33
v_cvt_pk_bf16_f32 v255, v34, v35
s_cmp_eq_u32 s29, 3
s_cbranch_scc1 L_interleave_layers__linear_kernel_hedgehog__mha_block__prompt_kernel_p_final
s_add_u32 s65, s29, 1
s_mul_i32 s31, s65, 4194304
s_add_u32 s31, s31, 0
s_add_u32 s36, s4, s31
s_addc_u32 s37, s5, 0
s_mov_b32 s38, 4194304
s_mov_b32 s39, 0x20000
s_lshl_b32 s31, s20, 2
s_add_u32 s31, s31, s27
s_lshl_b32 s31, s31, 16
s_lshl_b32 s32, s21, 12
s_add_u32 s31, s31, s32
buffer_store_dwordx4 v[240:243], v239, s[36:39], s31 offen offset:0 sc1
buffer_store_dwordx4 v[244:247], v239, s[36:39], s31 offen offset:1024 sc1
buffer_store_dwordx4 v[248:251], v239, s[36:39], s31 offen offset:2048 sc1
buffer_store_dwordx4 v[252:255], v239, s[36:39], s31 offen offset:3072 sc1
v_pk_mul_f32 v[190:191], v[4:5], v[4:5]
v_pk_add_f32 v[188:189], v[4:5], v[6:7]
v_pk_fma_f32 v[190:191], v[6:7], v[6:7], v[190:191]
v_pk_add_f32 v[188:189], v[188:189], v[8:9]
v_pk_fma_f32 v[190:191], v[8:9], v[8:9], v[190:191]
v_pk_add_f32 v[188:189], v[188:189], v[10:11]
v_pk_fma_f32 v[190:191], v[10:11], v[10:11], v[190:191]
v_pk_add_f32 v[188:189], v[188:189], v[12:13]
v_pk_fma_f32 v[190:191], v[12:13], v[12:13], v[190:191]
v_pk_add_f32 v[188:189], v[188:189], v[14:15]
v_pk_fma_f32 v[190:191], v[14:15], v[14:15], v[190:191]
v_pk_add_f32 v[188:189], v[188:189], v[16:17]
v_pk_fma_f32 v[190:191], v[16:17], v[16:17], v[190:191]
v_pk_add_f32 v[188:189], v[188:189], v[18:19]
v_pk_fma_f32 v[190:191], v[18:19], v[18:19], v[190:191]
v_pk_add_f32 v[188:189], v[188:189], v[20:21]
v_pk_fma_f32 v[190:191], v[20:21], v[20:21], v[190:191]
v_pk_add_f32 v[188:189], v[188:189], v[22:23]
v_pk_fma_f32 v[190:191], v[22:23], v[22:23], v[190:191]
v_pk_add_f32 v[188:189], v[188:189], v[24:25]
v_pk_fma_f32 v[190:191], v[24:25], v[24:25], v[190:191]
v_pk_add_f32 v[188:189], v[188:189], v[26:27]
v_pk_fma_f32 v[190:191], v[26:27], v[26:27], v[190:191]
v_pk_add_f32 v[188:189], v[188:189], v[28:29]
v_pk_fma_f32 v[190:191], v[28:29], v[28:29], v[190:191]
v_pk_add_f32 v[188:189], v[188:189], v[30:31]
v_pk_fma_f32 v[190:191], v[30:31], v[30:31], v[190:191]
v_pk_add_f32 v[188:189], v[188:189], v[32:33]
v_pk_fma_f32 v[190:191], v[32:33], v[32:33], v[190:191]
v_pk_add_f32 v[188:189], v[188:189], v[34:35]
v_pk_fma_f32 v[190:191], v[34:35], v[34:35], v[190:191]
v_add_f32 v186, v188, v189
v_add_f32 v187, v190, v191
v_mov_b32 v184, v186
s_nop 1
v_permlane32_swap_b32 v184, v186
v_add_f32 v186, v186, v184
v_mov_b32 v185, v187
s_nop 1
v_permlane32_swap_b32 v185, v187
v_add_f32 v187, v187, v185
s_mul_i32 s31, s65, 262144
s_add_u32 s31, s31, 55574528
s_add_u32 s48, s4, s31
s_addc_u32 s49, s5, 0
s_mov_b32 s50, 262144
s_mov_b32 s51, 0x20000
s_lshl_b32 s31, s21, 14
s_lshl_b32 s32, s20, 10
s_add_u32 s31, s31, s32
s_lshl_b32 s32, s27, 8
s_add_u32 s31, s31, s32
v_lshlrev_b32 v184, 3, v0
s_mov_b64 exec, 0xffffffff
buffer_store_dwordx2 v[186:187], v184, s[48:51], s31 offen sc1
s_mov_b64 exec, -1
s_waitcnt vmcnt(0)
s_barrier
s_cmp_lg_u32 s22, 0
s_cbranch_scc1 L_interleave_layers__linear_kernel_hedgehog__mha_block__prompt_kernel_p_x_npub
s_mul_i32 s31, s65, 2048
s_lshl_b32 s70, s20, 7
s_add_u32 s70, s70, s31
s_add_u32 s70, s70, 0
s_lshl_b32 s31, s21, 2
s_add_u32 s32, s70, s31
v_mov_b32 v1, s35
v_mov_b32 v2, 0
s_mov_b64 exec, 1
buffer_store_dword v1, v2, s[52:55], s32 offen sc1
s_mov_b64 exec, -1
L_interleave_layers__linear_kernel_hedgehog__mha_block__prompt_kernel_p_x_npub:
s_branch L_interleave_layers__linear_kernel_hedgehog__mha_block__prompt_kernel_p_pdone
L_interleave_layers__linear_kernel_hedgehog__mha_block__prompt_kernel_p_final:
v_permlane32_swap_b32 v240, v242
v_permlane32_swap_b32 v241, v243
v_permlane32_swap_b32 v244, v246
v_permlane32_swap_b32 v245, v247
v_permlane32_swap_b32 v248, v250
v_permlane32_swap_b32 v249, v251
v_permlane32_swap_b32 v252, v254
v_permlane32_swap_b32 v253, v255
s_mov_b32 s36, s16
s_mov_b32 s37, s17
s_mov_b32 s38, 4194304
s_mov_b32 s39, 0x20000
v_and_b32 v184, 31, v0
v_lshlrev_b32 v184, 11, v184
v_lshrrev_b32 v185, 5, v0
v_lshlrev_b32 v185, 4, v185
v_add_u32 v184, v184, v185
s_lshl_b32 s31, s20, 2
s_add_u32 s31, s31, s27
s_lshl_b32 s31, s31, 16
s_lshl_b32 s32, s21, 7
s_add_u32 s31, s31, s32
buffer_store_dwordx4 v[240:243], v184, s[36:39], s31 offen offset:0
buffer_store_dwordx4 v[244:247], v184, s[36:39], s31 offen offset:32
buffer_store_dwordx4 v[248:251], v184, s[36:39], s31 offen offset:64
buffer_store_dwordx4 v[252:255], v184, s[36:39], s31 offen offset:96
s_branch L_interleave_layers__linear_kernel_hedgehog__mha_block__prompt_kernel_done
L_interleave_layers__linear_kernel_hedgehog__mha_block__prompt_kernel_p_pdone:
v_mov_b32 v210, v232
v_mov_b32 v211, v233
v_mov_b32 v52, 0
v_mov_b32 v53, 0
v_mov_b32 v54, 0
v_mov_b32 v55, 0
v_mov_b32 v56, 0
v_mov_b32 v57, 0
v_mov_b32 v58, 0
v_mov_b32 v59, 0
v_mov_b32 v60, 0
v_mov_b32 v61, 0
v_mov_b32 v62, 0
v_mov_b32 v63, 0
v_mov_b32 v64, 0
v_mov_b32 v65, 0
v_mov_b32 v66, 0
v_mov_b32 v67, 0
v_mov_b32 v68, 0
v_mov_b32 v69, 0
v_mov_b32 v70, 0
v_mov_b32 v71, 0
v_mov_b32 v72, 0
v_mov_b32 v73, 0
v_mov_b32 v74, 0
v_mov_b32 v75, 0
v_mov_b32 v76, 0
v_mov_b32 v77, 0
v_mov_b32 v78, 0
v_mov_b32 v79, 0
v_mov_b32 v80, 0
v_mov_b32 v81, 0
v_mov_b32 v82, 0
v_mov_b32 v83, 0
v_mov_b32 v84, 0
v_mov_b32 v85, 0
v_mov_b32 v86, 0
v_mov_b32 v87, 0
v_mov_b32 v88, 0
v_mov_b32 v89, 0
v_mov_b32 v90, 0
v_mov_b32 v91, 0
v_mov_b32 v92, 0
v_mov_b32 v93, 0
v_mov_b32 v94, 0
v_mov_b32 v95, 0
v_mov_b32 v96, 0
v_mov_b32 v97, 0
v_mov_b32 v98, 0
v_mov_b32 v99, 0
v_mov_b32 v100, 0
v_mov_b32 v101, 0
v_mov_b32 v102, 0
v_mov_b32 v103, 0
v_mov_b32 v104, 0
v_mov_b32 v105, 0
v_mov_b32 v106, 0
v_mov_b32 v107, 0
v_mov_b32 v108, 0
v_mov_b32 v109, 0
v_mov_b32 v110, 0
v_mov_b32 v111, 0
v_mov_b32 v112, 0
v_mov_b32 v113, 0
v_mov_b32 v114, 0
v_mov_b32 v115, 0
v_mov_b32 v116, 0
v_mov_b32 v117, 0
v_mov_b32 v118, 0
v_mov_b32 v119, 0
v_mov_b32 v120, 0
v_mov_b32 v121, 0
v_mov_b32 v122, 0
v_mov_b32 v123, 0
v_mov_b32 v124, 0
v_mov_b32 v125, 0
v_mov_b32 v126, 0
v_mov_b32 v127, 0
v_mov_b32 v128, 0
v_mov_b32 v129, 0
v_mov_b32 v130, 0
v_mov_b32 v131, 0
v_mov_b32 v132, 0
v_mov_b32 v133, 0
v_mov_b32 v134, 0
v_mov_b32 v135, 0
v_mov_b32 v136, 0
v_mov_b32 v137, 0
v_mov_b32 v138, 0
v_mov_b32 v139, 0
v_mov_b32 v140, 0
v_mov_b32 v141, 0
v_mov_b32 v142, 0
v_mov_b32 v143, 0
v_mov_b32 v144, 0
v_mov_b32 v145, 0
v_mov_b32 v146, 0
v_mov_b32 v147, 0
s_branch L_interleave_layers__linear_kernel_hedgehog__mha_block__prompt_kernel_lend
L_interleave_layers__linear_kernel_hedgehog__mha_block__prompt_kernel_pL:
s_waitcnt vmcnt(0)
s_barrier
s_cmp_lg_u32 s27, 0
s_cbranch_scc1 L_interleave_layers__linear_kernel_hedgehog__mha_block__prompt_kernel_p_o_kd
s_mul_i32 s31, s29, 2048
s_lshl_b32 s65, s20, 7
s_add_u32 s65, s65, s31
s_add_u32 s65, s65, 16384
s_lshl_b32 s31, s21, 2
s_add_u32 s66, s65, s31
s_mov_b32 s71, 0
s_mov_b32 s34, 2097152
s_add_u32 s75, s29, 1
s_lshl_b32 s75, s75, 16
v_mov_b32 v3, 2240
L_interleave_layers__linear_kernel_hedgehog__mha_block__prompt_kernel_p_o_kp:
s_mov_b32 exec_lo, 0xffff
s_mov_b32 exec_hi, 0
v_lshlrev_b32 v2, 2, v0
buffer_load_dword v1, v2, s[52:55], s65 offen sc1
s_waitcnt vmcnt(0)
v_cmp_eq_u32 vcc, s35, v1
s_mov_b64 exec, -1
s_or_b32 s71, s71, vcc_lo
s_or_b32 s31, s71, s75
v_mov_b32 v1, s31
ds_write_b32 v3, v1
s_cmp_eq_u32 s71, 0xffff
s_cbranch_scc1 L_interleave_layers__linear_kernel_hedgehog__mha_block__prompt_kernel_p_o_kd
s_sub_u32 s34, s34, 1
s_cmp_lg_u32 s34, 0
s_cbranch_scc1 L_interleave_layers__linear_kernel_hedgehog__mha_block__prompt_kernel_p_o_kp
L_interleave_layers__linear_kernel_hedgehog__mha_block__prompt_kernel_p_o_kd:
s_and_b32 s31, s21, 7
s_cmp_lg_u32 s31, 3
s_cbranch_scc1 L_interleave_layers__linear_kernel_hedgehog__mha_block__prompt_kernel_p_nt
s_cmp_eq_u32 s27, 0
s_cbranch_scc1 L_interleave_layers__linear_kernel_hedgehog__mha_block__prompt_kernel_p_nt
s_and_b32 s31, s20, 7
s_cmp_ge_u32 s31, 5
s_cbranch_scc1 L_interleave_layers__linear_kernel_hedgehog__mha_block__prompt_kernel_p_nt
s_mul_i32 s67, s31, 393216
s_bitcmp0_b32 s29, 0
s_cselect_b32 s44, s8, s6
s_cselect_b32 s45, s9, s7
s_mov_b32 s46, 6291456
s_mov_b32 s47, 0x20000
v_mul_u32_u24 v4, 6144, v0
s_sub_u32 s31, s27, 1
s_lshl_b32 s31, s31, 11
s_lshl_b32 s32, s21, 7
s_add_u32 s31, s31, s32
v_add_u32 v4, s31, v4
buffer_load_dword v5, v4, s[44:47], s67 offen
L_interleave_layers__linear_kernel_hedgehog__mha_block__prompt_kernel_p_nt:
s_cmp_eq_u32 s29, 3
s_cbranch_scc1 L_interleave_layers__linear_kernel_hedgehog__mha_block__prompt_kernel_done
s_barrier
s_bitcmp0_b32 s29, 0
s_cselect_b32 s40, s8, s6
s_cselect_b32 s41, s9, s7
s_mov_b32 s42, 6291456
s_mov_b32 s43, 0x20000
s_lshl_b32 s61, s27, 11
s_lshl_b32 s62, s27, 10
s_add_u32 s62, s62, 8192
s_add_u32 s58, s62, 4096
s_add_u32 s78, s62, 8192
s_lshl_b32 s59, s21, 7
s_mov_b32 s60, 8192
s_bitcmp0_b32 s29, 0
s_cbranch_scc1 L_interleave_layers__linear_kernel_hedgehog__mha_block__prompt_kernel_nophi
s_mov_b32 s44, s10
s_mov_b32 s45, s11
s_mov_b32 s46, 65536
s_mov_b32 s47, 0x20000
s_lshl_b32 s31, s27, 10
s_add_u32 m0, s31, 4096
s_lshl_b32 s32, s21, 12
s_add_u32 s31, s31, s32
buffer_load_dwordx4 v239, s[44:47], s31 offen lds
L_interleave_layers__linear_kernel_hedgehog__mha_block__prompt_kernel_nophi:
s_mul_i32 s57, s21, 393216
s_add_u32 s57, s57, s59
s_add_u32 m0, s60, s62
s_nop 0
buffer_load_dwordx4 v232, s[40:43], s57 offen lds
s_add_u32 m0, s60, s58
s_nop 0
buffer_load_dwordx4 v233, s[40:43], s57 offen lds
s_add_u32 m0, s60, s78
s_nop 0
buffer_load_dwordx4 v235, s[40:43], s57 offen lds
s_add_u32 s57, s57, 196608
s_add_u32 s60, s60, 20480
s_cmp_eq_u32 s60, 151552
s_cselect_b32 s60, 8192, s60
s_add_u32 m0, s60, s62
s_nop 0
buffer_load_dwordx4 v232, s[40:43], s57 offen lds
s_add_u32 m0, s60, s58
s_nop 0
buffer_load_dwordx4 v233, s[40:43], s57 offen lds
s_add_u32 m0, s60, s78
s_nop 0
buffer_load_dwordx4 v235, s[40:43], s57 offen lds
s_add_u32 s57, s57, 196608
s_add_u32 s60, s60, 20480
s_cmp_eq_u32 s60, 151552
s_cselect_b32 s60, 8192, s60
s_cmp_lg_u32 s29, 0
s_cbranch_scc1 L_interleave_layers__linear_kernel_hedgehog__mha_block__prompt_kernel_pfcs
s_mov_b32 s60, 110592
s_mul_i32 s57, s20, 393216
s_add_u32 s57, s57, s59
s_add_u32 m0, s60, s62
s_nop 0
buffer_load_dwordx4 v232, s[40:43], s57 offen lds
s_add_u32 m0, s60, s58
s_nop 0
buffer_load_dwordx4 v233, s[40:43], s57 offen lds
s_add_u32 m0, s60, s78
s_nop 0
buffer_load_dwordx4 v235, s[40:43], s57 offen lds
s_add_u32 s57, s57, 196608
s_add_u32 s60, s60, 20480
s_cmp_eq_u32 s60, 151552
s_cselect_b32 s60, 8192, s60
s_add_u32 m0, s60, s62
s_nop 0
buffer_load_dwordx4 v232, s[40:43], s57 offen lds
s_add_u32 m0, s60, s58
s_nop 0
buffer_load_dwordx4 v233, s[40:43], s57 offen lds
s_add_u32 m0, s60, s78
s_nop 0
buffer_load_dwordx4 v235, s[40:43], s57 offen lds
s_add_u32 s57, s57, 196608
s_add_u32 s60, s60, 20480
s_cmp_eq_u32 s60, 151552
s_cselect_b32 s60, 8192, s60
L_interleave_layers__linear_kernel_hedgehog__mha_block__prompt_kernel_pfcs:
s_mov_b32 s60, 8192
L_interleave_layers__linear_kernel_hedgehog__mha_block__prompt_kernel_lend:
s_add_u32 s29, s29, 1
s_lshr_b32 s30, s29, 1
s_branch L_interleave_layers__linear_kernel_hedgehog__mha_block__prompt_kernel_loop
L_interleave_layers__linear_kernel_hedgehog__mha_block__prompt_kernel_done:
s_or_b32 s31, s2, s22
s_cmp_lg_u32 s31, 0
s_cbranch_scc1 L_interleave_layers__linear_kernel_hedgehog__mha_block__prompt_kernel_nononce
s_mov_b32 s32, 28672
v_mov_b32 v1, s35
v_mov_b32 v2, 0
s_mov_b64 exec, 1
buffer_store_dword v1, v2, s[52:55], s32 offen sc1
s_mov_b64 exec, -1
L_interleave_layers__linear_kernel_hedgehog__mha_block__prompt_kernel_nononce:
L_interleave_layers__linear_kernel_hedgehog__mha_block__prompt_kernel_end:
s_endpgm
L_interleave_layers__linear_kernel_hedgehog__mha_block__prompt_kernel_g_k0_keep:
s_cmp_eq_u32 s69, 1
s_cbranch_scc1 L_interleave_layers__linear_kernel_hedgehog__mha_block__prompt_kernel_g_k0_keepi
s_waitcnt vmcnt(0)
v_cmp_eq_u32 vcc, s35, v48
s_nop 0
s_and_b32 s31, vcc_lo, 0xffff
s_or_b32 s71, s71, s31
s_or_b32 s31, s71, s75
v_mov_b32 v50, s31
v_mov_b32 v49, 2244
ds_write_b32 v49, v50
s_mov_b32 s69, 0
s_cmp_eq_u32 s71, 0xffff
s_cbranch_scc1 L_interleave_layers__linear_kernel_hedgehog__mha_block__prompt_kernel_g_k0_nokeep
L_interleave_layers__linear_kernel_hedgehog__mha_block__prompt_kernel_g_k0_keepi:
v_lshlrev_b32 v49, 2, v0
buffer_load_dword v48, v49, s[52:55], s70 offen sc1
s_mov_b32 s69, 2
s_branch L_interleave_layers__linear_kernel_hedgehog__mha_block__prompt_kernel_g_k0_nokeep
L_interleave_layers__linear_kernel_hedgehog__mha_block__prompt_kernel_g_t0:
s_mov_b32 s31, 1966080
buffer_load_dword v47, v46, s[44:47], s31 offen
s_branch L_interleave_layers__linear_kernel_hedgehog__mha_block__prompt_kernel_g_t0_r
L_interleave_layers__linear_kernel_hedgehog__mha_block__prompt_kernel_g_k1_keep:
s_cmp_eq_u32 s69, 1
s_cbranch_scc1 L_interleave_layers__linear_kernel_hedgehog__mha_block__prompt_kernel_g_k1_keepi
s_waitcnt vmcnt(0)
v_cmp_eq_u32 vcc, s35, v48
s_nop 0
s_and_b32 s31, vcc_lo, 0xffff
s_or_b32 s71, s71, s31
s_or_b32 s31, s71, s75
v_mov_b32 v50, s31
v_mov_b32 v49, 2244
ds_write_b32 v49, v50
s_mov_b32 s69, 0
s_cmp_eq_u32 s71, 0xffff
s_cbranch_scc1 L_interleave_layers__linear_kernel_hedgehog__mha_block__prompt_kernel_g_k1_nokeep
L_interleave_layers__linear_kernel_hedgehog__mha_block__prompt_kernel_g_k1_keepi:
v_lshlrev_b32 v49, 2, v0
buffer_load_dword v48, v49, s[52:55], s70 offen sc1
s_mov_b32 s69, 2
s_branch L_interleave_layers__linear_kernel_hedgehog__mha_block__prompt_kernel_g_k1_nokeep
L_interleave_layers__linear_kernel_hedgehog__mha_block__prompt_kernel_g_t1:
s_mov_b32 s31, 2359296
buffer_load_dword v47, v46, s[44:47], s31 offen
s_branch L_interleave_layers__linear_kernel_hedgehog__mha_block__prompt_kernel_g_t1_r
L_interleave_layers__linear_kernel_hedgehog__mha_block__prompt_kernel_g_k2_keep:
s_cmp_eq_u32 s69, 1
s_cbranch_scc1 L_interleave_layers__linear_kernel_hedgehog__mha_block__prompt_kernel_g_k2_keepi
s_waitcnt vmcnt(0)
v_cmp_eq_u32 vcc, s35, v48
s_nop 0
s_and_b32 s31, vcc_lo, 0xffff
s_or_b32 s71, s71, s31
s_or_b32 s31, s71, s75
v_mov_b32 v50, s31
v_mov_b32 v49, 2244
ds_write_b32 v49, v50
s_mov_b32 s69, 0
s_cmp_eq_u32 s71, 0xffff
s_cbranch_scc1 L_interleave_layers__linear_kernel_hedgehog__mha_block__prompt_kernel_g_k2_nokeep
L_interleave_layers__linear_kernel_hedgehog__mha_block__prompt_kernel_g_k2_keepi:
v_lshlrev_b32 v49, 2, v0
buffer_load_dword v48, v49, s[52:55], s70 offen sc1
s_mov_b32 s69, 2
s_branch L_interleave_layers__linear_kernel_hedgehog__mha_block__prompt_kernel_g_k2_nokeep
L_interleave_layers__linear_kernel_hedgehog__mha_block__prompt_kernel_g_t2:
s_mov_b32 s31, 2752512
buffer_load_dword v47, v46, s[44:47], s31 offen
s_branch L_interleave_layers__linear_kernel_hedgehog__mha_block__prompt_kernel_g_t2_r
L_interleave_layers__linear_kernel_hedgehog__mha_block__prompt_kernel_g_k3_keep:
s_cmp_eq_u32 s69, 1
s_cbranch_scc1 L_interleave_layers__linear_kernel_hedgehog__mha_block__prompt_kernel_g_k3_keepi
s_waitcnt vmcnt(0)
v_cmp_eq_u32 vcc, s35, v48
s_nop 0
s_and_b32 s31, vcc_lo, 0xffff
s_or_b32 s71, s71, s31
s_or_b32 s31, s71, s75
v_mov_b32 v50, s31
v_mov_b32 v49, 2244
ds_write_b32 v49, v50
s_mov_b32 s69, 0
s_cmp_eq_u32 s71, 0xffff
s_cbranch_scc1 L_interleave_layers__linear_kernel_hedgehog__mha_block__prompt_kernel_g_k3_nokeep
L_interleave_layers__linear_kernel_hedgehog__mha_block__prompt_kernel_g_k3_keepi:
v_lshlrev_b32 v49, 2, v0
buffer_load_dword v48, v49, s[52:55], s70 offen sc1
s_mov_b32 s69, 2
s_branch L_interleave_layers__linear_kernel_hedgehog__mha_block__prompt_kernel_g_k3_nokeep
L_interleave_layers__linear_kernel_hedgehog__mha_block__prompt_kernel_g_t3:
s_mov_b32 s31, 3145728
buffer_load_dword v47, v46, s[44:47], s31 offen
s_branch L_interleave_layers__linear_kernel_hedgehog__mha_block__prompt_kernel_g_t3_r
L_interleave_layers__linear_kernel_hedgehog__mha_block__prompt_kernel_g_k4_keep:
s_cmp_eq_u32 s69, 1
s_cbranch_scc1 L_interleave_layers__linear_kernel_hedgehog__mha_block__prompt_kernel_g_k4_keepi
s_waitcnt vmcnt(0)
v_cmp_eq_u32 vcc, s35, v48
s_nop 0
s_and_b32 s31, vcc_lo, 0xffff
s_or_b32 s71, s71, s31
s_or_b32 s31, s71, s75
v_mov_b32 v50, s31
v_mov_b32 v49, 2244
ds_write_b32 v49, v50
s_mov_b32 s69, 0
s_cmp_eq_u32 s71, 0xffff
s_cbranch_scc1 L_interleave_layers__linear_kernel_hedgehog__mha_block__prompt_kernel_g_k4_nokeep
L_interleave_layers__linear_kernel_hedgehog__mha_block__prompt_kernel_g_k4_keepi:
v_lshlrev_b32 v49, 2, v0
buffer_load_dword v48, v49, s[52:55], s70 offen sc1
s_mov_b32 s69, 2
s_branch L_interleave_layers__linear_kernel_hedgehog__mha_block__prompt_kernel_g_k4_nokeep
L_interleave_layers__linear_kernel_hedgehog__mha_block__prompt_kernel_g_t4:
s_mov_b32 s31, 3538944
buffer_load_dword v47, v46, s[44:47], s31 offen
s_branch L_interleave_layers__linear_kernel_hedgehog__mha_block__prompt_kernel_g_t4_r
L_interleave_layers__linear_kernel_hedgehog__mha_block__prompt_kernel_g_k5_keep:
s_cmp_eq_u32 s69, 1
s_cbranch_scc1 L_interleave_layers__linear_kernel_hedgehog__mha_block__prompt_kernel_g_k5_keepi
s_waitcnt vmcnt(0)
v_cmp_eq_u32 vcc, s35, v48
s_nop 0
s_and_b32 s31, vcc_lo, 0xffff
s_or_b32 s71, s71, s31
s_or_b32 s31, s71, s75
v_mov_b32 v50, s31
v_mov_b32 v49, 2244
ds_write_b32 v49, v50
s_mov_b32 s69, 0
s_cmp_eq_u32 s71, 0xffff
s_cbranch_scc1 L_interleave_layers__linear_kernel_hedgehog__mha_block__prompt_kernel_g_k5_nokeep
L_interleave_layers__linear_kernel_hedgehog__mha_block__prompt_kernel_g_k5_keepi:
v_lshlrev_b32 v49, 2, v0
buffer_load_dword v48, v49, s[52:55], s70 offen sc1
s_mov_b32 s69, 2
s_branch L_interleave_layers__linear_kernel_hedgehog__mha_block__prompt_kernel_g_k5_nokeep
L_interleave_layers__linear_kernel_hedgehog__mha_block__prompt_kernel_g_t5:
s_mov_b32 s31, 3932160
buffer_load_dword v47, v46, s[44:47], s31 offen
s_branch L_interleave_layers__linear_kernel_hedgehog__mha_block__prompt_kernel_g_t5_r
L_interleave_layers__linear_kernel_hedgehog__mha_block__prompt_kernel_g_k6_keep:
s_cmp_eq_u32 s69, 1
s_cbranch_scc1 L_interleave_layers__linear_kernel_hedgehog__mha_block__prompt_kernel_g_k6_keepi
s_waitcnt vmcnt(0)
v_cmp_eq_u32 vcc, s35, v48
s_nop 0
s_and_b32 s31, vcc_lo, 0xffff
s_or_b32 s71, s71, s31
s_or_b32 s31, s71, s75
v_mov_b32 v50, s31
v_mov_b32 v49, 2244
ds_write_b32 v49, v50
s_mov_b32 s69, 0
s_cmp_eq_u32 s71, 0xffff
s_cbranch_scc1 L_interleave_layers__linear_kernel_hedgehog__mha_block__prompt_kernel_g_k6_nokeep
L_interleave_layers__linear_kernel_hedgehog__mha_block__prompt_kernel_g_k6_keepi:
v_lshlrev_b32 v49, 2, v0
buffer_load_dword v48, v49, s[52:55], s70 offen sc1
s_mov_b32 s69, 2
s_branch L_interleave_layers__linear_kernel_hedgehog__mha_block__prompt_kernel_g_k6_nokeep
L_interleave_layers__linear_kernel_hedgehog__mha_block__prompt_kernel_g_t6:
s_mov_b32 s31, 4325376
buffer_load_dword v47, v46, s[44:47], s31 offen
s_branch L_interleave_layers__linear_kernel_hedgehog__mha_block__prompt_kernel_g_t6_r
L_interleave_layers__linear_kernel_hedgehog__mha_block__prompt_kernel_g_k7_keep:
s_cmp_eq_u32 s69, 1
s_cbranch_scc1 L_interleave_layers__linear_kernel_hedgehog__mha_block__prompt_kernel_g_k7_keepi
s_waitcnt vmcnt(0)
v_cmp_eq_u32 vcc, s35, v48
s_nop 0
s_and_b32 s31, vcc_lo, 0xffff
s_or_b32 s71, s71, s31
s_or_b32 s31, s71, s75
v_mov_b32 v50, s31
v_mov_b32 v49, 2244
ds_write_b32 v49, v50
s_mov_b32 s69, 0
s_cmp_eq_u32 s71, 0xffff
s_cbranch_scc1 L_interleave_layers__linear_kernel_hedgehog__mha_block__prompt_kernel_g_k7_nokeep
L_interleave_layers__linear_kernel_hedgehog__mha_block__prompt_kernel_g_k7_keepi:
v_lshlrev_b32 v49, 2, v0
buffer_load_dword v48, v49, s[52:55], s70 offen sc1
s_mov_b32 s69, 2
s_branch L_interleave_layers__linear_kernel_hedgehog__mha_block__prompt_kernel_g_k7_nokeep
L_interleave_layers__linear_kernel_hedgehog__mha_block__prompt_kernel_g_t7:
s_mov_b32 s31, 4718592
buffer_load_dword v47, v46, s[44:47], s31 offen
s_branch L_interleave_layers__linear_kernel_hedgehog__mha_block__prompt_kernel_g_t7_r
L_interleave_layers__linear_kernel_hedgehog__mha_block__prompt_kernel_g_t8:
s_mov_b32 s31, 5111808
buffer_load_dword v47, v46, s[44:47], s31 offen
s_branch L_interleave_layers__linear_kernel_hedgehog__mha_block__prompt_kernel_g_t8_r
L_interleave_layers__linear_kernel_hedgehog__mha_block__prompt_kernel_g_t9:
s_mov_b32 s31, 5505024
buffer_load_dword v47, v46, s[44:47], s31 offen
s_branch L_interleave_layers__linear_kernel_hedgehog__mha_block__prompt_kernel_g_t9_r
L_interleave_layers__linear_kernel_hedgehog__mha_block__prompt_kernel_g_t10:
s_mov_b32 s31, 5898240
buffer_load_dword v47, v46, s[44:47], s31 offen
s_branch L_interleave_layers__linear_kernel_hedgehog__mha_block__prompt_kernel_g_t10_r
L_interleave_layers__linear_kernel_hedgehog__mha_block__prompt_kernel_a_r1_sl:
s_mov_b32 s34, 2097152
v_mov_b32 v3, 2240
L_interleave_layers__linear_kernel_hedgehog__mha_block__prompt_kernel_a_r1_rd:
ds_read_b32 v1, v3
s_waitcnt lgkmcnt(0)
v_readfirstlane_b32 s31, v1
s_nop 0
s_lshr_b32 s32, s31, 16
s_cmp_eq_u32 s32, s75
s_cselect_b32 s31, s31, 0
s_and_b32 s31, s31, 0xffff
s_or_b32 s71, s71, s31
s_andn2_b32 s32, s71, s72
s_cbranch_scc1 L_interleave_layers__linear_kernel_hedgehog__mha_block__prompt_kernel_a_r1_hv
s_sub_u32 s34, s34, 1
s_cmp_lg_u32 s34, 0
s_cbranch_scc1 L_interleave_layers__linear_kernel_hedgehog__mha_block__prompt_kernel_a_r1_rd
s_orn2_b32 s32, 0, s72
s_and_b32 s32, s32, 0xffff
s_branch L_interleave_layers__linear_kernel_hedgehog__mha_block__prompt_kernel_a_r1_hv
L_interleave_layers__linear_kernel_hedgehog__mha_block__prompt_kernel_a_r2_sl:
s_mov_b32 s34, 2097152
v_mov_b32 v3, 2240
L_interleave_layers__linear_kernel_hedgehog__mha_block__prompt_kernel_a_r2_rd:
ds_read_b32 v1, v3
s_waitcnt lgkmcnt(0)
v_readfirstlane_b32 s31, v1
s_nop 0
s_lshr_b32 s32, s31, 16
s_cmp_eq_u32 s32, s75
s_cselect_b32 s31, s31, 0
s_and_b32 s31, s31, 0xffff
s_or_b32 s71, s71, s31
s_andn2_b32 s32, s71, s72
s_cbranch_scc1 L_interleave_layers__linear_kernel_hedgehog__mha_block__prompt_kernel_a_r2_hv
s_sub_u32 s34, s34, 1
s_cmp_lg_u32 s34, 0
s_cbranch_scc1 L_interleave_layers__linear_kernel_hedgehog__mha_block__prompt_kernel_a_r2_rd
s_orn2_b32 s32, 0, s72
s_and_b32 s32, s32, 0xffff
s_branch L_interleave_layers__linear_kernel_hedgehog__mha_block__prompt_kernel_a_r2_hv
L_interleave_layers__linear_kernel_hedgehog__mha_block__prompt_kernel_a_r3_sl:
s_mov_b32 s34, 2097152
v_mov_b32 v3, 2240
L_interleave_layers__linear_kernel_hedgehog__mha_block__prompt_kernel_a_r3_rd:
ds_read_b32 v1, v3
s_waitcnt lgkmcnt(0)
v_readfirstlane_b32 s31, v1
s_nop 0
s_lshr_b32 s32, s31, 16
s_cmp_eq_u32 s32, s75
s_cselect_b32 s31, s31, 0
s_and_b32 s31, s31, 0xffff
s_or_b32 s71, s71, s31
s_andn2_b32 s32, s71, s72
s_cbranch_scc1 L_interleave_layers__linear_kernel_hedgehog__mha_block__prompt_kernel_a_r3_hv
s_sub_u32 s34, s34, 1
s_cmp_lg_u32 s34, 0
s_cbranch_scc1 L_interleave_layers__linear_kernel_hedgehog__mha_block__prompt_kernel_a_r3_rd
s_orn2_b32 s32, 0, s72
s_and_b32 s32, s32, 0xffff
s_branch L_interleave_layers__linear_kernel_hedgehog__mha_block__prompt_kernel_a_r3_hv
L_interleave_layers__linear_kernel_hedgehog__mha_block__prompt_kernel_a_r4_sl:
s_mov_b32 s34, 2097152
v_mov_b32 v3, 2240
L_interleave_layers__linear_kernel_hedgehog__mha_block__prompt_kernel_a_r4_rd:
ds_read_b32 v1, v3
s_waitcnt lgkmcnt(0)
v_readfirstlane_b32 s31, v1
s_nop 0
s_lshr_b32 s32, s31, 16
s_cmp_eq_u32 s32, s75
s_cselect_b32 s31, s31, 0
s_and_b32 s31, s31, 0xffff
s_or_b32 s71, s71, s31
s_andn2_b32 s32, s71, s72
s_cbranch_scc1 L_interleave_layers__linear_kernel_hedgehog__mha_block__prompt_kernel_a_r4_hv
s_sub_u32 s34, s34, 1
s_cmp_lg_u32 s34, 0
s_cbranch_scc1 L_interleave_layers__linear_kernel_hedgehog__mha_block__prompt_kernel_a_r4_rd
s_orn2_b32 s32, 0, s72
s_and_b32 s32, s32, 0xffff
s_branch L_interleave_layers__linear_kernel_hedgehog__mha_block__prompt_kernel_a_r4_hv
L_interleave_layers__linear_kernel_hedgehog__mha_block__prompt_kernel_a_r5_sl:
s_mov_b32 s34, 2097152
v_mov_b32 v3, 2240
L_interleave_layers__linear_kernel_hedgehog__mha_block__prompt_kernel_a_r5_rd:
ds_read_b32 v1, v3
s_waitcnt lgkmcnt(0)
v_readfirstlane_b32 s31, v1
s_nop 0
s_lshr_b32 s32, s31, 16
s_cmp_eq_u32 s32, s75
s_cselect_b32 s31, s31, 0
s_and_b32 s31, s31, 0xffff
s_or_b32 s71, s71, s31
s_andn2_b32 s32, s71, s72
s_cbranch_scc1 L_interleave_layers__linear_kernel_hedgehog__mha_block__prompt_kernel_a_r5_hv
s_sub_u32 s34, s34, 1
s_cmp_lg_u32 s34, 0
s_cbranch_scc1 L_interleave_layers__linear_kernel_hedgehog__mha_block__prompt_kernel_a_r5_rd
s_orn2_b32 s32, 0, s72
s_and_b32 s32, s32, 0xffff
s_branch L_interleave_layers__linear_kernel_hedgehog__mha_block__prompt_kernel_a_r5_hv
L_interleave_layers__linear_kernel_hedgehog__mha_block__prompt_kernel_a_r6_sl:
s_mov_b32 s34, 2097152
v_mov_b32 v3, 2240
L_interleave_layers__linear_kernel_hedgehog__mha_block__prompt_kernel_a_r6_rd:
ds_read_b32 v1, v3
s_waitcnt lgkmcnt(0)
v_readfirstlane_b32 s31, v1
s_nop 0
s_lshr_b32 s32, s31, 16
s_cmp_eq_u32 s32, s75
s_cselect_b32 s31, s31, 0
s_and_b32 s31, s31, 0xffff
s_or_b32 s71, s71, s31
s_andn2_b32 s32, s71, s72
s_cbranch_scc1 L_interleave_layers__linear_kernel_hedgehog__mha_block__prompt_kernel_a_r6_hv
s_sub_u32 s34, s34, 1
s_cmp_lg_u32 s34, 0
s_cbranch_scc1 L_interleave_layers__linear_kernel_hedgehog__mha_block__prompt_kernel_a_r6_rd
s_orn2_b32 s32, 0, s72
s_and_b32 s32, s32, 0xffff
s_branch L_interleave_layers__linear_kernel_hedgehog__mha_block__prompt_kernel_a_r6_hv
L_interleave_layers__linear_kernel_hedgehog__mha_block__prompt_kernel_a_r7_sl:
s_mov_b32 s34, 2097152
v_mov_b32 v3, 2240
L_interleave_layers__linear_kernel_hedgehog__mha_block__prompt_kernel_a_r7_rd:
ds_read_b32 v1, v3
s_waitcnt lgkmcnt(0)
v_readfirstlane_b32 s31, v1
s_nop 0
s_lshr_b32 s32, s31, 16
s_cmp_eq_u32 s32, s75
s_cselect_b32 s31, s31, 0
s_and_b32 s31, s31, 0xffff
s_or_b32 s71, s71, s31
s_andn2_b32 s32, s71, s72
s_cbranch_scc1 L_interleave_layers__linear_kernel_hedgehog__mha_block__prompt_kernel_a_r7_hv
s_sub_u32 s34, s34, 1
s_cmp_lg_u32 s34, 0
s_cbranch_scc1 L_interleave_layers__linear_kernel_hedgehog__mha_block__prompt_kernel_a_r7_rd
s_orn2_b32 s32, 0, s72
s_and_b32 s32, s32, 0xffff
s_branch L_interleave_layers__linear_kernel_hedgehog__mha_block__prompt_kernel_a_r7_hv
L_interleave_layers__linear_kernel_hedgehog__mha_block__prompt_kernel_a_r8_sl:
s_mov_b32 s34, 2097152
v_mov_b32 v3, 2240
L_interleave_layers__linear_kernel_hedgehog__mha_block__prompt_kernel_a_r8_rd:
ds_read_b32 v1, v3
s_waitcnt lgkmcnt(0)
v_readfirstlane_b32 s31, v1
s_nop 0
s_lshr_b32 s32, s31, 16
s_cmp_eq_u32 s32, s75
s_cselect_b32 s31, s31, 0
s_and_b32 s31, s31, 0xffff
s_or_b32 s71, s71, s31
s_andn2_b32 s32, s71, s72
s_cbranch_scc1 L_interleave_layers__linear_kernel_hedgehog__mha_block__prompt_kernel_a_r8_hv
s_sub_u32 s34, s34, 1
s_cmp_lg_u32 s34, 0
s_cbranch_scc1 L_interleave_layers__linear_kernel_hedgehog__mha_block__prompt_kernel_a_r8_rd
s_orn2_b32 s32, 0, s72
s_and_b32 s32, s32, 0xffff
s_branch L_interleave_layers__linear_kernel_hedgehog__mha_block__prompt_kernel_a_r8_hv
L_interleave_layers__linear_kernel_hedgehog__mha_block__prompt_kernel_a_r9_sl:
s_mov_b32 s34, 2097152
v_mov_b32 v3, 2240
L_interleave_layers__linear_kernel_hedgehog__mha_block__prompt_kernel_a_r9_rd:
ds_read_b32 v1, v3
s_waitcnt lgkmcnt(0)
v_readfirstlane_b32 s31, v1
s_nop 0
s_lshr_b32 s32, s31, 16
s_cmp_eq_u32 s32, s75
s_cselect_b32 s31, s31, 0
s_and_b32 s31, s31, 0xffff
s_or_b32 s71, s71, s31
s_andn2_b32 s32, s71, s72
s_cbranch_scc1 L_interleave_layers__linear_kernel_hedgehog__mha_block__prompt_kernel_a_r9_hv
s_sub_u32 s34, s34, 1
s_cmp_lg_u32 s34, 0
s_cbranch_scc1 L_interleave_layers__linear_kernel_hedgehog__mha_block__prompt_kernel_a_r9_rd
s_orn2_b32 s32, 0, s72
s_and_b32 s32, s32, 0xffff
s_branch L_interleave_layers__linear_kernel_hedgehog__mha_block__prompt_kernel_a_r9_hv
L_interleave_layers__linear_kernel_hedgehog__mha_block__prompt_kernel_a_r10_sl:
s_mov_b32 s34, 2097152
v_mov_b32 v3, 2240
L_interleave_layers__linear_kernel_hedgehog__mha_block__prompt_kernel_a_r10_rd:
ds_read_b32 v1, v3
s_waitcnt lgkmcnt(0)
v_readfirstlane_b32 s31, v1
s_nop 0
s_lshr_b32 s32, s31, 16
s_cmp_eq_u32 s32, s75
s_cselect_b32 s31, s31, 0
s_and_b32 s31, s31, 0xffff
s_or_b32 s71, s71, s31
s_andn2_b32 s32, s71, s72
s_cbranch_scc1 L_interleave_layers__linear_kernel_hedgehog__mha_block__prompt_kernel_a_r10_hv
s_sub_u32 s34, s34, 1
s_cmp_lg_u32 s34, 0
s_cbranch_scc1 L_interleave_layers__linear_kernel_hedgehog__mha_block__prompt_kernel_a_r10_rd
s_orn2_b32 s32, 0, s72
s_and_b32 s32, s32, 0xffff
s_branch L_interleave_layers__linear_kernel_hedgehog__mha_block__prompt_kernel_a_r10_hv
L_interleave_layers__linear_kernel_hedgehog__mha_block__prompt_kernel_a_r11_sl:
s_mov_b32 s34, 2097152
v_mov_b32 v3, 2240
L_interleave_layers__linear_kernel_hedgehog__mha_block__prompt_kernel_a_r11_rd:
ds_read_b32 v1, v3
s_waitcnt lgkmcnt(0)
v_readfirstlane_b32 s31, v1
s_nop 0
s_lshr_b32 s32, s31, 16
s_cmp_eq_u32 s32, s75
s_cselect_b32 s31, s31, 0
s_and_b32 s31, s31, 0xffff
s_or_b32 s71, s71, s31
s_andn2_b32 s32, s71, s72
s_cbranch_scc1 L_interleave_layers__linear_kernel_hedgehog__mha_block__prompt_kernel_a_r11_hv
s_sub_u32 s34, s34, 1
s_cmp_lg_u32 s34, 0
s_cbranch_scc1 L_interleave_layers__linear_kernel_hedgehog__mha_block__prompt_kernel_a_r11_rd
s_orn2_b32 s32, 0, s72
s_and_b32 s32, s32, 0xffff
s_branch L_interleave_layers__linear_kernel_hedgehog__mha_block__prompt_kernel_a_r11_hv
L_interleave_layers__linear_kernel_hedgehog__mha_block__prompt_kernel_a_r12_sl:
s_mov_b32 s34, 2097152
v_mov_b32 v3, 2240
L_interleave_layers__linear_kernel_hedgehog__mha_block__prompt_kernel_a_r12_rd:
ds_read_b32 v1, v3
s_waitcnt lgkmcnt(0)
v_readfirstlane_b32 s31, v1
s_nop 0
s_lshr_b32 s32, s31, 16
s_cmp_eq_u32 s32, s75
s_cselect_b32 s31, s31, 0
s_and_b32 s31, s31, 0xffff
s_or_b32 s71, s71, s31
s_andn2_b32 s32, s71, s72
s_cbranch_scc1 L_interleave_layers__linear_kernel_hedgehog__mha_block__prompt_kernel_a_r12_hv
s_sub_u32 s34, s34, 1
s_cmp_lg_u32 s34, 0
s_cbranch_scc1 L_interleave_layers__linear_kernel_hedgehog__mha_block__prompt_kernel_a_r12_rd
s_orn2_b32 s32, 0, s72
s_and_b32 s32, s32, 0xffff
s_branch L_interleave_layers__linear_kernel_hedgehog__mha_block__prompt_kernel_a_r12_hv
L_interleave_layers__linear_kernel_hedgehog__mha_block__prompt_kernel_a_r13_sl:
s_mov_b32 s34, 2097152
v_mov_b32 v3, 2240
L_interleave_layers__linear_kernel_hedgehog__mha_block__prompt_kernel_a_r13_rd:
ds_read_b32 v1, v3
s_waitcnt lgkmcnt(0)
v_readfirstlane_b32 s31, v1
s_nop 0
s_lshr_b32 s32, s31, 16
s_cmp_eq_u32 s32, s75
s_cselect_b32 s31, s31, 0
s_and_b32 s31, s31, 0xffff
s_or_b32 s71, s71, s31
s_andn2_b32 s32, s71, s72
s_cbranch_scc1 L_interleave_layers__linear_kernel_hedgehog__mha_block__prompt_kernel_a_r13_hv
s_sub_u32 s34, s34, 1
s_cmp_lg_u32 s34, 0
s_cbranch_scc1 L_interleave_layers__linear_kernel_hedgehog__mha_block__prompt_kernel_a_r13_rd
s_orn2_b32 s32, 0, s72
s_and_b32 s32, s32, 0xffff
s_branch L_interleave_layers__linear_kernel_hedgehog__mha_block__prompt_kernel_a_r13_hv
L_interleave_layers__linear_kernel_hedgehog__mha_block__prompt_kernel_a_r14_sl:
s_mov_b32 s34, 2097152
v_mov_b32 v3, 2240
L_interleave_layers__linear_kernel_hedgehog__mha_block__prompt_kernel_a_r14_rd:
ds_read_b32 v1, v3
s_waitcnt lgkmcnt(0)
v_readfirstlane_b32 s31, v1
s_nop 0
s_lshr_b32 s32, s31, 16
s_cmp_eq_u32 s32, s75
s_cselect_b32 s31, s31, 0
s_and_b32 s31, s31, 0xffff
s_or_b32 s71, s71, s31
s_andn2_b32 s32, s71, s72
s_cbranch_scc1 L_interleave_layers__linear_kernel_hedgehog__mha_block__prompt_kernel_a_r14_hv
s_sub_u32 s34, s34, 1
s_cmp_lg_u32 s34, 0
s_cbranch_scc1 L_interleave_layers__linear_kernel_hedgehog__mha_block__prompt_kernel_a_r14_rd
s_orn2_b32 s32, 0, s72
s_and_b32 s32, s32, 0xffff
s_branch L_interleave_layers__linear_kernel_hedgehog__mha_block__prompt_kernel_a_r14_hv
L_interleave_layers__linear_kernel_hedgehog__mha_block__prompt_kernel_a_r15_sl:
s_mov_b32 s34, 2097152
v_mov_b32 v3, 2240
L_interleave_layers__linear_kernel_hedgehog__mha_block__prompt_kernel_a_r15_rd:
ds_read_b32 v1, v3
s_waitcnt lgkmcnt(0)
v_readfirstlane_b32 s31, v1
s_nop 0
s_lshr_b32 s32, s31, 16
s_cmp_eq_u32 s32, s75
s_cselect_b32 s31, s31, 0
s_and_b32 s31, s31, 0xffff
s_or_b32 s71, s71, s31
s_andn2_b32 s32, s71, s72
s_cbranch_scc1 L_interleave_layers__linear_kernel_hedgehog__mha_block__prompt_kernel_a_r15_hv
s_sub_u32 s34, s34, 1
s_cmp_lg_u32 s34, 0
s_cbranch_scc1 L_interleave_layers__linear_kernel_hedgehog__mha_block__prompt_kernel_a_r15_rd
s_orn2_b32 s32, 0, s72
s_and_b32 s32, s32, 0xffff
s_branch L_interleave_layers__linear_kernel_hedgehog__mha_block__prompt_kernel_a_r15_hv
L_interleave_layers__linear_kernel_hedgehog__mha_block__prompt_kernel_p_q1_sl:
s_mov_b32 s34, 2097152
v_mov_b32 v3, 2240
L_interleave_layers__linear_kernel_hedgehog__mha_block__prompt_kernel_p_q1_rd:
ds_read_b32 v1, v3
s_waitcnt lgkmcnt(0)
v_readfirstlane_b32 s31, v1
s_nop 0
s_lshr_b32 s32, s31, 16
s_cmp_eq_u32 s32, s75
s_cselect_b32 s31, s31, 0
s_and_b32 s31, s31, 0xffff
s_or_b32 s71, s71, s31
s_andn2_b32 s32, s71, s72
s_cbranch_scc1 L_interleave_layers__linear_kernel_hedgehog__mha_block__prompt_kernel_p_q1_hv
s_sub_u32 s34, s34, 1
s_cmp_lg_u32 s34, 0
s_cbranch_scc1 L_interleave_layers__linear_kernel_hedgehog__mha_block__prompt_kernel_p_q1_rd
s_orn2_b32 s32, 0, s72
s_and_b32 s32, s32, 0xffff
s_branch L_interleave_layers__linear_kernel_hedgehog__mha_block__prompt_kernel_p_q1_hv
L_interleave_layers__linear_kernel_hedgehog__mha_block__prompt_kernel_p_q2_sl:
s_mov_b32 s34, 2097152
v_mov_b32 v3, 2240
L_interleave_layers__linear_kernel_hedgehog__mha_block__prompt_kernel_p_q2_rd:
ds_read_b32 v1, v3
s_waitcnt lgkmcnt(0)
v_readfirstlane_b32 s31, v1
s_nop 0
s_lshr_b32 s32, s31, 16
s_cmp_eq_u32 s32, s75
s_cselect_b32 s31, s31, 0
s_and_b32 s31, s31, 0xffff
s_or_b32 s71, s71, s31
s_andn2_b32 s32, s71, s72
s_cbranch_scc1 L_interleave_layers__linear_kernel_hedgehog__mha_block__prompt_kernel_p_q2_hv
s_sub_u32 s34, s34, 1
s_cmp_lg_u32 s34, 0
s_cbranch_scc1 L_interleave_layers__linear_kernel_hedgehog__mha_block__prompt_kernel_p_q2_rd
s_orn2_b32 s32, 0, s72
s_and_b32 s32, s32, 0xffff
s_branch L_interleave_layers__linear_kernel_hedgehog__mha_block__prompt_kernel_p_q2_hv
L_interleave_layers__linear_kernel_hedgehog__mha_block__prompt_kernel_p_q3_sl:
s_mov_b32 s34, 2097152
v_mov_b32 v3, 2240
L_interleave_layers__linear_kernel_hedgehog__mha_block__prompt_kernel_p_q3_rd:
ds_read_b32 v1, v3
s_waitcnt lgkmcnt(0)
v_readfirstlane_b32 s31, v1
s_nop 0
s_lshr_b32 s32, s31, 16
s_cmp_eq_u32 s32, s75
s_cselect_b32 s31, s31, 0
s_and_b32 s31, s31, 0xffff
s_or_b32 s71, s71, s31
s_andn2_b32 s32, s71, s72
s_cbranch_scc1 L_interleave_layers__linear_kernel_hedgehog__mha_block__prompt_kernel_p_q3_hv
s_sub_u32 s34, s34, 1
s_cmp_lg_u32 s34, 0
s_cbranch_scc1 L_interleave_layers__linear_kernel_hedgehog__mha_block__prompt_kernel_p_q3_rd
s_orn2_b32 s32, 0, s72
s_and_b32 s32, s32, 0xffff
s_branch L_interleave_layers__linear_kernel_hedgehog__mha_block__prompt_kernel_p_q3_hv
L_interleave_layers__linear_kernel_hedgehog__mha_block__prompt_kernel_p_q4_sl:
s_mov_b32 s34, 2097152
v_mov_b32 v3, 2240
L_interleave_layers__linear_kernel_hedgehog__mha_block__prompt_kernel_p_q4_rd:
ds_read_b32 v1, v3
s_waitcnt lgkmcnt(0)
v_readfirstlane_b32 s31, v1
s_nop 0
s_lshr_b32 s32, s31, 16
s_cmp_eq_u32 s32, s75
s_cselect_b32 s31, s31, 0
s_and_b32 s31, s31, 0xffff
s_or_b32 s71, s71, s31
s_andn2_b32 s32, s71, s72
s_cbranch_scc1 L_interleave_layers__linear_kernel_hedgehog__mha_block__prompt_kernel_p_q4_hv
s_sub_u32 s34, s34, 1
s_cmp_lg_u32 s34, 0
s_cbranch_scc1 L_interleave_layers__linear_kernel_hedgehog__mha_block__prompt_kernel_p_q4_rd
s_orn2_b32 s32, 0, s72
s_and_b32 s32, s32, 0xffff
s_branch L_interleave_layers__linear_kernel_hedgehog__mha_block__prompt_kernel_p_q4_hv
L_interleave_layers__linear_kernel_hedgehog__mha_block__prompt_kernel_p_q5_sl:
s_mov_b32 s34, 2097152
v_mov_b32 v3, 2240
L_interleave_layers__linear_kernel_hedgehog__mha_block__prompt_kernel_p_q5_rd:
ds_read_b32 v1, v3
s_waitcnt lgkmcnt(0)
v_readfirstlane_b32 s31, v1
s_nop 0
s_lshr_b32 s32, s31, 16
s_cmp_eq_u32 s32, s75
s_cselect_b32 s31, s31, 0
s_and_b32 s31, s31, 0xffff
s_or_b32 s71, s71, s31
s_andn2_b32 s32, s71, s72
s_cbranch_scc1 L_interleave_layers__linear_kernel_hedgehog__mha_block__prompt_kernel_p_q5_hv
s_sub_u32 s34, s34, 1
s_cmp_lg_u32 s34, 0
s_cbranch_scc1 L_interleave_layers__linear_kernel_hedgehog__mha_block__prompt_kernel_p_q5_rd
s_orn2_b32 s32, 0, s72
s_and_b32 s32, s32, 0xffff
s_branch L_interleave_layers__linear_kernel_hedgehog__mha_block__prompt_kernel_p_q5_hv
L_interleave_layers__linear_kernel_hedgehog__mha_block__prompt_kernel_p_q6_sl:
s_mov_b32 s34, 2097152
v_mov_b32 v3, 2240
L_interleave_layers__linear_kernel_hedgehog__mha_block__prompt_kernel_p_q6_rd:
ds_read_b32 v1, v3
s_waitcnt lgkmcnt(0)
v_readfirstlane_b32 s31, v1
s_nop 0
s_lshr_b32 s32, s31, 16
s_cmp_eq_u32 s32, s75
s_cselect_b32 s31, s31, 0
s_and_b32 s31, s31, 0xffff
s_or_b32 s71, s71, s31
s_andn2_b32 s32, s71, s72
s_cbranch_scc1 L_interleave_layers__linear_kernel_hedgehog__mha_block__prompt_kernel_p_q6_hv
s_sub_u32 s34, s34, 1
s_cmp_lg_u32 s34, 0
s_cbranch_scc1 L_interleave_layers__linear_kernel_hedgehog__mha_block__prompt_kernel_p_q6_rd
s_orn2_b32 s32, 0, s72
s_and_b32 s32, s32, 0xffff
s_branch L_interleave_layers__linear_kernel_hedgehog__mha_block__prompt_kernel_p_q6_hv
L_interleave_layers__linear_kernel_hedgehog__mha_block__prompt_kernel_p_q7_sl:
s_mov_b32 s34, 2097152
v_mov_b32 v3, 2240
L_interleave_layers__linear_kernel_hedgehog__mha_block__prompt_kernel_p_q7_rd:
ds_read_b32 v1, v3
s_waitcnt lgkmcnt(0)
v_readfirstlane_b32 s31, v1
s_nop 0
s_lshr_b32 s32, s31, 16
s_cmp_eq_u32 s32, s75
s_cselect_b32 s31, s31, 0
s_and_b32 s31, s31, 0xffff
s_or_b32 s71, s71, s31
s_andn2_b32 s32, s71, s72
s_cbranch_scc1 L_interleave_layers__linear_kernel_hedgehog__mha_block__prompt_kernel_p_q7_hv
s_sub_u32 s34, s34, 1
s_cmp_lg_u32 s34, 0
s_cbranch_scc1 L_interleave_layers__linear_kernel_hedgehog__mha_block__prompt_kernel_p_q7_rd
s_orn2_b32 s32, 0, s72
s_and_b32 s32, s32, 0xffff
s_branch L_interleave_layers__linear_kernel_hedgehog__mha_block__prompt_kernel_p_q7_hv
L_interleave_layers__linear_kernel_hedgehog__mha_block__prompt_kernel_p_q8_sl:
s_mov_b32 s34, 2097152
v_mov_b32 v3, 2240
L_interleave_layers__linear_kernel_hedgehog__mha_block__prompt_kernel_p_q8_rd:
ds_read_b32 v1, v3
s_waitcnt lgkmcnt(0)
v_readfirstlane_b32 s31, v1
s_nop 0
s_lshr_b32 s32, s31, 16
s_cmp_eq_u32 s32, s75
s_cselect_b32 s31, s31, 0
s_and_b32 s31, s31, 0xffff
s_or_b32 s71, s71, s31
s_andn2_b32 s32, s71, s72
s_cbranch_scc1 L_interleave_layers__linear_kernel_hedgehog__mha_block__prompt_kernel_p_q8_hv
s_sub_u32 s34, s34, 1
s_cmp_lg_u32 s34, 0
s_cbranch_scc1 L_interleave_layers__linear_kernel_hedgehog__mha_block__prompt_kernel_p_q8_rd
s_orn2_b32 s32, 0, s72
s_and_b32 s32, s32, 0xffff
s_branch L_interleave_layers__linear_kernel_hedgehog__mha_block__prompt_kernel_p_q8_hv
L_interleave_layers__linear_kernel_hedgehog__mha_block__prompt_kernel_p_q9_sl:
s_mov_b32 s34, 2097152
v_mov_b32 v3, 2240
L_interleave_layers__linear_kernel_hedgehog__mha_block__prompt_kernel_p_q9_rd:
ds_read_b32 v1, v3
s_waitcnt lgkmcnt(0)
v_readfirstlane_b32 s31, v1
s_nop 0
s_lshr_b32 s32, s31, 16
s_cmp_eq_u32 s32, s75
s_cselect_b32 s31, s31, 0
s_and_b32 s31, s31, 0xffff
s_or_b32 s71, s71, s31
s_andn2_b32 s32, s71, s72
s_cbranch_scc1 L_interleave_layers__linear_kernel_hedgehog__mha_block__prompt_kernel_p_q9_hv
s_sub_u32 s34, s34, 1
s_cmp_lg_u32 s34, 0
s_cbranch_scc1 L_interleave_layers__linear_kernel_hedgehog__mha_block__prompt_kernel_p_q9_rd
s_orn2_b32 s32, 0, s72
s_and_b32 s32, s32, 0xffff
s_branch L_interleave_layers__linear_kernel_hedgehog__mha_block__prompt_kernel_p_q9_hv
L_interleave_layers__linear_kernel_hedgehog__mha_block__prompt_kernel_p_q10_sl:
s_mov_b32 s34, 2097152
v_mov_b32 v3, 2240
L_interleave_layers__linear_kernel_hedgehog__mha_block__prompt_kernel_p_q10_rd:
ds_read_b32 v1, v3
s_waitcnt lgkmcnt(0)
v_readfirstlane_b32 s31, v1
s_nop 0
s_lshr_b32 s32, s31, 16
s_cmp_eq_u32 s32, s75
s_cselect_b32 s31, s31, 0
s_and_b32 s31, s31, 0xffff
s_or_b32 s71, s71, s31
s_andn2_b32 s32, s71, s72
s_cbranch_scc1 L_interleave_layers__linear_kernel_hedgehog__mha_block__prompt_kernel_p_q10_hv
s_sub_u32 s34, s34, 1
s_cmp_lg_u32 s34, 0
s_cbranch_scc1 L_interleave_layers__linear_kernel_hedgehog__mha_block__prompt_kernel_p_q10_rd
s_orn2_b32 s32, 0, s72
s_and_b32 s32, s32, 0xffff
s_branch L_interleave_layers__linear_kernel_hedgehog__mha_block__prompt_kernel_p_q10_hv
L_interleave_layers__linear_kernel_hedgehog__mha_block__prompt_kernel_p_q11_sl:
s_mov_b32 s34, 2097152
v_mov_b32 v3, 2240
L_interleave_layers__linear_kernel_hedgehog__mha_block__prompt_kernel_p_q11_rd:
ds_read_b32 v1, v3
s_waitcnt lgkmcnt(0)
v_readfirstlane_b32 s31, v1
s_nop 0
s_lshr_b32 s32, s31, 16
s_cmp_eq_u32 s32, s75
s_cselect_b32 s31, s31, 0
s_and_b32 s31, s31, 0xffff
s_or_b32 s71, s71, s31
s_andn2_b32 s32, s71, s72
s_cbranch_scc1 L_interleave_layers__linear_kernel_hedgehog__mha_block__prompt_kernel_p_q11_hv
s_sub_u32 s34, s34, 1
s_cmp_lg_u32 s34, 0
s_cbranch_scc1 L_interleave_layers__linear_kernel_hedgehog__mha_block__prompt_kernel_p_q11_rd
s_orn2_b32 s32, 0, s72
s_and_b32 s32, s32, 0xffff
s_branch L_interleave_layers__linear_kernel_hedgehog__mha_block__prompt_kernel_p_q11_hv
L_interleave_layers__linear_kernel_hedgehog__mha_block__prompt_kernel_p_q12_sl:
s_mov_b32 s34, 2097152
v_mov_b32 v3, 2240
L_interleave_layers__linear_kernel_hedgehog__mha_block__prompt_kernel_p_q12_rd:
ds_read_b32 v1, v3
s_waitcnt lgkmcnt(0)
v_readfirstlane_b32 s31, v1
s_nop 0
s_lshr_b32 s32, s31, 16
s_cmp_eq_u32 s32, s75
s_cselect_b32 s31, s31, 0
s_and_b32 s31, s31, 0xffff
s_or_b32 s71, s71, s31
s_andn2_b32 s32, s71, s72
s_cbranch_scc1 L_interleave_layers__linear_kernel_hedgehog__mha_block__prompt_kernel_p_q12_hv
s_sub_u32 s34, s34, 1
s_cmp_lg_u32 s34, 0
s_cbranch_scc1 L_interleave_layers__linear_kernel_hedgehog__mha_block__prompt_kernel_p_q12_rd
s_orn2_b32 s32, 0, s72
s_and_b32 s32, s32, 0xffff
s_branch L_interleave_layers__linear_kernel_hedgehog__mha_block__prompt_kernel_p_q12_hv
L_interleave_layers__linear_kernel_hedgehog__mha_block__prompt_kernel_p_q13_sl:
s_mov_b32 s34, 2097152
v_mov_b32 v3, 2240
L_interleave_layers__linear_kernel_hedgehog__mha_block__prompt_kernel_p_q13_rd:
ds_read_b32 v1, v3
s_waitcnt lgkmcnt(0)
v_readfirstlane_b32 s31, v1
s_nop 0
s_lshr_b32 s32, s31, 16
s_cmp_eq_u32 s32, s75
s_cselect_b32 s31, s31, 0
s_and_b32 s31, s31, 0xffff
s_or_b32 s71, s71, s31
s_andn2_b32 s32, s71, s72
s_cbranch_scc1 L_interleave_layers__linear_kernel_hedgehog__mha_block__prompt_kernel_p_q13_hv
s_sub_u32 s34, s34, 1
s_cmp_lg_u32 s34, 0
s_cbranch_scc1 L_interleave_layers__linear_kernel_hedgehog__mha_block__prompt_kernel_p_q13_rd
s_orn2_b32 s32, 0, s72
s_and_b32 s32, s32, 0xffff
s_branch L_interleave_layers__linear_kernel_hedgehog__mha_block__prompt_kernel_p_q13_hv
L_interleave_layers__linear_kernel_hedgehog__mha_block__prompt_kernel_p_q14_sl:
s_mov_b32 s34, 2097152
v_mov_b32 v3, 2240
L_interleave_layers__linear_kernel_hedgehog__mha_block__prompt_kernel_p_q14_rd:
ds_read_b32 v1, v3
s_waitcnt lgkmcnt(0)
v_readfirstlane_b32 s31, v1
s_nop 0
s_lshr_b32 s32, s31, 16
s_cmp_eq_u32 s32, s75
s_cselect_b32 s31, s31, 0
s_and_b32 s31, s31, 0xffff
s_or_b32 s71, s71, s31
s_andn2_b32 s32, s71, s72
s_cbranch_scc1 L_interleave_layers__linear_kernel_hedgehog__mha_block__prompt_kernel_p_q14_hv
s_sub_u32 s34, s34, 1
s_cmp_lg_u32 s34, 0
s_cbranch_scc1 L_interleave_layers__linear_kernel_hedgehog__mha_block__prompt_kernel_p_q14_rd
s_orn2_b32 s32, 0, s72
s_and_b32 s32, s32, 0xffff
s_branch L_interleave_layers__linear_kernel_hedgehog__mha_block__prompt_kernel_p_q14_hv
L_interleave_layers__linear_kernel_hedgehog__mha_block__prompt_kernel_p_q15_sl:
s_mov_b32 s34, 2097152
v_mov_b32 v3, 2240
L_interleave_layers__linear_kernel_hedgehog__mha_block__prompt_kernel_p_q15_rd:
ds_read_b32 v1, v3
s_waitcnt lgkmcnt(0)
v_readfirstlane_b32 s31, v1
s_nop 0
s_lshr_b32 s32, s31, 16
s_cmp_eq_u32 s32, s75
s_cselect_b32 s31, s31, 0
s_and_b32 s31, s31, 0xffff
s_or_b32 s71, s71, s31
s_andn2_b32 s32, s71, s72
s_cbranch_scc1 L_interleave_layers__linear_kernel_hedgehog__mha_block__prompt_kernel_p_q15_hv
s_sub_u32 s34, s34, 1
s_cmp_lg_u32 s34, 0
s_cbranch_scc1 L_interleave_layers__linear_kernel_hedgehog__mha_block__prompt_kernel_p_q15_rd
s_orn2_b32 s32, 0, s72
s_and_b32 s32, s32, 0xffff
s_branch L_interleave_layers__linear_kernel_hedgehog__mha_block__prompt_kernel_p_q15_hv
s_endpgm
.section .rodata,"a"
.p2align 6
.amdhsa_kernel interleave_layers__linear_kernel_hedgehog__mha_block__prompt_kernel
  .amdhsa_next_free_vgpr 256
  .amdhsa_next_free_sgpr 102
  .amdhsa_accum_offset 256
  .amdhsa_group_segment_fixed_size 0
  .amdhsa_kernarg_size 80
  .amdhsa_user_sgpr_count 2
  .amdhsa_user_sgpr_kernarg_segment_ptr 1
  .amdhsa_system_sgpr_workgroup_id_x 1
.end_amdhsa_kernel
.text
```
